```python
import torch

def _softmax(x, axis=-1):
    return torch.softmax(x, dim=axis)
def _gelu(x):
    return torch.nn.functional.gelu(x, approximate="tanh")
def _silu(x):
    return torch.nn.functional.silu(x)
def _sigmoid(x):
    return torch.sigmoid(x)
def _layernorm(x, axis=-1, eps=1e-5):
    m = x.mean(dim=axis, keepdim=True)
    v = x.var(dim=axis, keepdim=True, unbiased=False)
    return (x - m) / torch.sqrt(v + eps)
def _scatter_add(tgt, idx, src, axis=0):
    return tgt.clone().index_add_(axis, idx, src)
def _segment_sum(src, seg, n):
    out = torch.zeros((n,) + src.shape[1:], dtype=src.dtype)
    return out.index_add_(0, seg, src)
def _pad(x, pw):
    flat = tuple(v for pair in reversed(pw) for v in pair)
    return torch.nn.functional.pad(x, flat)

kernel_name = 'sequential_preLN__spectral_gfnet__dense_activation_silu__prompt'

def setup_inputs():

    _w = (lambda a: (lambda t: t.to(torch.bfloat16) if t.is_floating_point() else t)(torch.as_tensor(a)))
    def _A_setup():
        B, S, D = 1, 2048, 640
        Df = D // 2 + 1
        return {
            "x": _w((lambda *s: torch.randn(*s, dtype=torch.bfloat16) * 0.05)(B, S, D)),
            "w_r": _w((lambda *s: torch.randn(*s, dtype=torch.bfloat16) * 0.4)(S, Df) * 0.02),
            "w_i": _w((lambda *s: torch.randn(*s, dtype=torch.bfloat16) * 0.4)(S, Df) * 0.02),
        }
    _A_in = _A_setup()

    def _B_setup():
        B, S, D, F = 1, 2048, 640, 1728
        return {
            "x": _w((lambda *s: torch.randn(*s, dtype=torch.bfloat16) * 0.05)(B, S, D)),
            "w1": _w((lambda *s: torch.randn(*s, dtype=torch.bfloat16) * 0.8)(D, F) * (D ** -0.5)),
            "w2": _w((lambda *s: torch.randn(*s, dtype=torch.bfloat16) * 0.1)(F, D) * (F ** -0.5)),
        }
    _B_in = _B_setup()

    return {
        "A_x": _A_in["x"],
        "A_w_r": _A_in["w_r"],
        "A_w_i": _A_in["w_i"],
        "B_x": _B_in["x"],
        "B_w1": _B_in["w1"],
        "B_w2": _B_in["w2"],
    }

def reference(A_x, A_w_r, A_w_i, B_x, B_w1, B_w2):
    def _A_ref(x, w_r, w_i):
        B, S, D = x.shape
        X = (lambda x, axes=(-2,-1): torch.fft.rfft2(x.float(), dim=axes))(x, axes=(-2, -1))
        W = w_r + 1j * w_i
        X = X * W
        y = (lambda x, s, axes=(-2,-1): torch.fft.irfft2(x, s=s, dim=axes).to(torch.bfloat16))(X, (S, D), axes=(-2, -1))
        return y

    def _B_ref(x, w1, w2):
        h = torch.einsum("bsd,df->bsf", x, w1)
        h = _silu(h)
        out = torch.einsum("bsf,fd->bsd", h, w2)
        return out

    x = A_x
    h = x + _A_ref(_layernorm(x, axis=-1), A_w_r, A_w_i)
    h2 = h + _B_ref(_layernorm(h, axis=-1), B_w1, B_w2)
    return h2
```

```asm
; @launch grid=(256,1,1) block=(256,1,1) lds=163840
.amdgcn_target "amdgcn-amd-amdhsa--gfx950"
.text
.globl sequential_preLN__spectral_gfnet__dense_activation_silu__prompt_kernel
.p2align 8
.type sequential_preLN__spectral_gfnet__dense_activation_silu__prompt_kernel,@function
sequential_preLN__spectral_gfnet__dense_activation_silu__prompt_kernel:
    s_load_dwordx2 s[4:5], s[0:1], 0
    s_load_dwordx2 s[28:29], s[0:1], 64
    s_load_dwordx2 s[8:9], s[0:1], 8
    s_load_dwordx2 s[12:13], s[0:1], 16
    s_load_dwordx2 s[16:17], s[0:1], 32
    s_load_dwordx2 s[20:21], s[0:1], 40
    s_load_dwordx2 s[24:25], s[0:1], 48
    s_cmp_ge_u32 s2, 256
    s_cbranch_scc1 L_end
    s_getpc_b64 s[60:61]
L_pc:
    s_lshr_b32 s42, s2, 3
    v_min_u32 v6, 26, v0
    s_mul_i32 s50, s42, 3456
    v_lshl_add_u32 v6, v6, 7, s50
    v_min_u32 v6, (L_tab - L_pc + 71676), v6
    global_load_dword v7, v6, s[60:61]
    s_and_b32 s41, s2, 7
    v_and_b32 v2, 15, v0
    v_lshrrev_b32 v113, 4, v0
    s_lshr_b32 s37, s41, 2
    s_lshr_b32 s50, s42, 2
    s_lshl3_add_u32 s37, s37, s50
    s_and_b32 s38, s2, 3
    s_and_b32 s50, s42, 3
    s_lshl2_add_u32 s38, s38, s50
    s_lshl4_add_u32 s101, s37, s38
    s_lshr_b32 s39, s101, 1
    v_lshrrev_b32 v69, 6, v0
    s_nop 0
    v_readfirstlane_b32 s36, v69
    v_mul_u32_u24 v68, 163840, v113
    v_mul_u32_u24 v69, 16, v2
    s_mul_i32 s86, s36, 7168
    v_add_u32 v68, v68, v69
    s_mul_i32 s76, s39, 1280
    s_mov_b32 s6, 2621440
    s_mov_b32 s7, 0x20000
    s_mov_b32 s30, 33554432
    s_mov_b32 s31, 0x20000
    s_mov_b32 s77, 21069824
    s_waitcnt lgkmcnt(0)
    s_add_u32 m0, s86, 0
    s_nop 0
    buffer_load_dwordx4 v68, s[4:7], s76 offen offset:0 lds
    s_add_u32 m0, s86, 768
    s_nop 0
    buffer_load_dwordx4 v68, s[4:7], s76 offen offset:256 lds
    s_add_u32 m0, s86, 1536
    s_nop 0
    buffer_load_dwordx4 v68, s[4:7], s76 offen offset:512 lds
    s_add_u32 m0, s86, 2304
    s_nop 0
    buffer_load_dwordx4 v68, s[4:7], s76 offen offset:768 lds
    s_add_u32 m0, s86, 3072
    s_nop 0
    buffer_load_dwordx4 v68, s[4:7], s76 offen offset:1024 lds
    buffer_load_dword v5, off, s[28:31], s77 sc1
    v_and_b32 v1, 63, v0
    s_add_u32 s32, s60, (L_tab - L_pc)
    s_addc_u32 s33, s61, 0
    s_mov_b32 s34, 71680
    s_mov_b32 s35, 0x20000
    v_lshlrev_b32 v4, 4, v1
    s_and_b32 s40, s42, 1
    s_mov_b32 s49, 0x20000
    s_lshr_b32 s50, s42, 1
    s_xor_b32 s42, s42, s50
    s_and_b32 s42, s42, 1
    s_xor_b32 s42, s42, 1
    s_lshl4_add_u32 s42, s42, s50
    s_lshl3_add_u32 s2, s42, s41
    s_mov_b32 s10, 1314816
    s_mov_b32 s11, 0x20000
    s_mov_b32 s14, 1314816
    s_mov_b32 s15, 0x20000
    s_mov_b32 s18, 2211840
    s_mov_b32 s19, 0x20000
    s_mov_b32 s22, 2211840
    s_mov_b32 s23, 0x20000
    s_mov_b32 s26, 2621440
    s_mov_b32 s27, 0x20000
    s_lshl_b32 s63, s36, 13
    s_and_b32 s50, s36, 1
    s_lshl1_add_u32 s57, s40, s50
    s_lshl_b32 s78, s57, 13
    s_add_u32 s79, s78, 4096
    s_lshl_b32 s71, s57, 10
    s_add_u32 s71, s71, 32768
    v_lshlrev_b32 v112, 4, v2
    s_lshl2_add_u32 s83, s42, s36
    s_sub_u32 s53, 16, s41
    s_cmp_eq_u32 s41, 0
    s_cselect_b32 s53, 8, s53
    s_sub_u32 s53, s53, s41
    s_mul_i32 s53, s53, 642
    v_and_b32 v216, 7, v0
    v_min_u32 v216, 5, v216
    v_lshlrev_b32 v216, 7, v216
    v_bfe_u32 v217, v0, 3, 1
    v_mad_u32_u24 v216, v217, s53, v216
    v_bfe_u32 v217, v0, 4, 2
    v_lshl_add_u32 v216, v217, 28, v216
    s_lshl4_add_u32 s68, s83, s41
    s_mul_i32 s68, s68, 642
    v_min_u32 v218, 17, v1
    v_lshlrev_b32 v218, 7, v218
    s_mul_i32 s69, s41, 286720
    s_mul_i32 s53, s83, 2304
    s_add_u32 s69, s69, s53
    v_and_b32 v219, 7, v0
    v_min_u32 v219, 6, v219
    v_lshrrev_b32 v217, 3, v1
    v_min_u32 v217, 4, v217
    v_mul_u32_u24 v217, 3456, v217
    v_lshl_add_u32 v219, v219, 7, v217
    s_and_b32 s53, s2, 3
    s_mul_i32 s53, s53, 896
    s_mul_i32 s81, s83, 17280
    s_add_u32 s81, s81, s53
    s_mul_i32 s101, s101, 31488
    v_mov_b32 v244, -1
    v_mov_b32 v245, -1
    v_mov_b32 v246, -1
    v_mov_b32 v247, -1
    s_lshr_b32 s65, s36, 1
    s_and_b32 s66, s36, 1
    s_lshl_b32 s66, s66, 6
    s_add_u32 s66, s66, s101
    s_mul_i32 s55, s65, 384
    s_add_u32 s66, s66, s55
    v_lshrrev_b32 v3, 4, v1
    s_mov_b32 s44, 0x3e9e377a
    s_mov_b32 s45, 0xbf4f1bbd
    s_mov_b32 s46, 0x3f737871
    s_mov_b32 s47, 0x3f167918
    s_mov_b32 s48, 0xffff
    v_and_b32 v114, 7, v0
    v_xor_b32 v114, v113, v114
    v_lshlrev_b32 v114, 4, v114
    v_lshl_add_u32 v114, v2, 8, v114
    v_add_u32 v114, 114688, v114
    v_xor_b32 v115, 128, v114
    s_lshl_b32 s54, s65, 3
    buffer_load_dwordx4 a[0:3], v4, s[32:35], s78 offen offset:0
    v_lshrrev_b32 v196, 2, v2
    v_lshlrev_b32 v196, 1, v196
    v_and_b32 v197, 1, v2
    v_add3_u32 v196, v196, v197, s54
    v_bfe_u32 v197, v2, 1, 1
    v_lshlrev_b32 v198, 3, v197
    v_xor_b32 v196, v196, v198
    v_xor_b32 v196, v196, v3
    v_lshlrev_b32 v196, 4, v196
    v_lshl_add_u32 v196, v3, 8, v196
    v_lshl_add_u32 v196, v197, 12, v196
    v_add_u32 v116, 114688, v196
    buffer_load_dwordx4 a[16:19], v4, s[32:35], s79 offen offset:0
    v_xor_b32 v117, 64, v116
    v_cvt_f32_u32 v196, v2
    v_mul_f32 v196, 0x3a000000, v196
    v_lshlrev_b32 v197, 8, v3
    v_add_u32 v197, s39, v197
    v_cvt_f32_u32 v197, v197
    v_add_f32 v198, 0x0, v197
    v_mul_f32 v198, v196, v198
    v_cos_f32 v199, v198
    v_sin_f32 v200, v198
    s_nop 0
    v_cvt_pk_f16_f32 v104, v199, v200
    v_cvt_pk_f16_f32 v108, -v200, v199
    buffer_load_dwordx4 a[4:7], v4, s[32:35], s78 offen offset:1024
    v_add_f32 v198, 0x43000000, v197
    v_mul_f32 v198, v196, v198
    v_cos_f32 v199, v198
    v_sin_f32 v200, v198
    s_nop 0
    v_cvt_pk_f16_f32 v105, v199, v200
    v_cvt_pk_f16_f32 v109, -v200, v199
    v_add_f32 v198, 0x44800000, v197
    v_mul_f32 v198, v196, v198
    v_cos_f32 v199, v198
    v_sin_f32 v200, v198
    s_nop 0
    v_cvt_pk_f16_f32 v106, v199, v200
    v_cvt_pk_f16_f32 v110, -v200, v199
    buffer_load_dwordx4 a[20:23], v4, s[32:35], s79 offen offset:1024
    v_add_f32 v198, 0x44900000, v197
    v_mul_f32 v198, v196, v198
    v_cos_f32 v199, v198
    v_sin_f32 v200, v198
    s_nop 0
    v_cvt_pk_f16_f32 v107, v199, v200
    v_cvt_pk_f16_f32 v111, -v200, v199
    v_lshlrev_b32 v118, 2, v113
    v_add_u32 v118, 149504, v118
    s_lshl_b32 s54, s65, 5
    s_add_u32 s54, s54, 149504
    v_lshl_add_u32 v119, v3, 3, s54
    s_lshl_b32 s54, s40, 5
    buffer_load_dwordx4 a[8:11], v4, s[32:35], s78 offen offset:2048
    s_add_u32 s54, s54, 149568
    v_and_b32 v27, 7, v0
    v_lshl_add_u32 v27, v27, 2, s54
    s_lshl_b32 s54, s40, 3
    s_and_b32 s55, s36, 1
    s_lshl_b32 s56, s55, 2
    s_xor_b32 s54, s54, s56
    v_xor_b32 v120, v2, v3
    v_xor_b32 v120, s54, v120
    v_lshlrev_b32 v120, 4, v120
    v_lshl_add_u32 v120, v3, 8, v120
    v_lshrrev_b32 v197, 3, v2
    buffer_load_dwordx4 a[24:27], v4, s[32:35], s79 offen offset:2048
    v_lshl_add_u32 v120, v197, 12, v120
    s_lshl_b32 s54, s36, 10
    s_add_u32 s54, s54, 114688
    v_add_u32 v120, s54, v120
    s_mul_i32 s54, s55, 5120
    s_add_u32 s54, s54, 139264
    s_lshl_b32 s55, s65, 3
    s_add_u32 s55, s55, s54
    v_add_u32 v121, s55, v4
    s_mul_i32 s55, s65, 3072
    s_add_u32 s55, s55, s54
    v_add_u32 v122, s55, v4
    buffer_load_dwordx4 a[12:15], v4, s[32:35], s78 offen offset:3072
    v_mul_u32_u24 v123, 2560, v3
    v_lshl_add_u32 v123, v2, 2, v123
    s_lshl1_add_u32 s67, s39, s40
    s_lshl2_add_u32 s67, s67, s36
    s_lshl_b32 s67, s67, 6
    s_add_u32 s67, s67, 19922944
    s_mul_i32 s85, s36, 552960
    s_mul_i32 s55, s38, 224
    s_add_u32 s85, s85, s55
    v_mov_b32 v198, 0x3f803f80
    v_lshrrev_b32 v211, 3, v1
    v_mul_u32_u24 v211, 98240, v211
    buffer_load_dwordx4 a[28:31], v4, s[32:35], s79 offen offset:3072
    v_lshl_add_u32 v211, v1, 3, v211
    v_mul_u32_u24 v49, 80, v2
    v_lshl_add_u32 v50, v3, 8, s86
    s_movk_i32 s54, 768
    v_add_u32 v51, 0, v49
    v_lshrrev_b32 v53, 8, v51
    v_mad_u32_u24 v53, v53, s54, v51
    v_add_u32 v48, v53, v50
    v_add_u32 v51, 16, v49
    v_lshrrev_b32 v53, 8, v51
    v_mad_u32_u24 v53, v53, s54, v51
    v_add_u32 v52, v53, v50
    buffer_load_dwordx4 v[88:91], v112, s[32:35], s71 offen offset:0
    buffer_load_dwordx4 v[92:95], v112, s[32:35], s71 offen offset:256
    buffer_load_dwordx4 v[96:99], v112, s[32:35], s71 offen offset:512
    buffer_load_dwordx4 v[100:103], v112, s[32:35], s71 offen offset:768
    v_add_u32 v51, 32, v49
    v_lshrrev_b32 v53, 8, v51
    v_mad_u32_u24 v53, v53, s54, v51
    v_add_u32 v56, v53, v50
    v_add_u32 v51, 48, v49
    v_lshrrev_b32 v53, 8, v51
    v_mad_u32_u24 v53, v53, s54, v51
    v_add_u32 v60, v53, v50
    v_add_u32 v51, 64, v49
    v_lshrrev_b32 v53, 8, v51
    v_mad_u32_u24 v53, v53, s54, v51
    v_add_u32 v64, v53, v50
    buffer_load_ushort v252, v216, s[8:11], s68 offen
    s_nop 1
    s_cmp_ge_u32 s42, 20
    s_cbranch_scc1 L_nop2
    s_sub_u32 s53, 16, s41
    s_cmp_eq_u32 s41, 0
    s_cselect_b32 s53, 8, s53
    s_cmp_lt_u32 s42, 10
    s_cselect_b32 s43, s41, s53
    s_cselect_b32 s54, 0, 10
    s_mul_i32 s43, s43, 10
    s_add_u32 s43, s43, s42
    s_sub_u32 s43, s43, s54
    buffer_load_ushort v253, v216, s[12:15], s68 offen
    buffer_load_dword v249, v218, s[20:23], s69 offen
    v_cmp_gt_u32 vcc, 8, v2
    s_waitcnt vmcnt(16)
    ds_read_b128 v[48:51], v48
    ds_read_b128 v[52:55], v52
    ds_read_b128 v[56:59], v56
    ds_read_b128 v[60:63], v60
    ds_read_b128 v[64:67], v64
    s_waitcnt lgkmcnt(4)
    v_bfi_b32 v68, s48, v48, v50
    s_waitcnt lgkmcnt(3)
    v_bfi_b32 v69, s48, v53, v55
    s_waitcnt lgkmcnt(1)
    v_bfi_b32 v70, s48, v58, v60
    s_waitcnt lgkmcnt(0)
    v_bfi_b32 v71, s48, v63, v65
    ds_write_b128 v114, v[68:71] offset:0
    v_dot2_f32_bf16 v196, v48, v198, 0
    v_dot2_f32_bf16 v197, v48, v48, 0
    v_dot2_f32_bf16 v196, v49, v198, v196
    v_dot2_f32_bf16 v197, v49, v49, v197
    v_dot2_f32_bf16 v196, v50, v198, v196
    v_dot2_f32_bf16 v197, v50, v50, v197
    v_dot2_f32_bf16 v196, v51, v198, v196
    v_dot2_f32_bf16 v197, v51, v51, v197
    v_alignbit_b32 v72, v51, v48, 16
    s_mov_b32 s88, 36864
    buffer_load_dwordx4 v[20:23], v4, s[32:35], s88 offen
    buffer_load_dwordx3 v[24:26], v4, s[32:35], s88 offen offset:1024
    v_alignbit_b32 v73, v56, v53, 16
    v_alignbit_b32 v74, v61, v58, 16
    v_alignbit_b32 v75, v66, v63, 16
    ds_write_b128 v115, v[72:75] offset:4096
    v_dot2_f32_bf16 v196, v52, v198, v196
    v_dot2_f32_bf16 v197, v52, v52, v197
    v_dot2_f32_bf16 v196, v53, v198, v196
    v_dot2_f32_bf16 v197, v53, v53, v197
    v_dot2_f32_bf16 v196, v54, v198, v196
    v_dot2_f32_bf16 v197, v54, v54, v197
    v_dot2_f32_bf16 v196, v55, v198, v196
    v_dot2_f32_bf16 v197, v55, v55, v197
    v_bfi_b32 v76, s48, v49, v51
    v_bfi_b32 v77, s48, v54, v56
    v_bfi_b32 v78, s48, v59, v61
    v_bfi_b32 v79, s48, v64, v66
    ds_write_b128 v114, v[76:79] offset:8192
    v_dot2_f32_bf16 v196, v56, v198, v196
    v_dot2_f32_bf16 v197, v56, v56, v197
    v_dot2_f32_bf16 v196, v57, v198, v196
    v_dot2_f32_bf16 v197, v57, v57, v197
    v_dot2_f32_bf16 v196, v58, v198, v196
    v_dot2_f32_bf16 v197, v58, v58, v197
    v_dot2_f32_bf16 v196, v59, v198, v196
    v_dot2_f32_bf16 v197, v59, v59, v197
    v_alignbit_b32 v80, v52, v49, 16
    v_alignbit_b32 v81, v57, v54, 16
    v_alignbit_b32 v82, v62, v59, 16
    s_lshr_b32 s94, s36, 1
    s_lshl4_add_u32 s94, s94, s38
    s_and_b32 s95, s36, 1
    s_lshl1_add_u32 s94, s94, s95
    s_lshl_b32 s94, s94, 9
    s_lshl_b32 s95, s37, 15
    s_add_u32 s94, s94, s95
    s_add_u32 s94, s94, 21102592
    v_lshrrev_b32 v251, 1, v4
    buffer_store_dwordx2 v[244:245], v251, s[28:31], s94 offen sc1
    v_alignbit_b32 v83, v67, v64, 16
    ds_write_b128 v115, v[80:83] offset:12288
    v_dot2_f32_bf16 v196, v60, v198, v196
    v_dot2_f32_bf16 v197, v60, v60, v197
    v_dot2_f32_bf16 v196, v61, v198, v196
    v_dot2_f32_bf16 v197, v61, v61, v197
    v_dot2_f32_bf16 v196, v62, v198, v196
    v_dot2_f32_bf16 v197, v62, v62, v197
    v_dot2_f32_bf16 v196, v63, v198, v196
    v_dot2_f32_bf16 v197, v63, v63, v197
    v_bfi_b32 v84, s48, v50, v52
    v_bfi_b32 v85, s48, v55, v57
    v_bfi_b32 v86, s48, v60, v62
    v_bfi_b32 v87, s48, v65, v67
    s_add_u32 s94, s101, 30720
    s_lshl_b32 s95, s36, 26
    s_add_u32 s94, s94, s95
    v_lshrrev_b32 v251, 1, v4
    buffer_store_dwordx2 v[244:245], v251, s[28:31], s94 offen sc1
    ds_write_b128 v114, v[84:87] offset:16384
    v_dot2_f32_bf16 v196, v64, v198, v196
    v_dot2_f32_bf16 v197, v64, v64, v197
    v_dot2_f32_bf16 v196, v65, v198, v196
    v_dot2_f32_bf16 v197, v65, v65, v197
    v_dot2_f32_bf16 v196, v66, v198, v196
    v_dot2_f32_bf16 v197, v66, v66, v197
    v_dot2_f32_bf16 v196, v67, v198, v196
    v_dot2_f32_bf16 v197, v67, v67, v197
    s_waitcnt vmcnt(19)
    v_readfirstlane_b32 s62, v5
    s_waitcnt lgkmcnt(0)
    s_barrier
    ds_read_b128 v[124:127], v116 offset:0
    ds_read_b128 v[128:131], v116 offset:8192
    ds_read_b128 v[132:135], v116 offset:16384
    ds_read_b128 v[136:139], v117 offset:1024
    ds_read_b128 v[140:143], v117 offset:9216
    ds_read_b128 v[144:147], v117 offset:17408
    ds_read_b128 v[148:151], v116 offset:2048
    ds_read_b128 v[152:155], v116 offset:10240
    ds_read_b128 v[156:159], v116 offset:18432
    ds_read_b128 v[160:163], v117 offset:3072
    ds_read_b128 v[164:167], v117 offset:11264
    ds_read_b128 v[168:171], v117 offset:19456
    s_mul_i32 s62, s62, 0x9E3779B1
    s_add_u32 s62, s62, 0x7F4A7C16
    s_and_b32 s62, s62, -2
    v_mov_b32 v5, s62
    v_mov_b32 v220, s62
    v_mov_b32 v221, s62
    s_waitcnt vmcnt(18) lgkmcnt(11)
    v_mfma_f32_16x16x32_bf16 v[172:175], v[124:127], a[0:3], 0
    v_add_f32_dpp v196, v196, v196 row_ror:8 row_mask:0xf bank_mask:0xf
    v_add_f32_dpp v197, v197, v197 row_ror:8 row_mask:0xf bank_mask:0xf
    s_waitcnt vmcnt(17)
    v_mfma_f32_16x16x32_bf16 v[176:179], v[124:127], a[16:19], 0
    v_add_f32_dpp v196, v196, v196 row_ror:4 row_mask:0xf bank_mask:0xf
    v_add_f32_dpp v197, v197, v197 row_ror:4 row_mask:0xf bank_mask:0xf
    s_waitcnt lgkmcnt(10)
    v_mfma_f32_16x16x32_bf16 v[180:183], v[128:131], a[0:3], 0
    v_add_f32_dpp v196, v196, v196 row_ror:2 row_mask:0xf bank_mask:0xf
    v_add_f32_dpp v197, v197, v197 row_ror:2 row_mask:0xf bank_mask:0xf
    v_mfma_f32_16x16x32_bf16 v[184:187], v[128:131], a[16:19], 0
    v_add_f32_dpp v196, v196, v196 row_ror:1 row_mask:0xf bank_mask:0xf
    v_add_f32_dpp v197, v197, v197 row_ror:1 row_mask:0xf bank_mask:0xf
    s_waitcnt lgkmcnt(9)
    v_mfma_f32_16x16x32_bf16 v[188:191], v[132:135], a[0:3], 0
    v_mul_f32 v196, 0x3acccccd, v196
    v_mul_f32 v197, 0x3acccccd, v197
    v_mfma_f32_16x16x32_bf16 v[192:195], v[132:135], a[16:19], 0
    v_fma_f32 v197, -v196, v196, v197
    v_max_f32 v197, 0, v197
    s_waitcnt vmcnt(16) lgkmcnt(8)
    v_mfma_f32_16x16x32_bf16 v[172:175], v[136:139], a[4:7], v[172:175]
    v_cvt_pk_bf16_f32 v197, v197, v197
    v_lshlrev_b32 v197, 16, v197
    s_waitcnt vmcnt(15)
    v_mfma_f32_16x16x32_bf16 v[176:179], v[136:139], a[20:23], v[176:179]
    v_add_f32 v197, 0x3727c5ac, v197
    v_cvt_pk_bf16_f32 v197, v197, v197
    s_waitcnt lgkmcnt(7)
    v_mfma_f32_16x16x32_bf16 v[180:183], v[140:143], a[4:7], v[180:183]
    v_lshlrev_b32 v197, 16, v197
    v_sqrt_f32 v197, v197
    v_mfma_f32_16x16x32_bf16 v[184:187], v[140:143], a[20:23], v[184:187]
    v_cvt_pk_bf16_f32 v197, v197, v197
    v_lshlrev_b32 v197, 16, v197
    s_waitcnt lgkmcnt(6)
    v_mfma_f32_16x16x32_bf16 v[188:191], v[144:147], a[4:7], v[188:191]
    v_rcp_f32 v197, v197
    s_nop 0
    v_mul_f32 v197, 0x3c21e89b, v197
    v_mfma_f32_16x16x32_bf16 v[192:195], v[144:147], a[20:23], v[192:195]
    ds_write_b32 v118, v197
    ds_write_b32 v118, v196 offset:64
    s_waitcnt vmcnt(14) lgkmcnt(7)
    v_mfma_f32_16x16x32_bf16 v[172:175], v[148:151], a[8:11], v[172:175]
    ds_read_b128 v[8:11], v120 offset:0
    ds_read_b128 v[12:15], v120 offset:8192
    s_waitcnt vmcnt(13)
    v_mfma_f32_16x16x32_bf16 v[176:179], v[148:151], a[24:27], v[176:179]
    ds_read_b128 v[16:19], v120 offset:16384
    s_add_u32 s87, s63, 38912
    buffer_load_dwordx4 a[96:99], v4, s[32:35], s87 offen offset:0
    s_waitcnt lgkmcnt(9)
    v_mfma_f32_16x16x32_bf16 v[180:183], v[152:155], a[8:11], v[180:183]
    v_mfma_f32_16x16x32_bf16 v[184:187], v[152:155], a[24:27], v[184:187]
    s_waitcnt lgkmcnt(8)
    v_mfma_f32_16x16x32_bf16 v[188:191], v[156:159], a[8:11], v[188:191]
    v_mfma_f32_16x16x32_bf16 v[192:195], v[156:159], a[24:27], v[192:195]
    s_waitcnt vmcnt(13) lgkmcnt(7)
    v_mfma_f32_16x16x32_bf16 v[172:175], v[160:163], a[12:15], v[172:175]
    s_waitcnt vmcnt(12)
    v_mfma_f32_16x16x32_bf16 v[176:179], v[160:163], a[28:31], v[176:179]
    s_waitcnt lgkmcnt(6)
    v_mfma_f32_16x16x32_bf16 v[180:183], v[164:167], a[12:15], v[180:183]
    v_mfma_f32_16x16x32_bf16 v[184:187], v[164:167], a[28:31], v[184:187]
    s_waitcnt lgkmcnt(5)
    v_mfma_f32_16x16x32_bf16 v[188:191], v[168:171], a[12:15], v[188:191]
    v_mfma_f32_16x16x32_bf16 v[192:195], v[168:171], a[28:31], v[192:195]
    s_waitcnt lgkmcnt(0)
    s_barrier
    ds_read_b64 v[112:113], v119
    ds_read_b32 v27, v27
    v_cndmask_b32 v16, 0, v16, vcc
    buffer_load_dwordx4 a[100:103], v4, s[32:35], s87 offen offset:1024
    v_cndmask_b32 v17, 0, v17, vcc
    v_cndmask_b32 v18, 0, v18, vcc
    v_cndmask_b32 v19, 0, v19, vcc
    s_waitcnt vmcnt(12)
    v_pk_mul_f32 v[48:49], v[174:175], v[88:89] op_sel:[0,0] op_sel_hi:[1,0]
    s_waitcnt vmcnt(10)
    v_pk_mul_f32 v[56:57], v[178:179], v[96:97] op_sel:[0,0] op_sel_hi:[1,0]
    v_pk_fma_f32 v[48:49], v[178:179], v[92:93], v[48:49] op_sel:[0,0,0] op_sel_hi:[1,0,1]
    v_pk_fma_f32 v[56:57], v[174:175], v[92:93], v[56:57] op_sel:[0,0,0] op_sel_hi:[1,0,1] neg_lo:[0,1,0] neg_hi:[0,1,0]
    v_pk_mul_f32 v[50:51], v[180:181], v[88:89] op_sel:[0,1] op_sel_hi:[1,1]
    v_pk_mul_f32 v[58:59], v[184:185], v[96:97] op_sel:[0,1] op_sel_hi:[1,1]
    v_pk_fma_f32 v[50:51], v[184:185], v[92:93], v[50:51] op_sel:[0,1,0] op_sel_hi:[1,1,1]
    v_pk_fma_f32 v[58:59], v[180:181], v[92:93], v[58:59] op_sel:[0,1,0] op_sel_hi:[1,1,1] neg_lo:[0,1,0] neg_hi:[0,1,0]
    v_pk_mul_f32 v[52:53], v[182:183], v[90:91] op_sel:[0,0] op_sel_hi:[1,0]
    v_pk_mul_f32 v[60:61], v[186:187], v[98:99] op_sel:[0,0] op_sel_hi:[1,0]
    v_pk_fma_f32 v[52:53], v[186:187], v[94:95], v[52:53] op_sel:[0,0,0] op_sel_hi:[1,0,1]
    buffer_load_dwordx4 a[104:107], v4, s[32:35], s87 offen offset:2048
    v_pk_fma_f32 v[60:61], v[182:183], v[94:95], v[60:61] op_sel:[0,0,0] op_sel_hi:[1,0,1] neg_lo:[0,1,0] neg_hi:[0,1,0]
    v_pk_mul_f32 v[54:55], v[188:189], v[90:91] op_sel:[0,1] op_sel_hi:[1,1]
    v_pk_mul_f32 v[62:63], v[192:193], v[98:99] op_sel:[0,1] op_sel_hi:[1,1]
    v_pk_fma_f32 v[54:55], v[192:193], v[94:95], v[54:55] op_sel:[0,1,0] op_sel_hi:[1,1,1]
    v_pk_fma_f32 v[62:63], v[188:189], v[94:95], v[62:63] op_sel:[0,1,0] op_sel_hi:[1,1,1] neg_lo:[0,1,0] neg_hi:[0,1,0]
    v_pk_add_f32 v[64:65], v[48:49], v[54:55]
    v_pk_add_f32 v[66:67], v[50:51], v[52:53]
    v_pk_add_f32 v[68:69], v[48:49], v[54:55] neg_lo:[0,1] neg_hi:[0,1]
    v_pk_add_f32 v[70:71], v[50:51], v[52:53] neg_lo:[0,1] neg_hi:[0,1]
    v_pk_add_f32 v[72:73], v[172:173], v[64:65]
    v_pk_fma_f32 v[74:75], v[64:65], s[44:45], v[172:173] op_sel:[0,0,0] op_sel_hi:[1,0,1]
    v_pk_fma_f32 v[76:77], v[64:65], s[44:45], v[172:173] op_sel:[0,1,0] op_sel_hi:[1,1,1]
    v_pk_mul_f32 v[78:79], v[68:69], s[46:47] op_sel:[0,0] op_sel_hi:[1,0]
    v_pk_mul_f32 v[80:81], v[68:69], s[46:47] op_sel:[0,1] op_sel_hi:[1,1]
    buffer_load_dwordx4 a[108:111], v4, s[32:35], s87 offen offset:3072
    v_pk_add_f32 v[72:73], v[72:73], v[66:67]
    v_pk_fma_f32 v[74:75], v[66:67], s[44:45], v[74:75] op_sel:[0,1,0] op_sel_hi:[1,1,1]
    v_pk_fma_f32 v[76:77], v[66:67], s[44:45], v[76:77] op_sel:[0,0,0] op_sel_hi:[1,0,1]
    v_pk_fma_f32 v[78:79], v[70:71], s[46:47], v[78:79] op_sel:[0,1,0] op_sel_hi:[1,1,1]
    v_pk_fma_f32 v[80:81], v[70:71], s[46:47], v[80:81] op_sel:[0,0,0] op_sel_hi:[1,0,1] neg_lo:[0,1,0] neg_hi:[0,1,0]
    v_pk_add_f32 v[82:83], v[56:57], v[62:63]
    v_pk_add_f32 v[84:85], v[58:59], v[60:61]
    v_pk_add_f32 v[86:87], v[56:57], v[62:63] neg_lo:[0,1] neg_hi:[0,1]
    v_pk_add_f32 v[124:125], v[58:59], v[60:61] neg_lo:[0,1] neg_hi:[0,1]
    v_pk_add_f32 v[126:127], v[176:177], v[82:83]
    v_pk_fma_f32 v[128:129], v[82:83], s[44:45], v[176:177] op_sel:[0,0,0] op_sel_hi:[1,0,1]
    v_pk_fma_f32 v[130:131], v[82:83], s[44:45], v[176:177] op_sel:[0,1,0] op_sel_hi:[1,1,1]
    v_pk_mul_f32 v[132:133], v[86:87], s[46:47] op_sel:[0,0] op_sel_hi:[1,0]
    v_pk_mul_f32 v[134:135], v[86:87], s[46:47] op_sel:[0,1] op_sel_hi:[1,1]
    s_add_u32 s87, s63, 43008
    buffer_load_dwordx4 a[112:115], v4, s[32:35], s87 offen offset:0
    v_pk_add_f32 v[126:127], v[126:127], v[84:85]
    v_pk_fma_f32 v[128:129], v[84:85], s[44:45], v[128:129] op_sel:[0,1,0] op_sel_hi:[1,1,1]
    v_pk_fma_f32 v[130:131], v[84:85], s[44:45], v[130:131] op_sel:[0,0,0] op_sel_hi:[1,0,1]
    v_pk_fma_f32 v[132:133], v[124:125], s[46:47], v[132:133] op_sel:[0,1,0] op_sel_hi:[1,1,1]
    v_pk_fma_f32 v[134:135], v[124:125], s[46:47], v[134:135] op_sel:[0,0,0] op_sel_hi:[1,0,1] neg_lo:[0,1,0] neg_hi:[0,1,0]
    s_waitcnt vmcnt(12)
    v_pk_mul_f32 v[136:137], v[72:73], v[100:101] op_sel:[0,0] op_sel_hi:[1,0]
    s_waitcnt lgkmcnt(1)
    v_pk_mul_f32 v[136:137], v[136:137], v[112:113]
    v_pk_mul_f32 v[126:127], v[126:127], v[112:113]
    v_cvt_pk_f16_f32 v196, v136, v126
    v_cvt_pk_f16_f32 v197, v137, v127
    ds_write_b64 v121, v[196:197] offset:0
    v_pk_fma_f32 v[138:139], v[132:133], v[100:101], v[74:75] op_sel:[0,0,0] op_sel_hi:[1,0,1]
    v_pk_fma_f32 v[146:147], v[128:129], v[100:101], v[78:79] op_sel:[0,0,0] op_sel_hi:[1,0,1] neg_lo:[0,0,1] neg_hi:[0,0,1]
    v_pk_mul_f32 v[138:139], v[138:139], v[112:113]
    buffer_load_dwordx4 a[116:119], v4, s[32:35], s87 offen offset:1024
    v_pk_mul_f32 v[146:147], v[146:147], v[112:113]
    v_cvt_pk_f16_f32 v198, v138, v146
    v_cvt_pk_f16_f32 v199, v139, v147
    ds_write_b64 v121, v[198:199] offset:1024
    v_pk_fma_f32 v[140:141], v[134:135], v[100:101], v[76:77] op_sel:[0,0,0] op_sel_hi:[1,0,1]
    v_pk_fma_f32 v[148:149], v[130:131], v[100:101], v[80:81] op_sel:[0,0,0] op_sel_hi:[1,0,1] neg_lo:[0,0,1] neg_hi:[0,0,1]
    v_pk_mul_f32 v[140:141], v[140:141], v[112:113]
    v_pk_mul_f32 v[148:149], v[148:149], v[112:113]
    v_cvt_pk_f16_f32 v200, v140, v148
    v_cvt_pk_f16_f32 v201, v141, v149
    ds_write_b64 v121, v[200:201] offset:2048
    v_pk_fma_f32 v[142:143], v[76:77], v[100:101], v[134:135] op_sel:[0,0,0] op_sel_hi:[1,0,1] neg_lo:[0,0,1] neg_hi:[0,0,1]
    v_pk_fma_f32 v[150:151], v[80:81], v[100:101], v[130:131] op_sel:[0,0,0] op_sel_hi:[1,0,1]
    v_pk_mul_f32 v[142:143], v[142:143], v[112:113]
    buffer_load_dwordx4 a[120:123], v4, s[32:35], s87 offen offset:2048
    v_pk_mul_f32 v[150:151], v[150:151], v[112:113]
    v_cvt_pk_f16_f32 v202, v142, v150
    v_cvt_pk_f16_f32 v203, v143, v151
    ds_write_b64 v121, v[202:203] offset:3072
    v_pk_fma_f32 v[144:145], v[74:75], v[100:101], v[132:133] op_sel:[0,0,0] op_sel_hi:[1,0,1] neg_lo:[0,0,1] neg_hi:[0,0,1]
    v_pk_fma_f32 v[152:153], v[78:79], v[100:101], v[128:129] op_sel:[0,0,0] op_sel_hi:[1,0,1]
    v_pk_mul_f32 v[144:145], v[144:145], v[112:113]
    v_pk_mul_f32 v[152:153], v[152:153], v[112:113]
    v_cvt_pk_f16_f32 v204, v144, v152
    v_cvt_pk_f16_f32 v205, v145, v153
    ds_write_b64 v121, v[204:205] offset:4096
    s_waitcnt lgkmcnt(0)
    s_barrier
    ds_read_b128 v[48:51], v122 offset:0
    ds_read_b128 v[52:55], v122 offset:1024
    buffer_load_dwordx4 a[124:127], v4, s[32:35], s87 offen offset:3072
    ds_read_b128 v[56:59], v122 offset:2048
    s_waitcnt lgkmcnt(2)
    v_mfma_f32_16x16x32_f16 v[60:63], v[104:107], v[48:51], 0
    v_mfma_f32_16x16x32_f16 v[64:67], v[108:111], v[48:51], 0
    s_waitcnt lgkmcnt(1)
    v_mfma_f32_16x16x32_f16 v[68:71], v[104:107], v[52:55], 0
    v_mfma_f32_16x16x32_f16 v[72:75], v[108:111], v[52:55], 0
    s_waitcnt lgkmcnt(0)
    v_mfma_f32_16x16x32_f16 v[76:79], v[104:107], v[56:59], 0
    v_mfma_f32_16x16x32_f16 v[80:83], v[108:111], v[56:59], 0
    s_nop 1
    v_cvt_pk_f16_f32 v124, v60, v64
    v_and_b32 v124, -2, v124
    buffer_store_dword v124, v123, s[28:31], s66 offen offset:0 sc1
    v_cvt_pk_f16_f32 v125, v61, v65
    v_and_b32 v125, -2, v125
    buffer_store_dword v125, v123, s[28:31], s66 offen offset:640 sc1
    v_cvt_pk_f16_f32 v126, v62, v66
    v_and_b32 v126, -2, v126
    buffer_store_dword v126, v123, s[28:31], s66 offen offset:1280 sc1
    v_cvt_pk_f16_f32 v127, v63, v67
    v_and_b32 v127, -2, v127
    buffer_store_dword v127, v123, s[28:31], s66 offen offset:1920 sc1
    v_cvt_pk_f16_f32 v128, v68, v72
    v_and_b32 v128, -2, v128
    buffer_store_dword v128, v123, s[28:31], s66 offen offset:128 sc1
    v_cvt_pk_f16_f32 v129, v69, v73
    v_and_b32 v129, -2, v129
    buffer_store_dword v129, v123, s[28:31], s66 offen offset:768 sc1
    v_cvt_pk_f16_f32 v130, v70, v74
    v_and_b32 v130, -2, v130
    buffer_store_dword v130, v123, s[28:31], s66 offen offset:1408 sc1
    v_cvt_pk_f16_f32 v131, v71, v75
    v_and_b32 v131, -2, v131
    buffer_store_dword v131, v123, s[28:31], s66 offen offset:2048 sc1
    s_nop 1
    s_cmp_eq_u32 s65, 1
    s_cbranch_scc1 Lp1_1
    v_cvt_pk_f16_f32 v132, v76, v80
    v_and_b32 v132, -2, v132
    buffer_store_dword v132, v123, s[28:31], s66 offen offset:256 sc1
    v_cvt_pk_f16_f32 v133, v77, v81
    v_and_b32 v133, -2, v133
    buffer_store_dword v133, v123, s[28:31], s66 offen offset:896 sc1
    v_cvt_pk_f16_f32 v134, v78, v82
    v_and_b32 v134, -2, v134
    buffer_store_dword v134, v123, s[28:31], s66 offen offset:1536 sc1
    v_cvt_pk_f16_f32 v135, v79, v83
    v_and_b32 v135, -2, v135
    buffer_store_dword v135, v123, s[28:31], s66 offen offset:2176 sc1
    s_nop 1
Lp1_1:
    s_waitcnt vmcnt(0)
    buffer_store_dwordx2 v[220:221], v211, s[28:31], s67 offen sc1
    s_lshl_b32 s87, s36, 10
    s_add_u32 s87, s87, 32768
    v_lshlrev_b32 v251, 4, v2
    buffer_load_dwordx4 v[28:31], v251, s[32:35], s87 offen offset:0
    buffer_load_dwordx4 v[32:35], v251, s[32:35], s87 offen offset:256
    buffer_load_dwordx4 v[36:39], v251, s[32:35], s87 offen offset:512
    buffer_load_dwordx4 v[40:43], v251, s[32:35], s87 offen offset:768
    buffer_load_dword v250, v219, s[16:19], s81 offen
    s_mul_i32 s50, s43, 6554
    s_lshr_b32 s50, s50, 16
    s_mul_i32 s51, s50, 10
    s_sub_u32 s51, s43, s51
    s_lshr_b32 s52, s51, 1
    s_and_b32 s53, s51, 1
    s_lshl_b32 s54, s52, 7
    s_lshl_b32 s55, s53, 5
    s_add_u32 s54, s54, s55
    s_sub_u32 s55, 609, s54
    s_cmp_lt_u32 s52, 3
    s_cselect_b32 s54, s54, s55
    s_cselect_b32 s55, 1, -1
    s_lshl_b32 s54, s54, 1
    s_lshl_b32 s56, s52, 2
    s_lshr_b32 s56, 0x31425, s56
    s_and_b32 s56, s56, 15
    s_lshl_b32 s56, s56, 7
    s_mul_i32 s57, s50, s55
    s_lshl_b32 s57, s57, 1
    s_add_u32 s57, s57, s54
    s_and_b32 s89, s57, 15
    s_sub_u32 s54, s54, s89
    s_and_b32 s57, s55, 0x100
    s_or_b32 s89, s89, s57
    s_lshl_b32 s57, s50, 1
    s_and_b32 s57, s57, 15
    s_sub_u32 s56, s56, s57
    s_lshl_b32 s57, s57, 16
    s_or_b32 s89, s89, s57
    s_xor_b32 s57, s53, 1
    s_lshl_b32 s57, s57, 24
    s_or_b32 s89, s89, s57
    s_lshl_b32 s53, s53, 30
    s_add_u32 s56, s56, s53
    s_lshl_b32 s57, s36, 7
    s_add_u32 s50, s50, s57
    s_movk_i32 s51, 10923
    s_movk_i32 s52, 642
    v_mov_b32 v204, s55
    v_mov_b32 v205, s56
    v_add_u32 v200, 0, v1
    v_mul_u32_u24 v201, s51, v200
    v_lshrrev_b32 v201, 16, v201
    v_mul_u32_u24 v202, 6, v201
    v_sub_u32 v200, v200, v202
    v_lshrrev_b32 v202, 3, v201
    v_mul_u32_u24 v202, 24, v202
    v_add_u32 v201, v201, v202
    v_lshl_add_u32 v201, v201, 4, s50
    v_cmp_eq_u32 vcc, 5, v200
    v_lshl_add_u32 v200, v200, 4, s54
    s_nop 0
    v_cndmask_b32 v202, v204, 1, vcc
    v_cndmask_b32 v200, v200, v205, vcc
    v_mul_i32_i24 v201, v201, v202
    v_and_b32 v201, 0x7ff, v201
    v_mad_u32_u24 v206, v201, s52, v200
    v_add_u32 v200, 64, v1
    v_mul_u32_u24 v201, s51, v200
    v_lshrrev_b32 v201, 16, v201
    v_mul_u32_u24 v202, 6, v201
    v_sub_u32 v200, v200, v202
    v_lshrrev_b32 v202, 3, v201
    v_mul_u32_u24 v202, 24, v202
    v_add_u32 v201, v201, v202
    v_lshl_add_u32 v201, v201, 4, s50
    v_cmp_eq_u32 vcc, 5, v200
    v_lshl_add_u32 v200, v200, 4, s54
    s_nop 0
    v_cndmask_b32 v202, v204, 1, vcc
    v_cndmask_b32 v200, v200, v205, vcc
    v_mul_i32_i24 v201, v201, v202
    v_and_b32 v201, 0x7ff, v201
    v_mad_u32_u24 v207, v201, s52, v200
    v_add_u32 v200, 128, v1
    v_mul_u32_u24 v201, s51, v200
    v_lshrrev_b32 v201, 16, v201
    v_mul_u32_u24 v202, 6, v201
    v_sub_u32 v200, v200, v202
    v_lshrrev_b32 v202, 3, v201
    v_mul_u32_u24 v202, 24, v202
    v_add_u32 v201, v201, v202
    v_lshl_add_u32 v201, v201, 4, s50
    v_cmp_eq_u32 vcc, 5, v200
    v_lshl_add_u32 v200, v200, 4, s54
    s_nop 0
    v_cndmask_b32 v202, v204, 1, vcc
    v_cndmask_b32 v200, v200, v205, vcc
    v_mul_i32_i24 v201, v201, v202
    v_and_b32 v201, 0x7ff, v201
    v_mad_u32_u24 v208, v201, s52, v200
    s_and_b32 s82, s43, 1
    s_lshl1_add_u32 s82, s36, s82
    s_lshl_b32 s82, s82, 8
    s_add_u32 s82, s82, 19922944
    s_lshr_b32 s50, 0xF03C0, s42
    s_and_b32 s50, s50, 1
    s_lshl_b32 s50, s50, 7
    s_add_u32 s82, s82, s50
    v_lshrrev_b32 v7, 1, v1
    v_lshlrev_b32 v254, 11, v7
    v_and_b32 v7, 1, v1
    v_lshl_add_u32 v254, v7, 6, v254
    s_mul_i32 s50, s41, 98304
    s_add_u32 s82, s82, s50
    v_lshrrev_b32 v56, 5, v1
    v_mul_u32_u24 v56, 1007616, v56
    v_and_b32 v57, 31, v1
    v_lshl_add_u32 v56, v57, 2, v56
    v_add_u32 v60, 0, v56
    s_mov_b32 s92, 0x05040302
    s_mov_b32 s93, 0x07060302
    s_lshr_b32 s52, s43, 1
    s_lshl_b32 s52, s52, 7
    s_and_b32 s53, s43, 1
    s_lshl1_add_u32 s53, s36, s53
    s_mul_i32 s53, s53, 31488
    s_add_u32 s64, s52, s53
    s_add_u32 s65, s64, 251904
    s_add_u32 s66, s64, 503808
    s_add_u32 s67, s64, 755712
    s_add_u32 s68, s64, 2015232
    s_add_u32 s69, s64, 2267136
    s_add_u32 s70, s64, 2519040
    s_add_u32 s71, s64, 2770944
    s_add_u32 s72, s64, 4030464
    s_add_u32 s73, s64, 4282368
    s_add_u32 s74, s64, 4534272
    s_add_u32 s75, s64, 4786176
    s_add_u32 s76, s64, 6045696
    s_add_u32 s77, s64, 6297600
    s_add_u32 s78, s64, 6549504
    s_add_u32 s79, s64, 6801408
    s_add_u32 m0, s86, 86016
    s_nop 0
    buffer_load_dwordx4 v206, s[8:11], 0 offen lds
    s_add_u32 m0, s86, 89088
    s_nop 0
    buffer_load_dwordx4 v206, s[12:15], 0 offen lds
    s_add_u32 m0, s86, 87040
    s_nop 0
    buffer_load_dwordx4 v207, s[8:11], 0 offen lds
    s_add_u32 m0, s86, 90112
    s_nop 0
    buffer_load_dwordx4 v207, s[12:15], 0 offen lds
    s_add_u32 m0, s86, 88064
    s_nop 0
    buffer_load_dwordx4 v208, s[8:11], 0 offen lds
    s_add_u32 m0, s86, 91136
    s_nop 0
    buffer_load_dwordx4 v208, s[12:15], 0 offen lds
    v_lshrrev_b32 v197, 2, v2
    v_and_b32 v198, 1, v2
    v_lshl_add_u32 v197, v197, 1, v198
    s_lshl_b32 s50, s40, 10
    s_add_u32 s50, s50, s39
    v_lshlrev_b32 v197, 7, v197
    v_add_u32 v197, s50, v197
    v_cvt_f32_u32 v197, v197
    v_mul_f32 v197, 0xba000000, v197
    v_bfe_u32 v198, v2, 1, 1
    v_cvt_f32_u32 v198, v198
    v_mul_f32 v198, 0x3e800000, v198
    v_lshlrev_b32 v199, 2, v3
    v_cvt_f32_u32 v199, v199
    v_add_f32 v200, 0x0, v199
    v_fma_f32 v200, v200, v197, v198
    v_cos_f32 v201, v200
    v_sin_f32 v202, v200
    v_mul_f32 v201, 0x3921e89b, v201
    v_mul_f32 v202, 0x3921e89b, v202
    v_cvt_pk_bf16_f32 v44, v201, v202
    v_add_f32 v200, 0x3f800000, v199
    v_fma_f32 v200, v200, v197, v198
    v_cos_f32 v201, v200
    v_sin_f32 v202, v200
    v_mul_f32 v201, 0x3921e89b, v201
    v_mul_f32 v202, 0x3921e89b, v202
    v_cvt_pk_bf16_f32 v45, v201, v202
    v_add_f32 v200, 0x40000000, v199
    v_fma_f32 v200, v200, v197, v198
    v_cos_f32 v201, v200
    v_sin_f32 v202, v200
    v_mul_f32 v201, 0x3921e89b, v201
    v_mul_f32 v202, 0x3921e89b, v202
    v_cvt_pk_bf16_f32 v46, v201, v202
    v_add_f32 v200, 0x40400000, v199
    v_fma_f32 v200, v200, v197, v198
    v_cos_f32 v201, v200
    v_sin_f32 v202, v200
    v_mul_f32 v201, 0x3921e89b, v201
    v_mul_f32 v202, 0x3921e89b, v202
    v_cvt_pk_bf16_f32 v47, v201, v202
    buffer_load_dword v248, v254, s[28:31], s82 offen sc1
    v_and_b32 v160, 31, v1
    v_lshrrev_b32 v161, 5, v1
    v_lshl_add_u32 v161, v161, 4, s36
    v_cvt_f32_u32 v160, v160
    v_cvt_f32_u32 v161, v161
    v_mul_f32 v160, 0x3c000000, v160
    v_mul_f32 v161, v160, v161
    v_fmamk_f32 v162, v160, 0x0, v161
    v_cos_f32 v163, v162
    v_sin_f32 v164, v162
    v_fmamk_f32 v165, v160, 0x40800000, v161
    v_cos_f32 v166, v165
    v_sin_f32 v167, v165
    v_cvt_pk_f16_f32 v162, v163, v164
    v_cvt_pk_f16_f32 v163, -v164, v163
    v_cvt_pk_f16_f32 v165, v166, v167
    v_cvt_pk_f16_f32 v166, -v167, v166
    v_accvgpr_write_b32 a32, v162
    v_accvgpr_write_b32 a48, v163
    v_accvgpr_write_b32 a33, v165
    v_accvgpr_write_b32 a49, v166
    v_fmamk_f32 v162, v160, 0x41000000, v161
    v_cos_f32 v163, v162
    v_sin_f32 v164, v162
    v_fmamk_f32 v165, v160, 0x41400000, v161
    v_cos_f32 v166, v165
    v_sin_f32 v167, v165
    v_cvt_pk_f16_f32 v162, v163, v164
    v_cvt_pk_f16_f32 v163, -v164, v163
    v_cvt_pk_f16_f32 v165, v166, v167
    v_cvt_pk_f16_f32 v166, -v167, v166
    v_accvgpr_write_b32 a34, v162
    v_accvgpr_write_b32 a50, v163
    v_accvgpr_write_b32 a35, v165
    v_accvgpr_write_b32 a51, v166
    v_fmamk_f32 v162, v160, 0x42000000, v161
    v_cos_f32 v163, v162
    v_sin_f32 v164, v162
    v_fmamk_f32 v165, v160, 0x42100000, v161
    v_cos_f32 v166, v165
    v_sin_f32 v167, v165
    v_cvt_pk_f16_f32 v162, v163, v164
    v_cvt_pk_f16_f32 v163, -v164, v163
    v_cvt_pk_f16_f32 v165, v166, v167
    v_cvt_pk_f16_f32 v166, -v167, v166
    v_accvgpr_write_b32 a36, v162
    v_accvgpr_write_b32 a52, v163
    v_accvgpr_write_b32 a37, v165
    v_accvgpr_write_b32 a53, v166
    v_fmamk_f32 v162, v160, 0x42200000, v161
    v_cos_f32 v163, v162
    v_sin_f32 v164, v162
    v_fmamk_f32 v165, v160, 0x42300000, v161
    v_cos_f32 v166, v165
    v_sin_f32 v167, v165
    v_cvt_pk_f16_f32 v162, v163, v164
    v_cvt_pk_f16_f32 v163, -v164, v163
    v_cvt_pk_f16_f32 v165, v166, v167
    v_cvt_pk_f16_f32 v166, -v167, v166
    v_accvgpr_write_b32 a38, v162
    v_accvgpr_write_b32 a54, v163
    v_accvgpr_write_b32 a39, v165
    v_accvgpr_write_b32 a55, v166
    v_fmamk_f32 v162, v160, 0x42800000, v161
    v_cos_f32 v163, v162
    v_sin_f32 v164, v162
    v_fmamk_f32 v165, v160, 0x42880000, v161
    v_cos_f32 v166, v165
    v_sin_f32 v167, v165
    v_cvt_pk_f16_f32 v162, v163, v164
    v_cvt_pk_f16_f32 v163, -v164, v163
    v_cvt_pk_f16_f32 v165, v166, v167
    v_cvt_pk_f16_f32 v166, -v167, v166
    v_accvgpr_write_b32 a40, v162
    v_accvgpr_write_b32 a56, v163
    v_accvgpr_write_b32 a41, v165
    v_accvgpr_write_b32 a57, v166
    v_fmamk_f32 v162, v160, 0x42900000, v161
    v_cos_f32 v163, v162
    v_sin_f32 v164, v162
    v_fmamk_f32 v165, v160, 0x42980000, v161
    v_cos_f32 v166, v165
    v_sin_f32 v167, v165
    v_cvt_pk_f16_f32 v162, v163, v164
    v_cvt_pk_f16_f32 v163, -v164, v163
    v_cvt_pk_f16_f32 v165, v166, v167
    v_cvt_pk_f16_f32 v166, -v167, v166
    v_accvgpr_write_b32 a42, v162
    v_accvgpr_write_b32 a58, v163
    v_accvgpr_write_b32 a43, v165
    v_accvgpr_write_b32 a59, v166
    v_fmamk_f32 v162, v160, 0x42c00000, v161
    v_cos_f32 v163, v162
    v_sin_f32 v164, v162
    v_fmamk_f32 v165, v160, 0x42c80000, v161
    v_cos_f32 v166, v165
    v_sin_f32 v167, v165
    v_cvt_pk_f16_f32 v162, v163, v164
    v_cvt_pk_f16_f32 v163, -v164, v163
    v_cvt_pk_f16_f32 v165, v166, v167
    v_cvt_pk_f16_f32 v166, -v167, v166
    v_accvgpr_write_b32 a44, v162
    v_accvgpr_write_b32 a60, v163
    v_accvgpr_write_b32 a45, v165
    v_accvgpr_write_b32 a61, v166
    v_fmamk_f32 v162, v160, 0x42d00000, v161
    v_cos_f32 v163, v162
    v_sin_f32 v164, v162
    v_fmamk_f32 v165, v160, 0x42d80000, v161
    v_cos_f32 v166, v165
    v_sin_f32 v167, v165
    v_cvt_pk_f16_f32 v162, v163, v164
    v_cvt_pk_f16_f32 v163, -v164, v163
    v_cvt_pk_f16_f32 v165, v166, v167
    v_cvt_pk_f16_f32 v166, -v167, v166
    v_accvgpr_write_b32 a46, v162
    v_accvgpr_write_b32 a62, v163
    v_accvgpr_write_b32 a47, v165
    v_accvgpr_write_b32 a63, v166
    v_and_b32 v160, 31, v1
    v_lshrrev_b32 v161, 5, v1
    v_lshl_add_u32 v160, v160, 2, s36
    v_lshlrev_b32 v161, 2, v161
    v_cvt_f32_u32 v160, v160
    v_cvt_f32_u32 v161, v161
    v_mul_f32 v160, 0x3c000000, v160
    v_mul_f32 v161, v160, v161
    v_fmamk_f32 v162, v160, 0x0, v161
    v_cos_f32 v163, v162
    v_sin_f32 v164, v162
    v_fmamk_f32 v165, v160, 0x3f800000, v161
    v_cos_f32 v166, v165
    v_sin_f32 v167, v165
    v_cvt_pk_bf16_f32 v162, v163, -v164
    v_cvt_pk_bf16_f32 v163, v164, v163
    v_cvt_pk_bf16_f32 v165, v166, -v167
    v_cvt_pk_bf16_f32 v166, v167, v166
    v_accvgpr_write_b32 a64, v162
    v_accvgpr_write_b32 a80, v163
    v_accvgpr_write_b32 a65, v165
    v_accvgpr_write_b32 a81, v166
    v_fmamk_f32 v162, v160, 0x40000000, v161
    v_cos_f32 v163, v162
    v_sin_f32 v164, v162
    v_fmamk_f32 v165, v160, 0x40400000, v161
    v_cos_f32 v166, v165
    v_sin_f32 v167, v165
    v_cvt_pk_bf16_f32 v162, v163, -v164
    v_cvt_pk_bf16_f32 v163, v164, v163
    v_cvt_pk_bf16_f32 v165, v166, -v167
    v_cvt_pk_bf16_f32 v166, v167, v166
    v_accvgpr_write_b32 a66, v162
    v_accvgpr_write_b32 a82, v163
    v_accvgpr_write_b32 a67, v165
    v_accvgpr_write_b32 a83, v166
    v_fmamk_f32 v162, v160, 0x41000000, v161
    v_cos_f32 v163, v162
    v_sin_f32 v164, v162
    v_fmamk_f32 v165, v160, 0x41100000, v161
    v_cos_f32 v166, v165
    v_sin_f32 v167, v165
    v_cvt_pk_bf16_f32 v162, v163, -v164
    v_cvt_pk_bf16_f32 v163, v164, v163
    v_cvt_pk_bf16_f32 v165, v166, -v167
    v_cvt_pk_bf16_f32 v166, v167, v166
    v_accvgpr_write_b32 a68, v162
    v_accvgpr_write_b32 a84, v163
    v_accvgpr_write_b32 a69, v165
    v_accvgpr_write_b32 a85, v166
    v_fmamk_f32 v162, v160, 0x41200000, v161
    v_cos_f32 v163, v162
    v_sin_f32 v164, v162
    v_fmamk_f32 v165, v160, 0x41300000, v161
    v_cos_f32 v166, v165
    v_sin_f32 v167, v165
    v_cvt_pk_bf16_f32 v162, v163, -v164
    v_cvt_pk_bf16_f32 v163, v164, v163
    v_cvt_pk_bf16_f32 v165, v166, -v167
    v_cvt_pk_bf16_f32 v166, v167, v166
    v_accvgpr_write_b32 a70, v162
    v_accvgpr_write_b32 a86, v163
    v_accvgpr_write_b32 a71, v165
    v_accvgpr_write_b32 a87, v166
    v_fmamk_f32 v162, v160, 0x41800000, v161
    v_cos_f32 v163, v162
    v_sin_f32 v164, v162
    v_fmamk_f32 v165, v160, 0x41880000, v161
    v_cos_f32 v166, v165
    v_sin_f32 v167, v165
    v_cvt_pk_bf16_f32 v162, v163, -v164
    v_cvt_pk_bf16_f32 v163, v164, v163
    v_cvt_pk_bf16_f32 v165, v166, -v167
    v_cvt_pk_bf16_f32 v166, v167, v166
    v_accvgpr_write_b32 a72, v162
    v_accvgpr_write_b32 a88, v163
    v_accvgpr_write_b32 a73, v165
    v_accvgpr_write_b32 a89, v166
    v_fmamk_f32 v162, v160, 0x41900000, v161
    v_cos_f32 v163, v162
    v_sin_f32 v164, v162
    v_fmamk_f32 v165, v160, 0x41980000, v161
    v_cos_f32 v166, v165
    v_sin_f32 v167, v165
    v_cvt_pk_bf16_f32 v162, v163, -v164
    v_cvt_pk_bf16_f32 v163, v164, v163
    v_cvt_pk_bf16_f32 v165, v166, -v167
    v_cvt_pk_bf16_f32 v166, v167, v166
    v_accvgpr_write_b32 a74, v162
    v_accvgpr_write_b32 a90, v163
    v_accvgpr_write_b32 a75, v165
    v_accvgpr_write_b32 a91, v166
    v_fmamk_f32 v162, v160, 0x41c00000, v161
    v_cos_f32 v163, v162
    v_sin_f32 v164, v162
    v_fmamk_f32 v165, v160, 0x41c80000, v161
    v_cos_f32 v166, v165
    v_sin_f32 v167, v165
    v_cvt_pk_bf16_f32 v162, v163, -v164
    v_cvt_pk_bf16_f32 v163, v164, v163
    v_cvt_pk_bf16_f32 v165, v166, -v167
    v_cvt_pk_bf16_f32 v166, v167, v166
    v_accvgpr_write_b32 a76, v162
    v_accvgpr_write_b32 a92, v163
    v_accvgpr_write_b32 a77, v165
    v_accvgpr_write_b32 a93, v166
    v_fmamk_f32 v162, v160, 0x41d00000, v161
    v_cos_f32 v163, v162
    v_sin_f32 v164, v162
    v_fmamk_f32 v165, v160, 0x41d80000, v161
    v_cos_f32 v166, v165
    v_sin_f32 v167, v165
    v_cvt_pk_bf16_f32 v162, v163, -v164
    v_cvt_pk_bf16_f32 v163, v164, v163
    v_cvt_pk_bf16_f32 v165, v166, -v167
    v_cvt_pk_bf16_f32 v166, v167, v166
    v_accvgpr_write_b32 a78, v162
    v_accvgpr_write_b32 a94, v163
    v_accvgpr_write_b32 a79, v165
    v_accvgpr_write_b32 a95, v166
    s_waitcnt vmcnt(0)
    v_cmp_ne_u32 vcc, s62, v248
    s_nop 0
    s_cbranch_vccz Lok_3
Lfix_2:
    s_add_i32 s49, s49, -1
    s_cmp_lt_i32 s49, 0
    s_cbranch_scc1 Lok_3
    buffer_load_dword v248, v254, s[28:31], s82 offen sc1
    s_waitcnt vmcnt(0)
    v_cmp_ne_u32 vcc, s62, v248
    s_nop 0
    s_cbranch_vccnz Lfix_2
Lok_3:
    buffer_load_dword v80, v56, s[28:31], s64 offen sc1
    buffer_load_dword v81, v56, s[28:31], s65 offen sc1
    buffer_load_dword v82, v56, s[28:31], s66 offen sc1
    buffer_load_dword v83, v56, s[28:31], s67 offen sc1
    buffer_load_dword v84, v56, s[28:31], s68 offen sc1
    buffer_load_dword v85, v56, s[28:31], s69 offen sc1
    buffer_load_dword v86, v56, s[28:31], s70 offen sc1
    buffer_load_dword v87, v56, s[28:31], s71 offen sc1
    buffer_load_dword v88, v56, s[28:31], s72 offen sc1
    buffer_load_dword v89, v56, s[28:31], s73 offen sc1
    buffer_load_dword v90, v56, s[28:31], s74 offen sc1
    buffer_load_dword v91, v56, s[28:31], s75 offen sc1
    buffer_load_dword v92, v56, s[28:31], s76 offen sc1
    buffer_load_dword v93, v56, s[28:31], s77 offen sc1
    buffer_load_dword v94, v56, s[28:31], s78 offen sc1
    buffer_load_dword v95, v56, s[28:31], s79 offen sc1
    s_add_u32 m0, s86, 0
    s_add_u32 s88, s85, 0
    buffer_load_dwordx4 v20, s[16:19], s88 offen offset:0 lds
    buffer_load_dwordx4 v21, s[16:19], s88 offen offset:1024 lds
    buffer_load_dwordx4 v22, s[16:19], s88 offen offset:2048 lds
    buffer_load_dwordx4 v23, s[16:19], s88 offen offset:3072 lds
    s_add_u32 m0, s86, 4096
    s_nop 0
    buffer_load_dwordx4 v24, s[16:19], s88 offen offset:0 lds
    buffer_load_dwordx4 v25, s[16:19], s88 offen offset:1024 lds
    buffer_load_dwordx4 v26, s[16:19], s88 offen offset:2048 lds
    s_lshl_b32 s53, s36, 13
    s_add_u32 s53, s53, 114688
    v_add_u32 v57, s53, v4
    s_lshl_b32 s53, s36, 10
    s_add_u32 s53, s53, 114688
    v_add_u32 v58, s53, v4
    s_lshl_b32 s53, s36, 12
    s_add_u32 s53, s53, 147456
    v_add_u32 v59, s53, v4
    s_and_b32 s50, s89, 15
    s_bfe_u32 s51, s89, 0x10008
    s_bfe_u32 s52, s89, 0x40010
    s_lshr_b32 s53, s89, 24
    v_and_b32 v48, 31, v1
    s_mul_i32 s54, s51, 31
    v_xor_b32 v49, s54, v48
    v_lshl_add_u32 v49, v49, 1, s50
    s_add_u32 s52, s52, 80
    v_mov_b32 v50, s52
    s_lshl_b32 s51, s51, 31
    v_mov_b32 v51, s51
    v_cmp_gt_u32 vcc, s53, v48
    s_nop 1
    v_cndmask_b32 v49, v49, v50, vcc
    v_cndmask_b32 v51, v51, 0, vcc
    s_mul_i32 s54, s36, 7168
    s_add_u32 s54, s54, 86016
    v_lshrrev_b32 v48, 5, v1
    v_mul_u32_u24 v48, 384, v48
    v_add3_u32 v49, v49, v48, s54
    ds_read_u16 v212, v49 offset:0
    ds_read_u16 v213, v49 offset:96
    ds_read_u16 v214, v49 offset:192
    ds_read_u16 v215, v49 offset:288
    ds_read_u16 v216, v49 offset:768
    ds_read_u16 v217, v49 offset:864
    ds_read_u16 v218, v49 offset:960
    ds_read_u16 v219, v49 offset:1056
    ds_read_u16 v220, v49 offset:1536
    ds_read_u16 v221, v49 offset:1632
    ds_read_u16 v222, v49 offset:1728
    ds_read_u16 v223, v49 offset:1824
    ds_read_u16 v224, v49 offset:2304
    ds_read_u16 v225, v49 offset:2400
    ds_read_u16 v226, v49 offset:2496
    ds_read_u16 v227, v49 offset:2592
    s_waitcnt lgkmcnt(15)
    v_lshlrev_b32 v212, 16, v212
    s_waitcnt lgkmcnt(14)
    v_lshlrev_b32 v213, 16, v213
    s_waitcnt lgkmcnt(13)
    v_lshlrev_b32 v214, 16, v214
    s_waitcnt lgkmcnt(12)
    v_lshlrev_b32 v215, 16, v215
    s_waitcnt lgkmcnt(11)
    v_lshlrev_b32 v216, 16, v216
    s_waitcnt lgkmcnt(10)
    v_lshlrev_b32 v217, 16, v217
    s_waitcnt lgkmcnt(9)
    v_lshlrev_b32 v218, 16, v218
    s_waitcnt lgkmcnt(8)
    v_lshlrev_b32 v219, 16, v219
    s_waitcnt lgkmcnt(7)
    v_lshlrev_b32 v220, 16, v220
    s_waitcnt lgkmcnt(6)
    v_lshlrev_b32 v221, 16, v221
    s_waitcnt lgkmcnt(5)
    v_lshlrev_b32 v222, 16, v222
    s_waitcnt lgkmcnt(4)
    v_lshlrev_b32 v223, 16, v223
    s_waitcnt lgkmcnt(3)
    v_lshlrev_b32 v224, 16, v224
    s_waitcnt lgkmcnt(2)
    v_lshlrev_b32 v225, 16, v225
    s_waitcnt lgkmcnt(1)
    v_lshlrev_b32 v226, 16, v226
    s_waitcnt lgkmcnt(0)
    v_lshlrev_b32 v227, 16, v227
    ds_read_u16 v228, v49 offset:3072
    ds_read_u16 v229, v49 offset:3168
    ds_read_u16 v230, v49 offset:3264
    ds_read_u16 v231, v49 offset:3360
    ds_read_u16 v232, v49 offset:3840
    ds_read_u16 v233, v49 offset:3936
    ds_read_u16 v234, v49 offset:4032
    ds_read_u16 v235, v49 offset:4128
    ds_read_u16 v236, v49 offset:4608
    ds_read_u16 v237, v49 offset:4704
    ds_read_u16 v238, v49 offset:4800
    ds_read_u16 v239, v49 offset:4896
    ds_read_u16 v240, v49 offset:5376
    ds_read_u16 v241, v49 offset:5472
    ds_read_u16 v242, v49 offset:5568
    ds_read_u16 v243, v49 offset:5664
    s_waitcnt lgkmcnt(15)
    v_lshl_add_u32 v228, v228, 16, v51
    s_waitcnt lgkmcnt(14)
    v_lshl_add_u32 v229, v229, 16, v51
    s_waitcnt lgkmcnt(13)
    v_lshl_add_u32 v230, v230, 16, v51
    s_waitcnt lgkmcnt(12)
    v_lshl_add_u32 v231, v231, 16, v51
    s_waitcnt lgkmcnt(11)
    v_lshl_add_u32 v232, v232, 16, v51
    s_waitcnt lgkmcnt(10)
    v_lshl_add_u32 v233, v233, 16, v51
    s_waitcnt lgkmcnt(9)
    v_lshl_add_u32 v234, v234, 16, v51
    s_waitcnt lgkmcnt(8)
    v_lshl_add_u32 v235, v235, 16, v51
    s_waitcnt lgkmcnt(7)
    v_lshl_add_u32 v236, v236, 16, v51
    s_waitcnt lgkmcnt(6)
    v_lshl_add_u32 v237, v237, 16, v51
    s_waitcnt lgkmcnt(5)
    v_lshl_add_u32 v238, v238, 16, v51
    s_waitcnt lgkmcnt(4)
    v_lshl_add_u32 v239, v239, 16, v51
    s_waitcnt lgkmcnt(3)
    v_lshl_add_u32 v240, v240, 16, v51
    s_waitcnt lgkmcnt(2)
    v_lshl_add_u32 v241, v241, 16, v51
    s_waitcnt lgkmcnt(1)
    v_lshl_add_u32 v242, v242, 16, v51
    s_waitcnt lgkmcnt(0)
    v_lshl_add_u32 v243, v243, 16, v51
    s_and_b32 s82, s38, 7
    s_lshr_b32 s82, s82, 1
    v_lshrrev_b32 v254, 1, v1
    v_lshl_add_u32 v254, v254, 2, s82
    v_subrev_u32 v7, 12, v254
    v_min_u32 v254, v254, v7
    v_subrev_u32 v7, 12, v254
    v_min_u32 v254, v254, v7
    v_and_b32 v7, 1, v1
    v_lshl_add_u32 v254, v254, 3, v7
    v_lshl_add_u32 v254, s36, 1, v254
    s_mul_i32 s82, s37, 6
    s_sub_u32 s82, s82, 14
    v_add_u32 v7, s82, v1
    v_cmp_gt_u32 vcc, 14, v1
    s_nop 1
    v_cndmask_b32 v254, v7, v254, vcc
    v_add_u32 v254, 672, v254
    s_lshl1_add_u32 s82, s39, s40
    s_xor_b32 s82, s82, 1
    v_and_b32 v7, 3, v1
    v_lshl_add_u32 v7, s82, 2, v7
    v_lshlrev_b32 v254, 1, v254
    v_cmp_gt_u32 vcc, 20, v1
    s_nop 1
    v_cndmask_b32 v254, v7, v254, vcc
    v_lshlrev_b32 v254, 6, v254
    s_mov_b32 s82, 19922944
    s_mul_i32 s50, s41, 98304
    s_add_u32 s82, s82, s50
    s_barrier
    s_waitcnt vmcnt(19)
    v_mfma_f32_32x32x16_f16 v[96:111], a[32:35], v[80:83], 0
    s_add_u32 m0, s86, 28672
    s_add_u32 s88, s85, 3456
    buffer_load_dwordx4 v20, s[16:19], s88 offen offset:0 lds
    v_mfma_f32_32x32x16_f16 v[112:127], a[48:51], v[80:83], 0
    buffer_load_dwordx4 v21, s[16:19], s88 offen offset:1024 lds
    s_waitcnt vmcnt(17)
    v_mfma_f32_32x32x16_f16 v[96:111], a[36:39], v[84:87], v[96:111]
    buffer_load_dwordx4 v22, s[16:19], s88 offen offset:2048 lds
    v_mfma_f32_32x32x16_f16 v[112:127], a[52:55], v[84:87], v[112:127]
    buffer_load_dwordx4 v23, s[16:19], s88 offen offset:3072 lds
    s_waitcnt vmcnt(15)
    v_mfma_f32_32x32x16_f16 v[96:111], a[40:43], v[88:91], v[96:111]
    s_add_u32 m0, s86, 32768
    s_nop 0
    buffer_load_dwordx4 v24, s[16:19], s88 offen offset:0 lds
    v_mfma_f32_32x32x16_f16 v[112:127], a[56:59], v[88:91], v[112:127]
    buffer_load_dwordx4 v25, s[16:19], s88 offen offset:1024 lds
    s_waitcnt vmcnt(13)
    v_mfma_f32_32x32x16_f16 v[96:111], a[44:47], v[92:95], v[96:111]
    buffer_load_dwordx4 v26, s[16:19], s88 offen offset:2048 lds
    v_mfma_f32_32x32x16_f16 v[112:127], a[60:63], v[92:95], v[112:127]
    s_add_u32 m0, s86, 57344
    s_add_u32 s88, s85, 6912
    buffer_load_dwordx4 v20, s[16:19], s88 offen offset:0 lds
    s_nop 6
    ds_write_b128 v57, v[96:99] offset:0
    ds_write_b128 v57, v[100:103] offset:1024
    ds_write_b128 v57, v[104:107] offset:2048
    ds_write_b128 v57, v[108:111] offset:3072
    ds_write_b128 v57, v[112:115] offset:4096
    ds_write_b128 v57, v[116:119] offset:5120
    ds_write_b128 v57, v[120:123] offset:6144
    ds_write_b128 v57, v[124:127] offset:7168
    buffer_load_dwordx4 v21, s[16:19], s88 offen offset:1024 lds
    buffer_load_dwordx4 v22, s[16:19], s88 offen offset:2048 lds
    buffer_load_dwordx4 v23, s[16:19], s88 offen offset:3072 lds
    s_add_u32 m0, s86, 61440
    s_nop 0
    buffer_load_dwordx4 v24, s[16:19], s88 offen offset:0 lds
    s_waitcnt lgkmcnt(0)
    s_barrier
    ds_read_b128 v[128:131], v58 offset:0
    ds_read_b128 v[132:135], v58 offset:4096
    ds_read_b128 v[144:147], v58 offset:16384
    ds_read_b128 v[148:151], v58 offset:20480
    ds_read_b128 v[136:139], v58 offset:8192
    ds_read_b128 v[140:143], v58 offset:12288
    ds_read_b128 v[152:155], v58 offset:24576
    ds_read_b128 v[156:159], v58 offset:28672
    s_waitcnt lgkmcnt(5)
    v_pk_add_f32 v[96:97], v[128:129], v[144:145]
    v_pk_add_f32 v[104:105], v[128:129], v[144:145] neg_lo:[0,1] neg_hi:[0,1]
    v_pk_add_f32 v[98:99], v[130:131], v[146:147]
    v_pk_add_f32 v[106:107], v[130:131], v[146:147] neg_lo:[0,1] neg_hi:[0,1]
    s_waitcnt lgkmcnt(4)
    v_pk_add_f32 v[100:101], v[132:133], v[148:149]
    v_pk_add_f32 v[108:109], v[132:133], v[148:149] neg_lo:[0,1] neg_hi:[0,1]
    v_pk_add_f32 v[102:103], v[134:135], v[150:151]
    v_pk_add_f32 v[110:111], v[134:135], v[150:151] neg_lo:[0,1] neg_hi:[0,1]
    s_waitcnt lgkmcnt(1)
    v_pk_add_f32 v[112:113], v[136:137], v[152:153]
    v_pk_add_f32 v[120:121], v[136:137], v[152:153] neg_lo:[0,1] neg_hi:[0,1]
    v_pk_add_f32 v[114:115], v[138:139], v[154:155]
    v_pk_add_f32 v[122:123], v[138:139], v[154:155] neg_lo:[0,1] neg_hi:[0,1]
    buffer_load_dwordx4 v25, s[16:19], s88 offen offset:1024 lds
    s_waitcnt lgkmcnt(0)
    v_pk_add_f32 v[116:117], v[140:141], v[156:157]
    v_pk_add_f32 v[124:125], v[140:141], v[156:157] neg_lo:[0,1] neg_hi:[0,1]
    v_pk_add_f32 v[118:119], v[142:143], v[158:159]
    v_pk_add_f32 v[126:127], v[142:143], v[158:159] neg_lo:[0,1] neg_hi:[0,1]
    v_pk_add_f32 v[160:161], v[96:97], v[112:113]
    v_pk_add_f32 v[164:165], v[100:101], v[116:117]
    v_pk_add_f32 v[162:163], v[98:99], v[114:115]
    v_pk_add_f32 v[166:167], v[102:103], v[118:119]
    v_pk_add_f32 v[176:177], v[96:97], v[112:113] neg_lo:[0,1] neg_hi:[0,1]
    v_pk_add_f32 v[180:181], v[100:101], v[116:117] neg_lo:[0,1] neg_hi:[0,1]
    v_pk_add_f32 v[178:179], v[98:99], v[114:115] neg_lo:[0,1] neg_hi:[0,1]
    v_pk_add_f32 v[182:183], v[102:103], v[118:119] neg_lo:[0,1] neg_hi:[0,1]
    buffer_load_dwordx4 v26, s[16:19], s88 offen offset:2048 lds
    v_pk_add_f32 v[168:169], v[104:105], v[124:125]
    v_pk_add_f32 v[172:173], v[108:109], v[120:121] neg_lo:[0,1] neg_hi:[0,1]
    v_pk_add_f32 v[170:171], v[106:107], v[126:127]
    v_pk_add_f32 v[174:175], v[110:111], v[122:123] neg_lo:[0,1] neg_hi:[0,1]
    v_pk_add_f32 v[184:185], v[104:105], v[124:125] neg_lo:[0,1] neg_hi:[0,1]
    v_pk_add_f32 v[188:189], v[108:109], v[120:121]
    v_pk_add_f32 v[186:187], v[106:107], v[126:127] neg_lo:[0,1] neg_hi:[0,1]
    v_pk_add_f32 v[190:191], v[110:111], v[122:123]
    v_pk_mul_f32 v[128:129], v[160:161], v[212:213]
    v_pk_mul_f32 v[132:133], v[164:165], v[212:213]
    v_pk_fma_f32 v[128:129], v[164:165], v[228:229], v[128:129] neg_lo:[0,1,0] neg_hi:[0,1,0]
    v_pk_fma_f32 v[132:133], v[160:161], v[228:229], v[132:133]
    s_add_u32 m0, s86, 86016
    s_add_u32 s88, s85, 10368
    buffer_load_dwordx4 v20, s[16:19], s88 offen offset:0 lds
    v_pk_mul_f32 v[130:131], v[162:163], v[214:215]
    v_pk_mul_f32 v[134:135], v[166:167], v[214:215]
    v_pk_fma_f32 v[130:131], v[166:167], v[230:231], v[130:131] neg_lo:[0,1,0] neg_hi:[0,1,0]
    v_pk_fma_f32 v[134:135], v[162:163], v[230:231], v[134:135]
    v_pk_mul_f32 v[136:137], v[168:169], v[216:217]
    v_pk_mul_f32 v[140:141], v[172:173], v[216:217]
    v_pk_fma_f32 v[136:137], v[172:173], v[232:233], v[136:137] neg_lo:[0,1,0] neg_hi:[0,1,0]
    v_pk_fma_f32 v[140:141], v[168:169], v[232:233], v[140:141]
    v_pk_mul_f32 v[138:139], v[170:171], v[218:219]
    v_pk_mul_f32 v[142:143], v[174:175], v[218:219]
    v_pk_fma_f32 v[138:139], v[174:175], v[234:235], v[138:139] neg_lo:[0,1,0] neg_hi:[0,1,0]
    v_pk_fma_f32 v[142:143], v[170:171], v[234:235], v[142:143]
    buffer_load_dwordx4 v21, s[16:19], s88 offen offset:1024 lds
    v_pk_mul_f32 v[144:145], v[176:177], v[220:221]
    v_pk_mul_f32 v[148:149], v[180:181], v[220:221]
    v_pk_fma_f32 v[144:145], v[180:181], v[236:237], v[144:145] neg_lo:[0,1,0] neg_hi:[0,1,0]
    v_pk_fma_f32 v[148:149], v[176:177], v[236:237], v[148:149]
    v_pk_mul_f32 v[146:147], v[178:179], v[222:223]
    v_pk_mul_f32 v[150:151], v[182:183], v[222:223]
    v_pk_fma_f32 v[146:147], v[182:183], v[238:239], v[146:147] neg_lo:[0,1,0] neg_hi:[0,1,0]
    v_pk_fma_f32 v[150:151], v[178:179], v[238:239], v[150:151]
    v_pk_mul_f32 v[152:153], v[184:185], v[224:225]
    v_pk_mul_f32 v[156:157], v[188:189], v[224:225]
    v_pk_fma_f32 v[152:153], v[188:189], v[240:241], v[152:153] neg_lo:[0,1,0] neg_hi:[0,1,0]
    v_pk_fma_f32 v[156:157], v[184:185], v[240:241], v[156:157]
    buffer_load_dwordx4 v22, s[16:19], s88 offen offset:2048 lds
    v_pk_mul_f32 v[154:155], v[186:187], v[226:227]
    v_pk_mul_f32 v[158:159], v[190:191], v[226:227]
    v_pk_fma_f32 v[154:155], v[190:191], v[242:243], v[154:155] neg_lo:[0,1,0] neg_hi:[0,1,0]
    v_pk_fma_f32 v[158:159], v[186:187], v[242:243], v[158:159]
    v_pk_add_f32 v[96:97], v[128:129], v[144:145]
    v_pk_add_f32 v[104:105], v[128:129], v[144:145] neg_lo:[0,1] neg_hi:[0,1]
    v_pk_add_f32 v[98:99], v[130:131], v[146:147]
    v_pk_add_f32 v[106:107], v[130:131], v[146:147] neg_lo:[0,1] neg_hi:[0,1]
    v_pk_add_f32 v[100:101], v[132:133], v[148:149]
    v_pk_add_f32 v[108:109], v[132:133], v[148:149] neg_lo:[0,1] neg_hi:[0,1]
    v_pk_add_f32 v[102:103], v[134:135], v[150:151]
    v_pk_add_f32 v[110:111], v[134:135], v[150:151] neg_lo:[0,1] neg_hi:[0,1]
    buffer_load_dwordx4 v23, s[16:19], s88 offen offset:3072 lds
    v_pk_add_f32 v[112:113], v[136:137], v[152:153]
    v_pk_add_f32 v[120:121], v[136:137], v[152:153] neg_lo:[0,1] neg_hi:[0,1]
    v_pk_add_f32 v[114:115], v[138:139], v[154:155]
    v_pk_add_f32 v[122:123], v[138:139], v[154:155] neg_lo:[0,1] neg_hi:[0,1]
    v_pk_add_f32 v[116:117], v[140:141], v[156:157]
    v_pk_add_f32 v[124:125], v[140:141], v[156:157] neg_lo:[0,1] neg_hi:[0,1]
    v_pk_add_f32 v[118:119], v[142:143], v[158:159]
    v_pk_add_f32 v[126:127], v[142:143], v[158:159] neg_lo:[0,1] neg_hi:[0,1]
    v_pk_add_f32 v[160:161], v[96:97], v[112:113]
    v_pk_add_f32 v[164:165], v[100:101], v[116:117]
    v_pk_add_f32 v[162:163], v[98:99], v[114:115]
    v_pk_add_f32 v[166:167], v[102:103], v[118:119]
    s_add_u32 m0, s86, 90112
    s_nop 0
    buffer_load_dwordx4 v24, s[16:19], s88 offen offset:0 lds
    v_cvt_pk_bf16_f32 v192, v160, v164
    v_cvt_pk_bf16_f32 v193, v161, v165
    v_cvt_pk_bf16_f32 v194, v162, v166
    v_cvt_pk_bf16_f32 v195, v163, v167
    ds_write_b128 v58, v[192:195] offset:32768
    v_pk_add_f32 v[176:177], v[96:97], v[112:113] neg_lo:[0,1] neg_hi:[0,1]
    v_pk_add_f32 v[180:181], v[100:101], v[116:117] neg_lo:[0,1] neg_hi:[0,1]
    v_pk_add_f32 v[178:179], v[98:99], v[114:115] neg_lo:[0,1] neg_hi:[0,1]
    v_pk_add_f32 v[182:183], v[102:103], v[118:119] neg_lo:[0,1] neg_hi:[0,1]
    v_cvt_pk_bf16_f32 v200, v176, v180
    v_cvt_pk_bf16_f32 v201, v177, v181
    v_cvt_pk_bf16_f32 v202, v178, v182
    buffer_load_dwordx4 v25, s[16:19], s88 offen offset:1024 lds
    v_cvt_pk_bf16_f32 v203, v179, v183
    ds_write_b128 v58, v[200:203] offset:40960
    v_pk_add_f32 v[184:185], v[104:105], v[124:125]
    v_pk_add_f32 v[188:189], v[108:109], v[120:121] neg_lo:[0,1] neg_hi:[0,1]
    v_pk_add_f32 v[186:187], v[106:107], v[126:127]
    v_pk_add_f32 v[190:191], v[110:111], v[122:123] neg_lo:[0,1] neg_hi:[0,1]
    v_cvt_pk_bf16_f32 v204, v184, v188
    v_cvt_pk_bf16_f32 v205, v185, v189
    v_cvt_pk_bf16_f32 v206, v186, v190
    v_cvt_pk_bf16_f32 v207, v187, v191
    ds_write_b128 v58, v[204:207] offset:45056
    v_pk_add_f32 v[168:169], v[104:105], v[124:125] neg_lo:[0,1] neg_hi:[0,1]
    buffer_load_dwordx4 v26, s[16:19], s88 offen offset:2048 lds
    v_pk_add_f32 v[172:173], v[108:109], v[120:121]
    v_pk_add_f32 v[170:171], v[106:107], v[126:127] neg_lo:[0,1] neg_hi:[0,1]
    v_pk_add_f32 v[174:175], v[110:111], v[122:123]
    v_cvt_pk_bf16_f32 v196, v168, v172
    v_cvt_pk_bf16_f32 v197, v169, v173
    v_cvt_pk_bf16_f32 v198, v170, v174
    v_cvt_pk_bf16_f32 v199, v171, v175
    ds_write_b128 v58, v[196:199] offset:36864
    s_waitcnt lgkmcnt(0)
    s_barrier
    ds_read_b128 v[80:83], v59 offset:0
    ds_read_b128 v[84:87], v59 offset:1024
    ds_read_b128 v[88:91], v59 offset:2048
    ds_read_b128 v[92:95], v59 offset:3072
    buffer_load_dword v248, v254, s[28:31], s82 offen sc1
    s_waitcnt lgkmcnt(3)
    v_mfma_f32_32x32x16_bf16 v[96:111], a[64:67], v[80:83], 0
    v_mfma_f32_32x32x16_bf16 v[112:127], a[80:83], v[80:83], 0
    s_waitcnt lgkmcnt(2)
    v_mfma_f32_32x32x16_bf16 v[96:111], a[68:71], v[84:87], v[96:111]
    v_mfma_f32_32x32x16_bf16 v[112:127], a[84:87], v[84:87], v[112:127]
    s_waitcnt lgkmcnt(1)
    v_mfma_f32_32x32x16_bf16 v[96:111], a[72:75], v[88:91], v[96:111]
    v_mfma_f32_32x32x16_bf16 v[112:127], a[88:91], v[88:91], v[112:127]
    s_waitcnt lgkmcnt(0)
    v_mfma_f32_32x32x16_bf16 v[96:111], a[76:79], v[92:95], v[96:111]
    v_mfma_f32_32x32x16_bf16 v[112:127], a[92:95], v[92:95], v[112:127]
    s_nop 11
    v_cvt_pk_bf16_f32 v61, v112, v113
    v_perm_b32 v192, v61, v96, s92
    v_or_b32 v192, 1, v192
    buffer_store_dword v192, v60, s[28:31], s64 offen sc1
    v_perm_b32 v193, v61, v97, s93
    v_or_b32 v193, 1, v193
    buffer_store_dword v193, v60, s[28:31], s65 offen sc1
    v_cvt_pk_bf16_f32 v61, v114, v115
    v_perm_b32 v194, v61, v98, s92
    v_or_b32 v194, 1, v194
    buffer_store_dword v194, v60, s[28:31], s66 offen sc1
    v_perm_b32 v195, v61, v99, s93
    v_or_b32 v195, 1, v195
    buffer_store_dword v195, v60, s[28:31], s67 offen sc1
    v_cvt_pk_bf16_f32 v61, v116, v117
    v_perm_b32 v196, v61, v100, s92
    v_or_b32 v196, 1, v196
    buffer_store_dword v196, v60, s[28:31], s68 offen sc1
    v_perm_b32 v197, v61, v101, s93
    v_or_b32 v197, 1, v197
    buffer_store_dword v197, v60, s[28:31], s69 offen sc1
    v_cvt_pk_bf16_f32 v61, v118, v119
    v_perm_b32 v198, v61, v102, s92
    v_or_b32 v198, 1, v198
    buffer_store_dword v198, v60, s[28:31], s70 offen sc1
    v_perm_b32 v199, v61, v103, s93
    v_or_b32 v199, 1, v199
    buffer_store_dword v199, v60, s[28:31], s71 offen sc1
    v_cvt_pk_bf16_f32 v61, v120, v121
    v_perm_b32 v200, v61, v104, s92
    v_or_b32 v200, 1, v200
    buffer_store_dword v200, v60, s[28:31], s72 offen sc1
    v_perm_b32 v201, v61, v105, s93
    v_or_b32 v201, 1, v201
    buffer_store_dword v201, v60, s[28:31], s73 offen sc1
    v_cvt_pk_bf16_f32 v61, v122, v123
    v_perm_b32 v202, v61, v106, s92
    v_or_b32 v202, 1, v202
    buffer_store_dword v202, v60, s[28:31], s74 offen sc1
    v_perm_b32 v203, v61, v107, s93
    v_or_b32 v203, 1, v203
    buffer_store_dword v203, v60, s[28:31], s75 offen sc1
    v_cvt_pk_bf16_f32 v61, v124, v125
    v_perm_b32 v204, v61, v108, s92
    v_or_b32 v204, 1, v204
    buffer_store_dword v204, v60, s[28:31], s76 offen sc1
    v_perm_b32 v205, v61, v109, s93
    v_or_b32 v205, 1, v205
    buffer_store_dword v205, v60, s[28:31], s77 offen sc1
    v_cvt_pk_bf16_f32 v61, v126, v127
    v_perm_b32 v206, v61, v110, s92
    v_or_b32 v206, 1, v206
    buffer_store_dword v206, v60, s[28:31], s78 offen sc1
    v_perm_b32 v207, v61, v111, s93
    v_or_b32 v207, 1, v207
    buffer_store_dword v207, v60, s[28:31], s79 offen sc1
    s_waitcnt vmcnt(16)
    v_cmp_ne_u32 vcc, s62, v248
    s_nop 0
    s_cbranch_vccz Lok_5
Lfix_4:
    s_add_i32 s49, s49, -1
    s_cmp_lt_i32 s49, 0
    s_cbranch_scc1 Lok_5
    buffer_load_dword v248, v254, s[28:31], s82 offen sc1
    s_waitcnt vmcnt(0)
    v_cmp_ne_u32 vcc, s62, v248
    s_nop 0
    s_cbranch_vccnz Lfix_4
Lok_5:
    s_add_u32 m0, s86, 114688
    s_add_u32 s88, s85, 13824
    buffer_load_dwordx4 v20, s[16:19], s88 offen offset:0 lds
    buffer_load_dwordx4 v21, s[16:19], s88 offen offset:1024 lds
    buffer_load_dwordx4 v22, s[16:19], s88 offen offset:2048 lds
    buffer_load_dwordx4 v23, s[16:19], s88 offen offset:3072 lds
    s_add_u32 m0, s86, 118784
    s_nop 0
    buffer_load_dwordx4 v24, s[16:19], s88 offen offset:0 lds
    buffer_load_dwordx4 v25, s[16:19], s88 offen offset:1024 lds
    buffer_load_dwordx4 v26, s[16:19], s88 offen offset:2048 lds
    s_branch L_join2
L_nop2:
    s_mul_i32 s52, s36, 12
    s_add_u32 s52, s52, s42
    s_sub_u32 s52, s52, 20
    s_mul_i32 s53, s41, 28
    s_cmp_lt_u32 s52, 28
    s_cselect_b32 s53, s53, 224
    s_add_u32 s52, s52, s53
    s_lshr_b32 s53, s52, 2
    s_and_b32 s54, s52, 3
    s_mul_i32 s56, s36, 10240
    s_add_u32 s56, s56, 57344
    s_mul_i32 s72, s53, 40960
    s_mul_i32 s50, s54, 320
    s_add_u32 s72, s72, s50
    s_add_u32 s73, s72, 20480
    s_movk_i32 s50, 3277
    s_mov_b32 s75, s56
    v_add_u32 v200, 0, v1
    v_mul_u32_u24 v201, s50, v200
    v_lshrrev_b32 v201, 16, v201
    v_mul_u32_u24 v201, 960, v201
    v_lshl_add_u32 v206, v200, 4, v201
    v_add_u32 v200, 64, v1
    v_mul_u32_u24 v201, s50, v200
    v_lshrrev_b32 v201, 16, v201
    v_mul_u32_u24 v201, 960, v201
    v_lshl_add_u32 v207, v200, 4, v201
    v_add_u32 v200, 128, v1
    v_mul_u32_u24 v201, s50, v200
    v_lshrrev_b32 v201, 16, v201
    v_mul_u32_u24 v201, 960, v201
    v_lshl_add_u32 v208, v200, 4, v201
    v_add_u32 v200, 192, v1
    v_mul_u32_u24 v201, s50, v200
    v_lshrrev_b32 v201, 16, v201
    v_mul_u32_u24 v201, 960, v201
    v_lshl_add_u32 v209, v200, 4, v201
    v_add_u32 v200, 256, v1
    v_mul_u32_u24 v201, s50, v200
    v_lshrrev_b32 v201, 16, v201
    v_mul_u32_u24 v201, 960, v201
    v_lshl_add_u32 v210, v200, 4, v201
    buffer_load_ushort v253, v216, s[12:15], s68 offen
    buffer_load_dword v249, v218, s[20:23], s69 offen
    v_cmp_gt_u32 vcc, 8, v2
    s_waitcnt vmcnt(16)
    ds_read_b128 v[48:51], v48
    ds_read_b128 v[52:55], v52
    ds_read_b128 v[56:59], v56
    ds_read_b128 v[60:63], v60
    ds_read_b128 v[64:67], v64
    s_waitcnt lgkmcnt(4)
    v_bfi_b32 v68, s48, v48, v50
    s_waitcnt lgkmcnt(3)
    v_bfi_b32 v69, s48, v53, v55
    s_waitcnt lgkmcnt(1)
    v_bfi_b32 v70, s48, v58, v60
    s_waitcnt lgkmcnt(0)
    v_bfi_b32 v71, s48, v63, v65
    ds_write_b128 v114, v[68:71] offset:0
    v_dot2_f32_bf16 v196, v48, v198, 0
    v_dot2_f32_bf16 v197, v48, v48, 0
    v_dot2_f32_bf16 v196, v49, v198, v196
    v_dot2_f32_bf16 v197, v49, v49, v197
    v_dot2_f32_bf16 v196, v50, v198, v196
    v_dot2_f32_bf16 v197, v50, v50, v197
    v_dot2_f32_bf16 v196, v51, v198, v196
    v_dot2_f32_bf16 v197, v51, v51, v197
    v_alignbit_b32 v72, v51, v48, 16
    s_mov_b32 s88, 36864
    buffer_load_dwordx4 v[20:23], v4, s[32:35], s88 offen
    buffer_load_dwordx3 v[24:26], v4, s[32:35], s88 offen offset:1024
    v_alignbit_b32 v73, v56, v53, 16
    v_alignbit_b32 v74, v61, v58, 16
    v_alignbit_b32 v75, v66, v63, 16
    ds_write_b128 v115, v[72:75] offset:4096
    v_dot2_f32_bf16 v196, v52, v198, v196
    v_dot2_f32_bf16 v197, v52, v52, v197
    v_dot2_f32_bf16 v196, v53, v198, v196
    v_dot2_f32_bf16 v197, v53, v53, v197
    v_dot2_f32_bf16 v196, v54, v198, v196
    v_dot2_f32_bf16 v197, v54, v54, v197
    v_dot2_f32_bf16 v196, v55, v198, v196
    v_dot2_f32_bf16 v197, v55, v55, v197
    v_bfi_b32 v76, s48, v49, v51
    v_bfi_b32 v77, s48, v54, v56
    s_lshl_b32 s94, s2, 7
    s_and_b32 s95, s36, 1
    s_lshl_b32 s95, s95, 6
    s_add_u32 s94, s94, s95
    s_add_u32 s94, s94, 19988480
    buffer_store_dwordx2 v[244:245], v211, s[28:31], s94 offen sc1
    v_bfi_b32 v78, s48, v59, v61
    v_bfi_b32 v79, s48, v64, v66
    ds_write_b128 v114, v[76:79] offset:8192
    v_dot2_f32_bf16 v196, v56, v198, v196
    v_dot2_f32_bf16 v197, v56, v56, v197
    v_dot2_f32_bf16 v196, v57, v198, v196
    v_dot2_f32_bf16 v197, v57, v57, v197
    v_dot2_f32_bf16 v196, v58, v198, v196
    v_dot2_f32_bf16 v197, v58, v58, v197
    v_dot2_f32_bf16 v196, v59, v198, v196
    v_dot2_f32_bf16 v197, v59, v59, v197
    v_alignbit_b32 v80, v52, v49, 16
    v_alignbit_b32 v81, v57, v54, 16
    v_alignbit_b32 v82, v62, v59, 16
    s_lshr_b32 s94, s36, 1
    s_lshl4_add_u32 s94, s94, s38
    s_and_b32 s95, s36, 1
    s_lshl1_add_u32 s94, s94, s95
    s_lshl_b32 s94, s94, 9
    s_lshl_b32 s95, s37, 15
    s_add_u32 s94, s94, s95
    s_add_u32 s94, s94, 21102592
    v_lshrrev_b32 v251, 1, v4
    buffer_store_dwordx2 v[244:245], v251, s[28:31], s94 offen sc1
    v_alignbit_b32 v83, v67, v64, 16
    ds_write_b128 v115, v[80:83] offset:12288
    v_dot2_f32_bf16 v196, v60, v198, v196
    v_dot2_f32_bf16 v197, v60, v60, v197
    v_dot2_f32_bf16 v196, v61, v198, v196
    v_dot2_f32_bf16 v197, v61, v61, v197
    v_dot2_f32_bf16 v196, v62, v198, v196
    v_dot2_f32_bf16 v197, v62, v62, v197
    v_dot2_f32_bf16 v196, v63, v198, v196
    v_dot2_f32_bf16 v197, v63, v63, v197
    v_bfi_b32 v84, s48, v50, v52
    v_bfi_b32 v85, s48, v55, v57
    v_bfi_b32 v86, s48, v60, v62
    v_bfi_b32 v87, s48, v65, v67
    s_add_u32 s94, s101, 30720
    s_lshl_b32 s95, s36, 26
    s_add_u32 s94, s94, s95
    v_lshrrev_b32 v251, 1, v4
    buffer_store_dwordx2 v[244:245], v251, s[28:31], s94 offen sc1
    ds_write_b128 v114, v[84:87] offset:16384
    v_dot2_f32_bf16 v196, v64, v198, v196
    v_dot2_f32_bf16 v197, v64, v64, v197
    v_dot2_f32_bf16 v196, v65, v198, v196
    v_dot2_f32_bf16 v197, v65, v65, v197
    v_dot2_f32_bf16 v196, v66, v198, v196
    v_dot2_f32_bf16 v197, v66, v66, v197
    v_dot2_f32_bf16 v196, v67, v198, v196
    v_dot2_f32_bf16 v197, v67, v67, v197
    s_waitcnt vmcnt(20)
    v_readfirstlane_b32 s62, v5
    s_waitcnt lgkmcnt(0)
    s_barrier
    ds_read_b128 v[124:127], v116 offset:0
    ds_read_b128 v[128:131], v116 offset:8192
    ds_read_b128 v[132:135], v116 offset:16384
    ds_read_b128 v[136:139], v117 offset:1024
    ds_read_b128 v[140:143], v117 offset:9216
    ds_read_b128 v[144:147], v117 offset:17408
    ds_read_b128 v[148:151], v116 offset:2048
    ds_read_b128 v[152:155], v116 offset:10240
    ds_read_b128 v[156:159], v116 offset:18432
    ds_read_b128 v[160:163], v117 offset:3072
    ds_read_b128 v[164:167], v117 offset:11264
    ds_read_b128 v[168:171], v117 offset:19456
    s_mul_i32 s62, s62, 0x9E3779B1
    s_add_u32 s62, s62, 0x7F4A7C16
    s_and_b32 s62, s62, -2
    v_mov_b32 v5, s62
    v_mov_b32 v220, s62
    v_mov_b32 v221, s62
    s_waitcnt vmcnt(19) lgkmcnt(11)
    v_mfma_f32_16x16x32_bf16 v[172:175], v[124:127], a[0:3], 0
    v_add_f32_dpp v196, v196, v196 row_ror:8 row_mask:0xf bank_mask:0xf
    v_add_f32_dpp v197, v197, v197 row_ror:8 row_mask:0xf bank_mask:0xf
    s_waitcnt vmcnt(18)
    v_mfma_f32_16x16x32_bf16 v[176:179], v[124:127], a[16:19], 0
    v_add_f32_dpp v196, v196, v196 row_ror:4 row_mask:0xf bank_mask:0xf
    v_add_f32_dpp v197, v197, v197 row_ror:4 row_mask:0xf bank_mask:0xf
    s_waitcnt lgkmcnt(10)
    v_mfma_f32_16x16x32_bf16 v[180:183], v[128:131], a[0:3], 0
    v_add_f32_dpp v196, v196, v196 row_ror:2 row_mask:0xf bank_mask:0xf
    v_add_f32_dpp v197, v197, v197 row_ror:2 row_mask:0xf bank_mask:0xf
    v_mfma_f32_16x16x32_bf16 v[184:187], v[128:131], a[16:19], 0
    v_add_f32_dpp v196, v196, v196 row_ror:1 row_mask:0xf bank_mask:0xf
    v_add_f32_dpp v197, v197, v197 row_ror:1 row_mask:0xf bank_mask:0xf
    s_waitcnt lgkmcnt(9)
    v_mfma_f32_16x16x32_bf16 v[188:191], v[132:135], a[0:3], 0
    v_mul_f32 v196, 0x3acccccd, v196
    v_mul_f32 v197, 0x3acccccd, v197
    v_mfma_f32_16x16x32_bf16 v[192:195], v[132:135], a[16:19], 0
    v_fma_f32 v197, -v196, v196, v197
    v_max_f32 v197, 0, v197
    s_waitcnt vmcnt(17) lgkmcnt(8)
    v_mfma_f32_16x16x32_bf16 v[172:175], v[136:139], a[4:7], v[172:175]
    v_cvt_pk_bf16_f32 v197, v197, v197
    v_lshlrev_b32 v197, 16, v197
    s_waitcnt vmcnt(16)
    v_mfma_f32_16x16x32_bf16 v[176:179], v[136:139], a[20:23], v[176:179]
    v_add_f32 v197, 0x3727c5ac, v197
    v_cvt_pk_bf16_f32 v197, v197, v197
    s_waitcnt lgkmcnt(7)
    v_mfma_f32_16x16x32_bf16 v[180:183], v[140:143], a[4:7], v[180:183]
    v_lshlrev_b32 v197, 16, v197
    v_sqrt_f32 v197, v197
    v_mfma_f32_16x16x32_bf16 v[184:187], v[140:143], a[20:23], v[184:187]
    v_cvt_pk_bf16_f32 v197, v197, v197
    v_lshlrev_b32 v197, 16, v197
    s_waitcnt lgkmcnt(6)
    v_mfma_f32_16x16x32_bf16 v[188:191], v[144:147], a[4:7], v[188:191]
    v_rcp_f32 v197, v197
    s_nop 0
    v_mul_f32 v197, 0x3c21e89b, v197
    v_mfma_f32_16x16x32_bf16 v[192:195], v[144:147], a[20:23], v[192:195]
    ds_write_b32 v118, v197
    ds_write_b32 v118, v196 offset:64
    s_waitcnt vmcnt(15) lgkmcnt(7)
    v_mfma_f32_16x16x32_bf16 v[172:175], v[148:151], a[8:11], v[172:175]
    ds_read_b128 v[8:11], v120 offset:0
    ds_read_b128 v[12:15], v120 offset:8192
    s_waitcnt vmcnt(14)
    v_mfma_f32_16x16x32_bf16 v[176:179], v[148:151], a[24:27], v[176:179]
    ds_read_b128 v[16:19], v120 offset:16384
    s_waitcnt lgkmcnt(9)
    v_mfma_f32_16x16x32_bf16 v[180:183], v[152:155], a[8:11], v[180:183]
    v_mfma_f32_16x16x32_bf16 v[184:187], v[152:155], a[24:27], v[184:187]
    s_waitcnt lgkmcnt(8)
    v_mfma_f32_16x16x32_bf16 v[188:191], v[156:159], a[8:11], v[188:191]
    v_mfma_f32_16x16x32_bf16 v[192:195], v[156:159], a[24:27], v[192:195]
    s_waitcnt vmcnt(13) lgkmcnt(7)
    v_mfma_f32_16x16x32_bf16 v[172:175], v[160:163], a[12:15], v[172:175]
    s_waitcnt vmcnt(12)
    v_mfma_f32_16x16x32_bf16 v[176:179], v[160:163], a[28:31], v[176:179]
    s_waitcnt lgkmcnt(6)
    v_mfma_f32_16x16x32_bf16 v[180:183], v[164:167], a[12:15], v[180:183]
    v_mfma_f32_16x16x32_bf16 v[184:187], v[164:167], a[28:31], v[184:187]
    s_waitcnt lgkmcnt(5)
    v_mfma_f32_16x16x32_bf16 v[188:191], v[168:171], a[12:15], v[188:191]
    v_mfma_f32_16x16x32_bf16 v[192:195], v[168:171], a[28:31], v[192:195]
    s_waitcnt lgkmcnt(0)
    s_barrier
    ds_read_b64 v[112:113], v119
    ds_read_b32 v27, v27
    v_cndmask_b32 v16, 0, v16, vcc
    v_cndmask_b32 v17, 0, v17, vcc
    v_cndmask_b32 v18, 0, v18, vcc
    v_cndmask_b32 v19, 0, v19, vcc
    s_waitcnt vmcnt(11)
    v_pk_mul_f32 v[48:49], v[174:175], v[88:89] op_sel:[0,0] op_sel_hi:[1,0]
    s_waitcnt vmcnt(9)
    v_pk_mul_f32 v[56:57], v[178:179], v[96:97] op_sel:[0,0] op_sel_hi:[1,0]
    v_pk_fma_f32 v[48:49], v[178:179], v[92:93], v[48:49] op_sel:[0,0,0] op_sel_hi:[1,0,1]
    v_pk_fma_f32 v[56:57], v[174:175], v[92:93], v[56:57] op_sel:[0,0,0] op_sel_hi:[1,0,1] neg_lo:[0,1,0] neg_hi:[0,1,0]
    v_pk_mul_f32 v[50:51], v[180:181], v[88:89] op_sel:[0,1] op_sel_hi:[1,1]
    v_pk_mul_f32 v[58:59], v[184:185], v[96:97] op_sel:[0,1] op_sel_hi:[1,1]
    v_pk_fma_f32 v[50:51], v[184:185], v[92:93], v[50:51] op_sel:[0,1,0] op_sel_hi:[1,1,1]
    v_pk_fma_f32 v[58:59], v[180:181], v[92:93], v[58:59] op_sel:[0,1,0] op_sel_hi:[1,1,1] neg_lo:[0,1,0] neg_hi:[0,1,0]
    v_pk_mul_f32 v[52:53], v[182:183], v[90:91] op_sel:[0,0] op_sel_hi:[1,0]
    v_pk_mul_f32 v[60:61], v[186:187], v[98:99] op_sel:[0,0] op_sel_hi:[1,0]
    v_pk_fma_f32 v[52:53], v[186:187], v[94:95], v[52:53] op_sel:[0,0,0] op_sel_hi:[1,0,1]
    v_pk_fma_f32 v[60:61], v[182:183], v[94:95], v[60:61] op_sel:[0,0,0] op_sel_hi:[1,0,1] neg_lo:[0,1,0] neg_hi:[0,1,0]
    v_pk_mul_f32 v[54:55], v[188:189], v[90:91] op_sel:[0,1] op_sel_hi:[1,1]
    v_pk_mul_f32 v[62:63], v[192:193], v[98:99] op_sel:[0,1] op_sel_hi:[1,1]
    v_pk_fma_f32 v[54:55], v[192:193], v[94:95], v[54:55] op_sel:[0,1,0] op_sel_hi:[1,1,1]
    v_pk_fma_f32 v[62:63], v[188:189], v[94:95], v[62:63] op_sel:[0,1,0] op_sel_hi:[1,1,1] neg_lo:[0,1,0] neg_hi:[0,1,0]
    v_pk_add_f32 v[64:65], v[48:49], v[54:55]
    v_pk_add_f32 v[66:67], v[50:51], v[52:53]
    v_pk_add_f32 v[68:69], v[48:49], v[54:55] neg_lo:[0,1] neg_hi:[0,1]
    v_pk_add_f32 v[70:71], v[50:51], v[52:53] neg_lo:[0,1] neg_hi:[0,1]
    v_pk_add_f32 v[72:73], v[172:173], v[64:65]
    v_pk_fma_f32 v[74:75], v[64:65], s[44:45], v[172:173] op_sel:[0,0,0] op_sel_hi:[1,0,1]
    v_pk_fma_f32 v[76:77], v[64:65], s[44:45], v[172:173] op_sel:[0,1,0] op_sel_hi:[1,1,1]
    v_pk_mul_f32 v[78:79], v[68:69], s[46:47] op_sel:[0,0] op_sel_hi:[1,0]
    v_pk_mul_f32 v[80:81], v[68:69], s[46:47] op_sel:[0,1] op_sel_hi:[1,1]
    v_pk_add_f32 v[72:73], v[72:73], v[66:67]
    v_pk_fma_f32 v[74:75], v[66:67], s[44:45], v[74:75] op_sel:[0,1,0] op_sel_hi:[1,1,1]
    v_pk_fma_f32 v[76:77], v[66:67], s[44:45], v[76:77] op_sel:[0,0,0] op_sel_hi:[1,0,1]
    v_pk_fma_f32 v[78:79], v[70:71], s[46:47], v[78:79] op_sel:[0,1,0] op_sel_hi:[1,1,1]
    v_pk_fma_f32 v[80:81], v[70:71], s[46:47], v[80:81] op_sel:[0,0,0] op_sel_hi:[1,0,1] neg_lo:[0,1,0] neg_hi:[0,1,0]
    v_pk_add_f32 v[82:83], v[56:57], v[62:63]
    v_pk_add_f32 v[84:85], v[58:59], v[60:61]
    v_pk_add_f32 v[86:87], v[56:57], v[62:63] neg_lo:[0,1] neg_hi:[0,1]
    v_pk_add_f32 v[124:125], v[58:59], v[60:61] neg_lo:[0,1] neg_hi:[0,1]
    v_pk_add_f32 v[126:127], v[176:177], v[82:83]
    v_pk_fma_f32 v[128:129], v[82:83], s[44:45], v[176:177] op_sel:[0,0,0] op_sel_hi:[1,0,1]
    v_pk_fma_f32 v[130:131], v[82:83], s[44:45], v[176:177] op_sel:[0,1,0] op_sel_hi:[1,1,1]
    v_pk_mul_f32 v[132:133], v[86:87], s[46:47] op_sel:[0,0] op_sel_hi:[1,0]
    v_pk_mul_f32 v[134:135], v[86:87], s[46:47] op_sel:[0,1] op_sel_hi:[1,1]
    v_pk_add_f32 v[126:127], v[126:127], v[84:85]
    v_pk_fma_f32 v[128:129], v[84:85], s[44:45], v[128:129] op_sel:[0,1,0] op_sel_hi:[1,1,1]
    v_pk_fma_f32 v[130:131], v[84:85], s[44:45], v[130:131] op_sel:[0,0,0] op_sel_hi:[1,0,1]
    v_pk_fma_f32 v[132:133], v[124:125], s[46:47], v[132:133] op_sel:[0,1,0] op_sel_hi:[1,1,1]
    v_pk_fma_f32 v[134:135], v[124:125], s[46:47], v[134:135] op_sel:[0,0,0] op_sel_hi:[1,0,1] neg_lo:[0,1,0] neg_hi:[0,1,0]
    s_waitcnt vmcnt(8)
    v_pk_mul_f32 v[136:137], v[72:73], v[100:101] op_sel:[0,0] op_sel_hi:[1,0]
    s_waitcnt lgkmcnt(1)
    v_pk_mul_f32 v[136:137], v[136:137], v[112:113]
    v_pk_mul_f32 v[126:127], v[126:127], v[112:113]
    v_cvt_pk_f16_f32 v196, v136, v126
    v_cvt_pk_f16_f32 v197, v137, v127
    ds_write_b64 v121, v[196:197] offset:0
    v_pk_fma_f32 v[138:139], v[132:133], v[100:101], v[74:75] op_sel:[0,0,0] op_sel_hi:[1,0,1]
    v_pk_fma_f32 v[146:147], v[128:129], v[100:101], v[78:79] op_sel:[0,0,0] op_sel_hi:[1,0,1] neg_lo:[0,0,1] neg_hi:[0,0,1]
    v_pk_mul_f32 v[138:139], v[138:139], v[112:113]
    v_pk_mul_f32 v[146:147], v[146:147], v[112:113]
    v_cvt_pk_f16_f32 v198, v138, v146
    v_cvt_pk_f16_f32 v199, v139, v147
    ds_write_b64 v121, v[198:199] offset:1024
    v_pk_fma_f32 v[140:141], v[134:135], v[100:101], v[76:77] op_sel:[0,0,0] op_sel_hi:[1,0,1]
    v_pk_fma_f32 v[148:149], v[130:131], v[100:101], v[80:81] op_sel:[0,0,0] op_sel_hi:[1,0,1] neg_lo:[0,0,1] neg_hi:[0,0,1]
    v_pk_mul_f32 v[140:141], v[140:141], v[112:113]
    v_pk_mul_f32 v[148:149], v[148:149], v[112:113]
    v_cvt_pk_f16_f32 v200, v140, v148
    v_cvt_pk_f16_f32 v201, v141, v149
    ds_write_b64 v121, v[200:201] offset:2048
    v_pk_fma_f32 v[142:143], v[76:77], v[100:101], v[134:135] op_sel:[0,0,0] op_sel_hi:[1,0,1] neg_lo:[0,0,1] neg_hi:[0,0,1]
    v_pk_fma_f32 v[150:151], v[80:81], v[100:101], v[130:131] op_sel:[0,0,0] op_sel_hi:[1,0,1]
    v_pk_mul_f32 v[142:143], v[142:143], v[112:113]
    v_pk_mul_f32 v[150:151], v[150:151], v[112:113]
    v_cvt_pk_f16_f32 v202, v142, v150
    v_cvt_pk_f16_f32 v203, v143, v151
    ds_write_b64 v121, v[202:203] offset:3072
    v_pk_fma_f32 v[144:145], v[74:75], v[100:101], v[132:133] op_sel:[0,0,0] op_sel_hi:[1,0,1] neg_lo:[0,0,1] neg_hi:[0,0,1]
    v_pk_fma_f32 v[152:153], v[78:79], v[100:101], v[128:129] op_sel:[0,0,0] op_sel_hi:[1,0,1]
    v_pk_mul_f32 v[144:145], v[144:145], v[112:113]
    v_pk_mul_f32 v[152:153], v[152:153], v[112:113]
    v_cvt_pk_f16_f32 v204, v144, v152
    v_cvt_pk_f16_f32 v205, v145, v153
    ds_write_b64 v121, v[204:205] offset:4096
    s_waitcnt lgkmcnt(0)
    s_barrier
    ds_read_b128 v[48:51], v122 offset:0
    ds_read_b128 v[52:55], v122 offset:1024
    ds_read_b128 v[56:59], v122 offset:2048
    s_waitcnt lgkmcnt(2)
    v_mfma_f32_16x16x32_f16 v[60:63], v[104:107], v[48:51], 0
    v_mfma_f32_16x16x32_f16 v[64:67], v[108:111], v[48:51], 0
    s_waitcnt lgkmcnt(1)
    v_mfma_f32_16x16x32_f16 v[68:71], v[104:107], v[52:55], 0
    v_mfma_f32_16x16x32_f16 v[72:75], v[108:111], v[52:55], 0
    s_waitcnt lgkmcnt(0)
    v_mfma_f32_16x16x32_f16 v[76:79], v[104:107], v[56:59], 0
    v_mfma_f32_16x16x32_f16 v[80:83], v[108:111], v[56:59], 0
    s_nop 1
    v_cvt_pk_f16_f32 v124, v60, v64
    v_and_b32 v124, -2, v124
    buffer_store_dword v124, v123, s[28:31], s66 offen offset:0 sc1
    v_cvt_pk_f16_f32 v125, v61, v65
    v_and_b32 v125, -2, v125
    buffer_store_dword v125, v123, s[28:31], s66 offen offset:640 sc1
    v_cvt_pk_f16_f32 v126, v62, v66
    v_and_b32 v126, -2, v126
    buffer_store_dword v126, v123, s[28:31], s66 offen offset:1280 sc1
    v_cvt_pk_f16_f32 v127, v63, v67
    v_and_b32 v127, -2, v127
    buffer_store_dword v127, v123, s[28:31], s66 offen offset:1920 sc1
    v_cvt_pk_f16_f32 v128, v68, v72
    v_and_b32 v128, -2, v128
    buffer_store_dword v128, v123, s[28:31], s66 offen offset:128 sc1
    v_cvt_pk_f16_f32 v129, v69, v73
    v_and_b32 v129, -2, v129
    buffer_store_dword v129, v123, s[28:31], s66 offen offset:768 sc1
    v_cvt_pk_f16_f32 v130, v70, v74
    v_and_b32 v130, -2, v130
    buffer_store_dword v130, v123, s[28:31], s66 offen offset:1408 sc1
    v_cvt_pk_f16_f32 v131, v71, v75
    v_and_b32 v131, -2, v131
    buffer_store_dword v131, v123, s[28:31], s66 offen offset:2048 sc1
    s_nop 1
    s_cmp_eq_u32 s65, 1
    s_cbranch_scc1 Lp1_6
    v_cvt_pk_f16_f32 v132, v76, v80
    v_and_b32 v132, -2, v132
    buffer_store_dword v132, v123, s[28:31], s66 offen offset:256 sc1
    v_cvt_pk_f16_f32 v133, v77, v81
    v_and_b32 v133, -2, v133
    buffer_store_dword v133, v123, s[28:31], s66 offen offset:896 sc1
    v_cvt_pk_f16_f32 v134, v78, v82
    v_and_b32 v134, -2, v134
    buffer_store_dword v134, v123, s[28:31], s66 offen offset:1536 sc1
    v_cvt_pk_f16_f32 v135, v79, v83
    v_and_b32 v135, -2, v135
    buffer_store_dword v135, v123, s[28:31], s66 offen offset:2176 sc1
    s_nop 1
Lp1_6:
    s_waitcnt vmcnt(0)
    buffer_store_dwordx2 v[220:221], v211, s[28:31], s67 offen sc1
    buffer_load_dword v250, v219, s[16:19], s81 offen
    s_add_u32 m0, s75, 0
    s_nop 0
    buffer_load_dwordx4 v206, s[20:23], s72 offen lds
    s_add_u32 m0, s75, 5120
    s_nop 0
    buffer_load_dwordx4 v206, s[20:23], s73 offen lds
    s_add_u32 m0, s75, 1024
    s_nop 0
    buffer_load_dwordx4 v207, s[20:23], s72 offen lds
    s_add_u32 m0, s75, 6144
    s_nop 0
    buffer_load_dwordx4 v207, s[20:23], s73 offen lds
    s_add_u32 m0, s75, 2048
    s_nop 0
    buffer_load_dwordx4 v208, s[20:23], s72 offen lds
    s_add_u32 m0, s75, 7168
    s_nop 0
    buffer_load_dwordx4 v208, s[20:23], s73 offen lds
    s_add_u32 m0, s75, 3072
    s_nop 0
    buffer_load_dwordx4 v209, s[20:23], s72 offen lds
    s_add_u32 m0, s75, 8192
    s_nop 0
    buffer_load_dwordx4 v209, s[20:23], s73 offen lds
    s_add_u32 m0, s75, 4096
    s_nop 0
    buffer_load_dwordx4 v210, s[20:23], s72 offen lds
    s_add_u32 m0, s75, 9216
    s_nop 0
    buffer_load_dwordx4 v210, s[20:23], s73 offen lds
    s_add_u32 m0, s86, 0
    s_add_u32 s88, s85, 0
    buffer_load_dwordx4 v20, s[16:19], s88 offen offset:0 lds
    buffer_load_dwordx4 v21, s[16:19], s88 offen offset:1024 lds
    buffer_load_dwordx4 v22, s[16:19], s88 offen offset:2048 lds
    buffer_load_dwordx4 v23, s[16:19], s88 offen offset:3072 lds
    s_add_u32 m0, s86, 4096
    s_nop 0
    buffer_load_dwordx4 v24, s[16:19], s88 offen offset:0 lds
    buffer_load_dwordx4 v25, s[16:19], s88 offen offset:1024 lds
    buffer_load_dwordx4 v26, s[16:19], s88 offen offset:2048 lds
    s_add_u32 m0, s86, 28672
    s_add_u32 s88, s85, 3456
    buffer_load_dwordx4 v20, s[16:19], s88 offen offset:0 lds
    buffer_load_dwordx4 v21, s[16:19], s88 offen offset:1024 lds
    buffer_load_dwordx4 v22, s[16:19], s88 offen offset:2048 lds
    buffer_load_dwordx4 v23, s[16:19], s88 offen offset:3072 lds
    s_add_u32 m0, s86, 32768
    s_nop 0
    buffer_load_dwordx4 v24, s[16:19], s88 offen offset:0 lds
    buffer_load_dwordx4 v25, s[16:19], s88 offen offset:1024 lds
    buffer_load_dwordx4 v26, s[16:19], s88 offen offset:2048 lds
    s_add_u32 s87, s63, 38912
    buffer_load_dwordx4 a[96:99], v4, s[32:35], s87 offen offset:0
    buffer_load_dwordx4 a[100:103], v4, s[32:35], s87 offen offset:1024
    buffer_load_dwordx4 a[104:107], v4, s[32:35], s87 offen offset:2048
    buffer_load_dwordx4 a[108:111], v4, s[32:35], s87 offen offset:3072
    s_add_u32 s87, s63, 43008
    buffer_load_dwordx4 a[112:115], v4, s[32:35], s87 offen offset:0
    buffer_load_dwordx4 a[116:119], v4, s[32:35], s87 offen offset:1024
    buffer_load_dwordx4 a[120:123], v4, s[32:35], s87 offen offset:2048
    buffer_load_dwordx4 a[124:127], v4, s[32:35], s87 offen offset:3072
    s_lshl_b32 s87, s36, 10
    s_add_u32 s87, s87, 32768
    v_lshlrev_b32 v251, 4, v2
    buffer_load_dwordx4 v[28:31], v251, s[32:35], s87 offen offset:0
    buffer_load_dwordx4 v[32:35], v251, s[32:35], s87 offen offset:256
    buffer_load_dwordx4 v[36:39], v251, s[32:35], s87 offen offset:512
    buffer_load_dwordx4 v[40:43], v251, s[32:35], s87 offen offset:768
    v_lshrrev_b32 v197, 2, v2
    v_and_b32 v198, 1, v2
    v_lshl_add_u32 v197, v197, 1, v198
    s_lshl_b32 s50, s40, 10
    s_add_u32 s50, s50, s39
    v_lshlrev_b32 v197, 7, v197
    v_add_u32 v197, s50, v197
    v_cvt_f32_u32 v197, v197
    v_mul_f32 v197, 0xba000000, v197
    v_bfe_u32 v198, v2, 1, 1
    v_cvt_f32_u32 v198, v198
    v_mul_f32 v198, 0x3e800000, v198
    v_lshlrev_b32 v199, 2, v3
    v_cvt_f32_u32 v199, v199
    v_add_f32 v200, 0x0, v199
    v_fma_f32 v200, v200, v197, v198
    v_cos_f32 v201, v200
    v_sin_f32 v202, v200
    v_mul_f32 v201, 0x3921e89b, v201
    v_mul_f32 v202, 0x3921e89b, v202
    v_cvt_pk_bf16_f32 v44, v201, v202
    v_add_f32 v200, 0x3f800000, v199
    v_fma_f32 v200, v200, v197, v198
    v_cos_f32 v201, v200
    v_sin_f32 v202, v200
    v_mul_f32 v201, 0x3921e89b, v201
    v_mul_f32 v202, 0x3921e89b, v202
    v_cvt_pk_bf16_f32 v45, v201, v202
    v_add_f32 v200, 0x40000000, v199
    v_fma_f32 v200, v200, v197, v198
    v_cos_f32 v201, v200
    v_sin_f32 v202, v200
    v_mul_f32 v201, 0x3921e89b, v201
    v_mul_f32 v202, 0x3921e89b, v202
    v_cvt_pk_bf16_f32 v46, v201, v202
    v_add_f32 v200, 0x40400000, v199
    v_fma_f32 v200, v200, v197, v198
    v_cos_f32 v201, v200
    v_sin_f32 v202, v200
    v_mul_f32 v201, 0x3921e89b, v201
    v_mul_f32 v202, 0x3921e89b, v202
    v_cvt_pk_bf16_f32 v47, v201, v202
    s_mul_i32 s52, s36, 12
    s_add_u32 s52, s52, s42
    s_sub_u32 s52, s52, 20
    s_mul_i32 s53, s41, 28
    s_cmp_lt_u32 s52, 28
    s_cselect_b32 s53, s53, 224
    s_add_u32 s52, s52, s53
    s_lshr_b32 s53, s52, 2
    s_and_b32 s54, s52, 3
    s_mul_i32 s56, s36, 10240
    s_add_u32 s56, s56, 57344
    s_cmp_ge_u32 s52, 224
    s_cbranch_scc1 Lrp_7
    s_mul_i32 s50, s53, 9363
    s_lshr_b32 s50, s50, 16
    s_mul_i32 s50, s50, 7
    s_sub_u32 s50, s53, s50
    s_cmp_eq_u32 s50, 3
    s_cselect_b32 s50, 1280, 0
    s_mul_i32 s51, s50, 3
    s_sub_u32 s51, 5120, s51
    v_lshrrev_b32 v58, 2, v1
    v_mul_u32_u24 v58, 320, v58
    v_and_b32 v59, 3, v1
    v_mul_u32_u24 v59, 40, v59
    v_add3_u32 v58, v58, v59, s56
    v_mad_u32_u24 v58, v3, s50, v58
    v_add_u32 v59, s51, v58
    s_mul_i32 s50, s53, 4682
    s_lshr_b32 s50, s50, 16
    s_mul_i32 s50, s50, 14
    s_sub_u32 s51, s53, s50
    s_lshl_b32 s51, s51, 2
    s_mov_b32 s58, 693225536
    s_mov_b32 s59, 12008870
    s_lshr_b64 s[58:59], s[58:59], s51
    s_and_b32 s58, s58, 15
    s_add_u32 s53, s50, s58
    s_waitcnt vmcnt(26)
    s_mul_i32 s55, s54, 573440
    s_mul_i32 s56, s53, 5120
    s_add_u32 s55, s55, s56
    s_add_u32 s55, s55, 16777216
    ds_read_b64_tr_b16 v[64:65], v58 offset:0
    ds_read_b64_tr_b16 v[66:67], v59 offset:0
    ds_read_b64_tr_b16 v[68:69], v58 offset:8
    ds_read_b64_tr_b16 v[70:71], v59 offset:8
    ds_read_b64_tr_b16 v[72:73], v58 offset:16
    ds_read_b64_tr_b16 v[74:75], v59 offset:16
    ds_read_b64_tr_b16 v[76:77], v58 offset:24
    ds_read_b64_tr_b16 v[78:79], v59 offset:24
    ds_read_b64_tr_b16 v[80:81], v58 offset:32
    ds_read_b64_tr_b16 v[82:83], v59 offset:32
    ds_read_b64_tr_b16 v[84:85], v58 offset:160
    ds_read_b64_tr_b16 v[86:87], v59 offset:160
    ds_read_b64_tr_b16 v[88:89], v58 offset:168
    ds_read_b64_tr_b16 v[90:91], v59 offset:168
    ds_read_b64_tr_b16 v[92:93], v58 offset:176
    ds_read_b64_tr_b16 v[94:95], v59 offset:176
    ds_read_b64_tr_b16 v[96:97], v58 offset:184
    ds_read_b64_tr_b16 v[98:99], v59 offset:184
    ds_read_b64_tr_b16 v[100:101], v58 offset:192
    ds_read_b64_tr_b16 v[102:103], v59 offset:192
    s_add_u32 s56, s55, 0
    s_waitcnt lgkmcnt(15)
    buffer_store_dwordx4 v[64:67], v4, s[28:31], s56 offen offset:0 sc1
    buffer_store_dwordx4 v[68:71], v4, s[28:31], s56 offen offset:1024 sc1
    s_waitcnt lgkmcnt(14)
    buffer_store_dwordx4 v[72:75], v4, s[28:31], s56 offen offset:2048 sc1
    s_waitcnt lgkmcnt(12)
    buffer_store_dwordx4 v[76:79], v4, s[28:31], s56 offen offset:3072 sc1
    s_add_u32 s56, s55, 4096
    s_waitcnt lgkmcnt(10)
    buffer_store_dwordx4 v[80:83], v4, s[28:31], s56 offen offset:0 sc1
    s_add_u32 s56, s55, 286720
    s_waitcnt lgkmcnt(8)
    buffer_store_dwordx4 v[84:87], v4, s[28:31], s56 offen offset:0 sc1
    s_waitcnt lgkmcnt(6)
    buffer_store_dwordx4 v[88:91], v4, s[28:31], s56 offen offset:1024 sc1
    s_waitcnt lgkmcnt(4)
    buffer_store_dwordx4 v[92:95], v4, s[28:31], s56 offen offset:2048 sc1
    s_waitcnt lgkmcnt(2)
    buffer_store_dwordx4 v[96:99], v4, s[28:31], s56 offen offset:3072 sc1
    s_add_u32 s56, s55, 290816
    s_waitcnt lgkmcnt(0)
    buffer_store_dwordx4 v[100:103], v4, s[28:31], s56 offen offset:0 sc1
    s_nop 1
Lrp_7:
    s_sub_u32 s50, s2, 160
    s_mul_i32 s54, s50, 10923
    s_lshr_b32 s54, s54, 16
    s_mul_i32 s51, s54, 6
    s_sub_u32 s50, s50, s51
    s_lshl2_add_u32 s50, s50, s36
    s_mul_i32 s54, s54, 503808
    s_add_u32 s54, s54, 20480
    s_add_u32 s51, s50, 0
    s_mul_i32 s52, s51, 6554
    s_lshr_b32 s52, s52, 16
    s_mul_i32 s52, s52, 21248
    s_lshl_b32 s53, s51, 10
    s_add_u32 s52, s52, s53
    s_add_u32 s52, s52, s54
    buffer_store_dwordx4 v[244:247], v4, s[28:31], s52 offen sc1
    s_add_u32 s51, s50, 24
    s_mul_i32 s52, s51, 6554
    s_lshr_b32 s52, s52, 16
    s_mul_i32 s52, s52, 21248
    s_lshl_b32 s53, s51, 10
    s_add_u32 s52, s52, s53
    s_add_u32 s52, s52, s54
    buffer_store_dwordx4 v[244:247], v4, s[28:31], s52 offen sc1
    s_add_u32 s51, s50, 48
    s_mul_i32 s52, s51, 6554
    s_lshr_b32 s52, s52, 16
    s_mul_i32 s52, s52, 21248
    s_lshl_b32 s53, s51, 10
    s_add_u32 s52, s52, s53
    s_add_u32 s52, s52, s54
    buffer_store_dwordx4 v[244:247], v4, s[28:31], s52 offen sc1
    s_add_u32 s51, s50, 72
    s_mul_i32 s52, s51, 6554
    s_lshr_b32 s52, s52, 16
    s_mul_i32 s52, s52, 21248
    s_lshl_b32 s53, s51, 10
    s_add_u32 s52, s52, s53
    s_add_u32 s52, s52, s54
    buffer_store_dwordx4 v[244:247], v4, s[28:31], s52 offen sc1
    s_add_u32 s51, s50, 96
    s_mul_i32 s52, s51, 6554
    s_lshr_b32 s52, s52, 16
    s_mul_i32 s52, s52, 21248
    s_lshl_b32 s53, s51, 10
    s_add_u32 s52, s52, s53
    s_add_u32 s52, s52, s54
    buffer_store_dwordx4 v[244:247], v4, s[28:31], s52 offen sc1
    s_add_u32 s51, s50, 120
    s_mul_i32 s52, s51, 6554
    s_lshr_b32 s52, s52, 16
    s_mul_i32 s52, s52, 21248
    s_lshl_b32 s53, s51, 10
    s_add_u32 s52, s52, s53
    s_add_u32 s52, s52, s54
    buffer_store_dwordx4 v[244:247], v4, s[28:31], s52 offen sc1
    s_add_u32 s51, s50, 144
    s_mul_i32 s52, s51, 6554
    s_lshr_b32 s52, s52, 16
    s_mul_i32 s52, s52, 21248
    s_lshl_b32 s53, s51, 10
    s_add_u32 s52, s52, s53
    s_add_u32 s52, s52, s54
    s_cmp_lt_u32 s51, 160
    s_cselect_b32 s52, s52, 33554432
    buffer_store_dwordx4 v[244:247], v4, s[28:31], s52 offen sc1
    s_lshl_b32 s64, s2, 7
    s_add_u32 s64, s64, 19988480
    s_waitcnt vmcnt(0)
    s_barrier
    s_cmp_lg_u32 s36, 0
    s_cbranch_scc1 Lsig_8
    buffer_store_dwordx2 v[220:221], v211, s[28:31], s64 offen sc1
Lsig_8:
    s_add_u32 m0, s86, 57344
    s_add_u32 s88, s85, 6912
    buffer_load_dwordx4 v20, s[16:19], s88 offen offset:0 lds
    buffer_load_dwordx4 v21, s[16:19], s88 offen offset:1024 lds
    buffer_load_dwordx4 v22, s[16:19], s88 offen offset:2048 lds
    buffer_load_dwordx4 v23, s[16:19], s88 offen offset:3072 lds
    s_add_u32 m0, s86, 61440
    s_nop 0
    buffer_load_dwordx4 v24, s[16:19], s88 offen offset:0 lds
    buffer_load_dwordx4 v25, s[16:19], s88 offen offset:1024 lds
    buffer_load_dwordx4 v26, s[16:19], s88 offen offset:2048 lds
    s_add_u32 m0, s86, 86016
    s_add_u32 s88, s85, 10368
    buffer_load_dwordx4 v20, s[16:19], s88 offen offset:0 lds
    buffer_load_dwordx4 v21, s[16:19], s88 offen offset:1024 lds
    buffer_load_dwordx4 v22, s[16:19], s88 offen offset:2048 lds
    buffer_load_dwordx4 v23, s[16:19], s88 offen offset:3072 lds
    s_add_u32 m0, s86, 90112
    s_nop 0
    buffer_load_dwordx4 v24, s[16:19], s88 offen offset:0 lds
    buffer_load_dwordx4 v25, s[16:19], s88 offen offset:1024 lds
    buffer_load_dwordx4 v26, s[16:19], s88 offen offset:2048 lds
    s_add_u32 m0, s86, 114688
    s_add_u32 s88, s85, 13824
    buffer_load_dwordx4 v20, s[16:19], s88 offen offset:0 lds
    buffer_load_dwordx4 v21, s[16:19], s88 offen offset:1024 lds
    buffer_load_dwordx4 v22, s[16:19], s88 offen offset:2048 lds
    buffer_load_dwordx4 v23, s[16:19], s88 offen offset:3072 lds
    s_add_u32 m0, s86, 118784
    s_nop 0
    buffer_load_dwordx4 v24, s[16:19], s88 offen offset:0 lds
    buffer_load_dwordx4 v25, s[16:19], s88 offen offset:1024 lds
    buffer_load_dwordx4 v26, s[16:19], s88 offen offset:2048 lds
    s_and_b32 s82, s38, 7
    s_lshr_b32 s82, s82, 1
    v_lshrrev_b32 v254, 1, v1
    v_lshl_add_u32 v254, v254, 2, s82
    v_subrev_u32 v7, 12, v254
    v_min_u32 v254, v254, v7
    v_subrev_u32 v7, 12, v254
    v_min_u32 v254, v254, v7
    v_and_b32 v7, 1, v1
    v_lshl_add_u32 v254, v254, 3, v7
    v_lshl_add_u32 v254, s36, 1, v254
    s_mul_i32 s82, s37, 6
    s_sub_u32 s82, s82, 14
    v_add_u32 v7, s82, v1
    v_cmp_gt_u32 vcc, 14, v1
    s_nop 1
    v_cndmask_b32 v254, v7, v254, vcc
    v_add_u32 v254, 672, v254
    s_lshl1_add_u32 s82, s39, s40
    s_xor_b32 s82, s82, 1
    v_and_b32 v7, 3, v1
    v_lshl_add_u32 v7, s82, 2, v7
    v_lshlrev_b32 v254, 1, v254
    v_cmp_gt_u32 vcc, 20, v1
    s_nop 1
    v_cndmask_b32 v254, v7, v254, vcc
    v_lshlrev_b32 v254, 6, v254
    s_mov_b32 s82, 19922944
    s_mul_i32 s50, s41, 98304
    s_add_u32 s82, s82, s50
    buffer_load_dword v248, v254, s[28:31], s82 offen sc1
    s_waitcnt vmcnt(0)
    v_cmp_ne_u32 vcc, s62, v248
    s_nop 0
    s_cbranch_vccz Lok_10
Lfix_9:
    s_add_i32 s49, s49, -1
    s_cmp_lt_i32 s49, 0
    s_cbranch_scc1 Lok_10
    buffer_load_dword v248, v254, s[28:31], s82 offen sc1
    s_waitcnt vmcnt(0)
    v_cmp_ne_u32 vcc, s62, v248
    s_nop 0
    s_cbranch_vccnz Lfix_9
Lok_10:
    s_nop 2
L_join2:
    v_mov_b32 v56, 0
    v_mov_b32 v57, 0
    v_mov_b32 v58, 0
    v_mov_b32 v59, 0
    v_min_u32 v55, 143, v0
    v_lshlrev_b32 v55, 4, v55
    v_add_u32 v55, 154880, v55
    v_mul_u32_u24 v48, 2560, v3
    v_lshl_add_u32 v48, v2, 2, v48
    s_lshr_b32 s52, s36, 1
    s_lshl1_add_u32 s52, s39, s52
    s_mul_i32 s52, s52, 31488
    s_and_b32 s53, s36, 1
    s_lshl_b32 s53, s53, 6
    s_add_u32 s64, s52, s53
    s_add_u32 s64, s64, 0
    s_and_b32 s50, s38, 7
    s_mul_i32 s84, s50, 286720
    s_mul_i32 s50, s36, 71680
    s_add_u32 s84, s84, s50
    s_add_u32 s84, s84, 16777216
    s_barrier
    ds_write_b128 v55, v[56:59]
    v_mul_u32_u24 v49, 576, v3
    v_lshl_add_u32 v49, v2, 2, v49
    s_lshl_b32 s54, s36, 6
    s_add_u32 s54, s54, 143360
    v_add_u32 v49, s54, v49
    v_mul_u32_u24 v50, 288, v2
    v_lshl_add_u32 v50, v3, 4, v50
    v_add_u32 v50, 143360, v50
    v_and_b32 v52, 7, v2
    v_lshlrev_b32 v52, 5, v52
    v_add_u32 v52, 157184, v52
    s_lshl_b32 s54, s36, 3
    v_add_u32 v51, s54, v52
    v_and_b32 v53, 7, v2
    v_lshlrev_b32 v53, 4, v53
    v_lshl_add_u32 v53, v3, 7, v53
    v_lshrrev_b32 v55, 3, v2
    v_lshl_add_u32 v54, v55, 30, v53
    s_mov_b32 s54, 31488
    v_mad_u32_u24 v227, v55, s54, v53
    v_add_u32 v228, 62976, v227
    v_lshl_add_u32 v53, v55, 11, v53
    s_lshl_b32 s55, s36, 9
    s_add_u32 s54, s101, s55
    s_add_u32 s65, s54, 20480
    s_add_u32 s66, s54, 24576
    s_add_u32 s67, s54, 28672
    v_lshlrev_b32 v60, 16, v8
    v_and_b32 v61, 0xffff0000, v8
    v_lshlrev_b32 v62, 16, v9
    v_and_b32 v63, 0xffff0000, v9
    v_lshlrev_b32 v64, 16, v10
    v_and_b32 v65, 0xffff0000, v10
    v_lshlrev_b32 v66, 16, v11
    v_and_b32 v67, 0xffff0000, v11
    v_lshlrev_b32 v68, 16, v12
    v_and_b32 v69, 0xffff0000, v12
    v_lshlrev_b32 v70, 16, v13
    v_and_b32 v71, 0xffff0000, v13
    v_lshlrev_b32 v72, 16, v14
    v_and_b32 v73, 0xffff0000, v14
    v_lshlrev_b32 v74, 16, v15
    v_and_b32 v75, 0xffff0000, v15
    v_lshlrev_b32 v76, 16, v16
    v_and_b32 v77, 0xffff0000, v16
    v_lshlrev_b32 v78, 16, v17
    v_and_b32 v79, 0xffff0000, v17
    v_lshlrev_b32 v80, 16, v18
    v_and_b32 v81, 0xffff0000, v18
    v_lshlrev_b32 v82, 16, v19
    v_and_b32 v83, 0xffff0000, v19
    v_mov_b32 v55, 0x3f803f80
    v_cvt_pk_bf16_f32 v27, -v27, -v27
    v_lshlrev_b32 v27, 16, v27
    buffer_load_dword v92, v48, s[28:31], s64 offen offset:256 sc1
    buffer_load_dword v93, v48, s[28:31], s64 offen offset:896 sc1
    buffer_load_dword v94, v48, s[28:31], s64 offen offset:1536 sc1
    buffer_load_dword v95, v48, s[28:31], s64 offen offset:2176 sc1
    buffer_load_dword v96, v48, s[28:31], s64 offen offset:384 sc1
    buffer_load_dword v97, v48, s[28:31], s64 offen offset:1024 sc1
    buffer_load_dword v98, v48, s[28:31], s64 offen offset:1664 sc1
    buffer_load_dword v99, v48, s[28:31], s64 offen offset:2304 sc1
    buffer_load_dword v88, v48, s[28:31], s64 offen offset:128 sc1
    buffer_load_dword v89, v48, s[28:31], s64 offen offset:768 sc1
    buffer_load_dword v90, v48, s[28:31], s64 offen offset:1408 sc1
    buffer_load_dword v91, v48, s[28:31], s64 offen offset:2048 sc1
    buffer_load_dword v100, v48, s[28:31], s64 offen offset:512 sc1
    buffer_load_dword v101, v48, s[28:31], s64 offen offset:1152 sc1
    buffer_load_dword v102, v48, s[28:31], s64 offen offset:1792 sc1
    buffer_load_dword v103, v48, s[28:31], s64 offen offset:2432 sc1
    buffer_load_dword v84, v48, s[28:31], s64 offen offset:0 sc1
    buffer_load_dword v85, v48, s[28:31], s64 offen offset:640 sc1
    buffer_load_dword v86, v48, s[28:31], s64 offen offset:1280 sc1
    buffer_load_dword v87, v48, s[28:31], s64 offen offset:1920 sc1
    v_lshrrev_b32 v224, 2, v1
    v_mul_u32_u24 v224, 224, v224
    v_and_b32 v225, 3, v1
    v_lshl_add_u32 v224, v225, 3, v224
    s_add_u32 s87, s84, 0
    buffer_load_dwordx4 a[128:131], v4, s[28:31], s87 offen offset:0 sc1
    s_xor_b32 s52, s40, 1
    s_mul_i32 s52, s52, 192
    v_add_u32 v252, s52, v224
    s_lshl_b32 s52, s40, 5
    buffer_load_dwordx4 a[132:135], v4, s[28:31], s87 offen offset:1024 sc1
    v_add_u32 v224, s52, v224
    v_add_u32 v225, 57344, v224
    v_add_u32 v253, 57344, v252
    v_add_u32 v226, 114688, v224
    buffer_load_dwordx4 a[136:139], v4, s[28:31], s87 offen offset:2048 sc1
    v_add_u32 v254, 114688, v252
    s_lshl2_add_u32 s52, s37, s36
    s_mul_i32 s52, s52, 125952
    s_add_u32 s68, s52, 20480
    buffer_load_dwordx4 a[140:143], v4, s[28:31], s87 offen offset:3072 sc1
    s_add_u32 s69, s52, 24576
    s_add_u32 s70, s52, 28672
    s_mul_i32 s52, s37, 458752
    s_mul_i32 s53, s36, 114688
    s_add_u32 s87, s84, 4096
    buffer_load_dwordx4 a[144:147], v4, s[28:31], s87 offen offset:0 sc1
    s_add_u32 s52, s52, s53
    s_lshr_b32 s53, s38, 1
    s_mul_i32 s53, s53, 7168
    s_add_u32 s52, s52, s53
    s_add_u32 s52, s52, 8388608
    s_lshl_b32 s53, s40, 12
    s_add_u32 s60, s53, s52
    s_add_u32 s61, s60, 57344
    s_lshl_b32 s53, s40, 9
    s_add_u32 s100, s53, s52
    v_and_b32 v229, 1, v3
    v_mul_u32_u24 v229, 57344, v229
    v_lshrrev_b32 v7, 1, v3
    v_lshl_add_u32 v229, v7, 8, v229
    v_lshl_add_u32 v229, v2, 4, v229
    s_lshr_b32 s55, s38, 1
    s_and_b32 s55, s55, 4
    s_lshl3_add_u32 s55, s37, s55
    s_mul_i32 s53, s36, 14336
    s_add_u32 s52, s36, 1
    s_and_b32 s52, s52, 3
    s_add_u32 s52, s52, s55
    s_mul_i32 s52, s52, 57344
    s_add_u32 s52, s52, s53
    s_add_u32 s72, s52, 8388608
    s_add_u32 s73, s52, 8392704
    s_add_u32 s74, s52, 8396800
    s_add_u32 s75, s52, 8400896
    s_add_u32 s52, s36, 2
    s_and_b32 s52, s52, 3
    s_add_u32 s52, s52, s55
    s_mul_i32 s52, s52, 57344
    s_add_u32 s52, s52, s53
    s_add_u32 s76, s52, 8388608
    s_add_u32 s77, s52, 8392704
    s_add_u32 s78, s52, 8396800
    s_add_u32 s79, s52, 8400896
    s_add_u32 s52, s36, 3
    s_and_b32 s52, s52, 3
    s_add_u32 s52, s52, s55
    s_mul_i32 s52, s52, 57344
    s_add_u32 s52, s52, s53
    s_add_u32 s80, s52, 8388608
    s_add_u32 s81, s52, 8392704
    s_add_u32 s82, s52, 8396800
    s_add_u32 s83, s52, 8400896
    s_waitcnt vmcnt(23)
    v_bitop3_b32 v104, 1, v92, v93 bitop3:0x80
    s_waitcnt vmcnt(21)
    v_bitop3_b32 v104, v104, v94, v95 bitop3:0x80
    s_waitcnt vmcnt(19)
    v_bitop3_b32 v104, v104, v96, v97 bitop3:0x80
    s_waitcnt vmcnt(17)
    v_bitop3_b32 v104, v104, v98, v99 bitop3:0x80
    s_waitcnt vmcnt(15)
    v_bitop3_b32 v104, v104, v88, v89 bitop3:0x80
    s_waitcnt vmcnt(13)
    v_bitop3_b32 v104, v104, v90, v91 bitop3:0x80
    s_waitcnt vmcnt(11)
    v_bitop3_b32 v104, v104, v100, v101 bitop3:0x80
    s_waitcnt vmcnt(9)
    v_bitop3_b32 v104, v104, v102, v103 bitop3:0x80
    s_waitcnt vmcnt(7)
    v_bitop3_b32 v104, v104, v84, v85 bitop3:0x80
    s_waitcnt vmcnt(5)
    v_bitop3_b32 v104, v104, v86, v87 bitop3:0x80
    v_cmp_eq_u32 vcc, 0, v104
    s_nop 0
    s_cbranch_vccz Lok_12
Lfix_11:
    s_add_i32 s49, s49, -1
    s_cmp_lt_i32 s49, 0
    s_cbranch_scc1 Lok_12
    buffer_load_dword v92, v48, s[28:31], s64 offen offset:256 sc1
    buffer_load_dword v93, v48, s[28:31], s64 offen offset:896 sc1
    buffer_load_dword v94, v48, s[28:31], s64 offen offset:1536 sc1
    buffer_load_dword v95, v48, s[28:31], s64 offen offset:2176 sc1
    buffer_load_dword v96, v48, s[28:31], s64 offen offset:384 sc1
    buffer_load_dword v97, v48, s[28:31], s64 offen offset:1024 sc1
    buffer_load_dword v98, v48, s[28:31], s64 offen offset:1664 sc1
    buffer_load_dword v99, v48, s[28:31], s64 offen offset:2304 sc1
    buffer_load_dword v88, v48, s[28:31], s64 offen offset:128 sc1
    buffer_load_dword v89, v48, s[28:31], s64 offen offset:768 sc1
    buffer_load_dword v90, v48, s[28:31], s64 offen offset:1408 sc1
    buffer_load_dword v91, v48, s[28:31], s64 offen offset:2048 sc1
    buffer_load_dword v100, v48, s[28:31], s64 offen offset:512 sc1
    buffer_load_dword v101, v48, s[28:31], s64 offen offset:1152 sc1
    buffer_load_dword v102, v48, s[28:31], s64 offen offset:1792 sc1
    buffer_load_dword v103, v48, s[28:31], s64 offen offset:2432 sc1
    buffer_load_dword v84, v48, s[28:31], s64 offen offset:0 sc1
    buffer_load_dword v85, v48, s[28:31], s64 offen offset:640 sc1
    buffer_load_dword v86, v48, s[28:31], s64 offen offset:1280 sc1
    buffer_load_dword v87, v48, s[28:31], s64 offen offset:1920 sc1
    s_waitcnt vmcnt(0)
    v_bitop3_b32 v104, 1, v92, v93 bitop3:0x80
    v_bitop3_b32 v104, v104, v94, v95 bitop3:0x80
    v_bitop3_b32 v104, v104, v96, v97 bitop3:0x80
    v_bitop3_b32 v104, v104, v98, v99 bitop3:0x80
    v_bitop3_b32 v104, v104, v88, v89 bitop3:0x80
    v_bitop3_b32 v104, v104, v90, v91 bitop3:0x80
    v_bitop3_b32 v104, v104, v100, v101 bitop3:0x80
    v_bitop3_b32 v104, v104, v102, v103 bitop3:0x80
    v_bitop3_b32 v104, v104, v84, v85 bitop3:0x80
    v_bitop3_b32 v104, v104, v86, v87 bitop3:0x80
    v_cmp_eq_u32 vcc, 0, v104
    s_nop 0
    s_cbranch_vccnz Lfix_11
Lok_12:
    v_mfma_f32_16x16x32_bf16 v[112:115], v[44:47], v[92:95], 0
    v_mfma_f32_16x16x32_bf16 v[116:119], v[44:47], v[96:99], 0
    v_mfma_f32_16x16x32_bf16 v[108:111], v[44:47], v[88:91], 0
    v_mfma_f32_16x16x32_bf16 v[120:123], v[44:47], v[100:103], 0
    v_mfma_f32_16x16x32_bf16 v[104:107], v[44:47], v[84:87], 0
    s_nop 4
    v_pk_fma_f32 v[136:137], v[116:117], v[40:41], v[112:113] op_sel:[0,0,0] op_sel_hi:[1,0,1]
    v_pk_fma_f32 v[138:139], v[112:113], v[40:41], v[116:117] op_sel:[0,0,0] op_sel_hi:[1,0,1] neg_lo:[0,0,1] neg_hi:[0,0,1]
    v_pk_fma_f32 v[140:141], v[114:115], v[40:41], v[118:119] op_sel:[0,0,0] op_sel_hi:[1,0,1]
    v_pk_fma_f32 v[142:143], v[118:119], v[40:41], v[114:115] op_sel:[0,0,0] op_sel_hi:[1,0,1] neg_lo:[0,0,1] neg_hi:[0,0,1]
    buffer_load_dwordx4 a[148:151], v4, s[28:31], s87 offen offset:1024 sc1
    v_pk_fma_f32 v[128:129], v[120:121], v[40:41], v[108:109] op_sel:[0,0,0] op_sel_hi:[1,0,1]
    v_pk_fma_f32 v[130:131], v[108:109], v[40:41], v[120:121] op_sel:[0,0,0] op_sel_hi:[1,0,1] neg_lo:[0,0,1] neg_hi:[0,0,1]
    v_pk_fma_f32 v[132:133], v[110:111], v[40:41], v[122:123] op_sel:[0,0,0] op_sel_hi:[1,0,1]
    v_pk_fma_f32 v[134:135], v[122:123], v[40:41], v[110:111] op_sel:[0,0,0] op_sel_hi:[1,0,1] neg_lo:[0,0,1] neg_hi:[0,0,1]
    v_pk_mul_f32 v[124:125], v[104:105], v[40:41] op_sel:[0,0] op_sel_hi:[1,0]
    v_pk_mul_f32 v[126:127], v[106:107], v[40:41] op_sel:[0,1] op_sel_hi:[1,1]
    v_pk_fma_f32 v[144:145], v[128:129], s[44:45], v[124:125] op_sel:[0,0,0] op_sel_hi:[1,0,1]
    v_pk_fma_f32 v[146:147], v[128:129], s[44:45], v[124:125] op_sel:[0,1,0] op_sel_hi:[1,1,1]
    v_pk_mul_f32 v[148:149], v[134:135], s[46:47] op_sel:[0,0] op_sel_hi:[1,0]
    buffer_load_dwordx4 a[152:155], v4, s[28:31], s87 offen offset:2048 sc1
    v_pk_mul_f32 v[150:151], v[134:135], s[46:47] op_sel:[0,1] op_sel_hi:[1,1]
    v_pk_add_f32 v[152:153], v[124:125], v[128:129]
    v_pk_fma_f32 v[144:145], v[136:137], s[44:45], v[144:145] op_sel:[0,1,0] op_sel_hi:[1,1,1]
    v_pk_fma_f32 v[146:147], v[136:137], s[44:45], v[146:147] op_sel:[0,0,0] op_sel_hi:[1,0,1]
    v_pk_fma_f32 v[148:149], v[142:143], s[46:47], v[148:149] op_sel:[0,1,0] op_sel_hi:[1,1,1]
    v_pk_fma_f32 v[150:151], v[142:143], s[46:47], v[150:151] op_sel:[0,0,0] op_sel_hi:[1,0,1] neg_lo:[0,1,0] neg_hi:[0,1,0]
    v_pk_add_f32 v[152:153], v[152:153], v[136:137]
    v_pk_add_f32 v[154:155], v[144:145], v[148:149]
    v_pk_add_f32 v[156:157], v[146:147], v[150:151]
    buffer_load_dwordx4 a[156:159], v4, s[28:31], s87 offen offset:3072 sc1
    v_pk_add_f32 v[158:159], v[146:147], v[150:151] neg_lo:[0,1] neg_hi:[0,1]
    v_pk_add_f32 v[160:161], v[144:145], v[148:149] neg_lo:[0,1] neg_hi:[0,1]
    v_pk_fma_f32 v[162:163], v[132:133], s[44:45], v[126:127] op_sel:[0,0,0] op_sel_hi:[1,0,1]
    v_pk_fma_f32 v[164:165], v[132:133], s[44:45], v[126:127] op_sel:[0,1,0] op_sel_hi:[1,1,1]
    v_pk_mul_f32 v[166:167], v[130:131], s[46:47] op_sel:[0,0] op_sel_hi:[1,0]
    v_pk_mul_f32 v[168:169], v[130:131], s[46:47] op_sel:[0,1] op_sel_hi:[1,1]
    v_pk_add_f32 v[170:171], v[126:127], v[132:133]
    v_pk_fma_f32 v[162:163], v[140:141], s[44:45], v[162:163] op_sel:[0,1,0] op_sel_hi:[1,1,1]
    v_pk_fma_f32 v[164:165], v[140:141], s[44:45], v[164:165] op_sel:[0,0,0] op_sel_hi:[1,0,1]
    s_add_u32 s87, s84, 8192
    buffer_load_dwordx4 a[160:163], v4, s[28:31], s87 offen offset:0 sc1
    v_pk_fma_f32 v[166:167], v[138:139], s[46:47], v[166:167] op_sel:[0,1,0] op_sel_hi:[1,1,1]
    v_pk_fma_f32 v[168:169], v[138:139], s[46:47], v[168:169] op_sel:[0,0,0] op_sel_hi:[1,0,1] neg_lo:[0,1,0] neg_hi:[0,1,0]
    v_pk_add_f32 v[170:171], v[170:171], v[140:141]
    v_pk_add_f32 v[172:173], v[162:163], v[166:167]
    v_pk_add_f32 v[174:175], v[164:165], v[168:169]
    v_pk_add_f32 v[176:177], v[164:165], v[168:169] neg_lo:[0,1] neg_hi:[0,1]
    v_pk_add_f32 v[178:179], v[162:163], v[166:167] neg_lo:[0,1] neg_hi:[0,1]
    v_cvt_pk_bf16_f32 v84, v152, v170
    v_cvt_pk_bf16_f32 v85, v153, v171
    buffer_load_dwordx4 a[164:167], v4, s[28:31], s87 offen offset:1024 sc1
    ds_write_b32 v49, v84 offset:0
    ds_write_b32 v49, v85 offset:288
    v_pk_mul_f32 v[180:181], v[154:155], v[28:29] op_sel:[0,0] op_sel_hi:[1,0]
    v_pk_mul_f32 v[188:189], v[172:173], v[36:37] op_sel:[0,0] op_sel_hi:[1,0]
    v_pk_fma_f32 v[180:181], v[172:173], v[32:33], v[180:181] op_sel:[0,0,0] op_sel_hi:[1,0,1] neg_lo:[0,1,0] neg_hi:[0,1,0]
    v_pk_fma_f32 v[188:189], v[154:155], v[32:33], v[188:189] op_sel:[0,0,0] op_sel_hi:[1,0,1]
    v_cvt_pk_bf16_f32 v86, v180, v188
    v_cvt_pk_bf16_f32 v87, v181, v189
    ds_write_b32 v49, v86 offset:2304
    buffer_load_dwordx4 a[168:171], v4, s[28:31], s87 offen offset:2048 sc1
    ds_write_b32 v49, v87 offset:2592
    v_pk_mul_f32 v[182:183], v[156:157], v[28:29] op_sel:[0,1] op_sel_hi:[1,1]
    v_pk_mul_f32 v[190:191], v[174:175], v[36:37] op_sel:[0,1] op_sel_hi:[1,1]
    v_pk_fma_f32 v[182:183], v[174:175], v[32:33], v[182:183] op_sel:[0,1,0] op_sel_hi:[1,1,1] neg_lo:[0,1,0] neg_hi:[0,1,0]
    v_pk_fma_f32 v[190:191], v[156:157], v[32:33], v[190:191] op_sel:[0,1,0] op_sel_hi:[1,1,1]
    v_cvt_pk_bf16_f32 v88, v182, v190
    v_cvt_pk_bf16_f32 v89, v183, v191
    ds_write_b32 v49, v88 offset:4608
    ds_write_b32 v49, v89 offset:4896
    buffer_load_dwordx4 a[172:175], v4, s[28:31], s87 offen offset:3072 sc1
    v_pk_mul_f32 v[184:185], v[158:159], v[30:31] op_sel:[0,0] op_sel_hi:[1,0]
    v_pk_mul_f32 v[192:193], v[176:177], v[38:39] op_sel:[0,0] op_sel_hi:[1,0]
    v_pk_fma_f32 v[184:185], v[176:177], v[34:35], v[184:185] op_sel:[0,0,0] op_sel_hi:[1,0,1] neg_lo:[0,1,0] neg_hi:[0,1,0]
    v_pk_fma_f32 v[192:193], v[158:159], v[34:35], v[192:193] op_sel:[0,0,0] op_sel_hi:[1,0,1]
    v_cvt_pk_bf16_f32 v90, v184, v192
    v_cvt_pk_bf16_f32 v91, v185, v193
    ds_write_b32 v49, v90 offset:6912
    ds_write_b32 v49, v91 offset:7200
    v_pk_mul_f32 v[186:187], v[160:161], v[30:31] op_sel:[0,1] op_sel_hi:[1,1]
    s_add_u32 s87, s84, 12288
    buffer_load_dwordx4 a[176:179], v4, s[28:31], s87 offen offset:0 sc1
    v_pk_mul_f32 v[194:195], v[178:179], v[38:39] op_sel:[0,1] op_sel_hi:[1,1]
    v_pk_fma_f32 v[186:187], v[178:179], v[34:35], v[186:187] op_sel:[0,1,0] op_sel_hi:[1,1,1] neg_lo:[0,1,0] neg_hi:[0,1,0]
    v_pk_fma_f32 v[194:195], v[160:161], v[34:35], v[194:195] op_sel:[0,1,0] op_sel_hi:[1,1,1]
    v_cvt_pk_bf16_f32 v92, v186, v194
    v_cvt_pk_bf16_f32 v93, v187, v195
    ds_write_b32 v49, v92 offset:9216
    ds_write_b32 v49, v93 offset:9504
    s_mov_b32 s44, 0x3f80
    s_mov_b32 s45, 0x3f800000
    buffer_load_dwordx4 a[180:183], v4, s[28:31], s87 offen offset:1024 sc1
    s_waitcnt lgkmcnt(0)
    s_barrier
    ds_read_b128 v[124:127], v50 offset:0
    ds_read_b128 v[128:131], v50 offset:64
    ds_read_b128 v[132:135], v50 offset:128
    ds_read_b128 v[136:139], v50 offset:192
    ds_read_b128 v[140:143], v50 offset:4608
    ds_read_b128 v[144:147], v50 offset:4672
    ds_read_b128 v[148:151], v50 offset:4736
    ds_read_b128 v[152:155], v50 offset:4800
    buffer_load_dwordx4 a[184:187], v4, s[28:31], s87 offen offset:2048 sc1
    ds_read_b128 v[156:159], v50 offset:9216
    ds_read_b128 v[160:163], v50 offset:9280
    ds_read_b128 v[164:167], v50 offset:9344
    ds_read_b128 v[168:171], v50 offset:9408
    s_waitcnt lgkmcnt(11)
    v_mfma_f32_16x16x32_bf16 v[172:175], a[96:99], v[124:127], v[60:63]
    v_mfma_f32_16x16x32_bf16 v[176:179], a[112:115], v[124:127], v[64:67]
    s_waitcnt lgkmcnt(10)
    v_mfma_f32_16x16x32_bf16 v[172:175], a[100:103], v[128:131], v[172:175]
    v_mfma_f32_16x16x32_bf16 v[176:179], a[116:119], v[128:131], v[176:179]
    s_waitcnt lgkmcnt(9)
    v_mfma_f32_16x16x32_bf16 v[172:175], a[104:107], v[132:135], v[172:175]
    v_mfma_f32_16x16x32_bf16 v[176:179], a[120:123], v[132:135], v[176:179]
    s_waitcnt lgkmcnt(8)
    v_mfma_f32_16x16x32_bf16 v[172:175], a[108:111], v[136:139], v[172:175]
    v_mfma_f32_16x16x32_bf16 v[176:179], a[124:127], v[136:139], v[176:179]
    s_waitcnt lgkmcnt(7)
    v_mfma_f32_16x16x32_bf16 v[180:183], a[96:99], v[140:143], v[68:71]
    v_mfma_f32_16x16x32_bf16 v[184:187], a[112:115], v[140:143], v[72:75]
    s_waitcnt lgkmcnt(6)
    v_mfma_f32_16x16x32_bf16 v[180:183], a[100:103], v[144:147], v[180:183]
    s_nop 1
    v_cvt_pk_bf16_f32 v84, v172, v173
    v_cvt_pk_bf16_f32 v85, v174, v175
    v_cvt_pk_bf16_f32 v86, v176, v177
    v_mfma_f32_16x16x32_bf16 v[184:187], a[116:119], v[144:147], v[184:187]
    v_cvt_pk_bf16_f32 v87, v178, v179
    v_dot2_f32_bf16 v172, v84, s44, v27
    v_dot2_f32_bf16 v173, v84, s45, v27
    s_waitcnt lgkmcnt(5)
    v_mfma_f32_16x16x32_bf16 v[180:183], a[104:107], v[148:151], v[180:183]
    v_dot2_f32_bf16 v174, v85, s44, v27
    v_dot2_f32_bf16 v175, v85, s45, v27
    v_dot2_f32_bf16 v176, v86, s44, v27
    v_mfma_f32_16x16x32_bf16 v[184:187], a[120:123], v[148:151], v[184:187]
    v_dot2_f32_bf16 v177, v86, s45, v27
    v_dot2_f32_bf16 v178, v87, s44, v27
    v_dot2_f32_bf16 v179, v87, s45, v27
    s_waitcnt lgkmcnt(4)
    v_mfma_f32_16x16x32_bf16 v[180:183], a[108:111], v[152:155], v[180:183]
    v_cvt_pk_bf16_f32 v104, v172, v173
    v_cvt_pk_bf16_f32 v105, v174, v175
    v_cvt_pk_bf16_f32 v106, v176, v177
    v_mfma_f32_16x16x32_bf16 v[184:187], a[124:127], v[152:155], v[184:187]
    v_cvt_pk_bf16_f32 v107, v178, v179
    buffer_store_dwordx4 v[104:107], v53, s[28:31], s65 offen sc1
    s_waitcnt lgkmcnt(3)
    v_mfma_f32_16x16x32_bf16 v[188:191], a[96:99], v[156:159], v[76:79]
    v_mfma_f32_16x16x32_bf16 v[192:195], a[112:115], v[156:159], v[80:83]
    s_waitcnt lgkmcnt(2)
    v_mfma_f32_16x16x32_bf16 v[188:191], a[100:103], v[160:163], v[188:191]
    v_cvt_pk_bf16_f32 v88, v180, v181
    v_cvt_pk_bf16_f32 v89, v182, v183
    v_cvt_pk_bf16_f32 v90, v184, v185
    v_mfma_f32_16x16x32_bf16 v[192:195], a[116:119], v[160:163], v[192:195]
    v_cvt_pk_bf16_f32 v91, v186, v187
    v_dot2_f32_bf16 v180, v88, s44, v27
    v_dot2_f32_bf16 v181, v88, s45, v27
    s_waitcnt lgkmcnt(1)
    v_mfma_f32_16x16x32_bf16 v[188:191], a[104:107], v[164:167], v[188:191]
    v_dot2_f32_bf16 v182, v89, s44, v27
    v_dot2_f32_bf16 v183, v89, s45, v27
    v_dot2_f32_bf16 v184, v90, s44, v27
    v_mfma_f32_16x16x32_bf16 v[192:195], a[120:123], v[164:167], v[192:195]
    v_dot2_f32_bf16 v185, v90, s45, v27
    v_dot2_f32_bf16 v186, v91, s44, v27
    v_dot2_f32_bf16 v187, v91, s45, v27
    s_waitcnt lgkmcnt(0)
    v_mfma_f32_16x16x32_bf16 v[188:191], a[108:111], v[168:171], v[188:191]
    v_cvt_pk_bf16_f32 v108, v180, v181
    v_cvt_pk_bf16_f32 v109, v182, v183
    v_cvt_pk_bf16_f32 v110, v184, v185
    v_mfma_f32_16x16x32_bf16 v[192:195], a[124:127], v[168:171], v[192:195]
    v_cvt_pk_bf16_f32 v111, v186, v187
    buffer_store_dwordx4 v[108:111], v53, s[28:31], s66 offen sc1
    s_nop 1
    v_cvt_pk_bf16_f32 v92, v188, v189
    v_cvt_pk_bf16_f32 v93, v190, v191
    s_nop 1
    v_cvt_pk_bf16_f32 v94, v192, v193
    v_cvt_pk_bf16_f32 v95, v194, v195
    v_dot2_f32_bf16 v188, v92, s44, v27
    v_dot2_f32_bf16 v189, v92, s45, v27
    v_dot2_f32_bf16 v190, v93, s44, v27
    v_dot2_f32_bf16 v191, v93, s45, v27
    v_dot2_f32_bf16 v192, v94, s44, v27
    v_dot2_f32_bf16 v193, v94, s45, v27
    v_dot2_f32_bf16 v194, v95, s44, v27
    v_dot2_f32_bf16 v195, v95, s45, v27
    v_cvt_pk_bf16_f32 v112, v188, v189
    v_cvt_pk_bf16_f32 v113, v190, v191
    v_cvt_pk_bf16_f32 v114, v192, v193
    v_cvt_pk_bf16_f32 v115, v194, v195
    buffer_store_dwordx4 v[112:115], v54, s[28:31], s67 offen sc1
    buffer_load_dwordx4 a[188:191], v4, s[28:31], s87 offen offset:3072 sc1
    s_add_u32 s87, s84, 16384
    buffer_load_dwordx4 a[192:195], v4, s[28:31], s87 offen offset:0 sc1
    buffer_load_dwordx4 a[196:199], v4, s[28:31], s87 offen offset:1024 sc1
    buffer_load_dwordx4 a[200:203], v4, s[28:31], s87 offen offset:2048 sc1
    buffer_load_dwordx4 a[204:207], v4, s[28:31], s87 offen offset:3072 sc1
    s_add_u32 s87, s84, 20480
    buffer_load_dwordx4 a[208:211], v4, s[28:31], s87 offen offset:0 sc1
    buffer_load_dwordx4 a[212:215], v4, s[28:31], s87 offen offset:1024 sc1
    buffer_load_dwordx4 a[216:219], v4, s[28:31], s87 offen offset:2048 sc1
    buffer_load_dwordx4 a[220:223], v4, s[28:31], s87 offen offset:3072 sc1
    s_add_u32 s87, s84, 24576
    buffer_load_dwordx4 a[224:227], v4, s[28:31], s87 offen offset:0 sc1
    v_dot2_f32_bf16 v246, v84, v55, 0
    v_dot2_f32_bf16 v247, v84, v84, 0
    v_dot2_f32_bf16 v246, v85, v55, v246
    v_dot2_f32_bf16 v247, v85, v85, v247
    v_dot2_f32_bf16 v246, v86, v55, v246
    v_dot2_f32_bf16 v247, v86, v86, v247
    v_dot2_f32_bf16 v246, v87, v55, v246
    v_dot2_f32_bf16 v247, v87, v87, v247
    v_dot2_f32_bf16 v246, v88, v55, v246
    v_dot2_f32_bf16 v247, v88, v88, v247
    v_dot2_f32_bf16 v246, v89, v55, v246
    v_dot2_f32_bf16 v247, v89, v89, v247
    v_dot2_f32_bf16 v246, v90, v55, v246
    v_dot2_f32_bf16 v247, v90, v90, v247
    v_dot2_f32_bf16 v246, v91, v55, v246
    v_dot2_f32_bf16 v247, v91, v91, v247
    v_dot2_f32_bf16 v246, v92, v55, v246
    v_dot2_f32_bf16 v247, v92, v92, v247
    v_dot2_f32_bf16 v246, v93, v55, v246
    v_dot2_f32_bf16 v247, v93, v93, v247
    v_dot2_f32_bf16 v246, v94, v55, v246
    v_dot2_f32_bf16 v247, v94, v94, v247
    v_dot2_f32_bf16 v246, v95, v55, v246
    v_dot2_f32_bf16 v247, v95, v95, v247
    s_nop 1
    v_add_f32_dpp v246, v246, v246 row_ror:8 row_mask:0xf bank_mask:0xf
    v_add_f32_dpp v247, v247, v247 row_ror:8 row_mask:0xf bank_mask:0xf
    v_mov_b32 v244, v246
    v_mov_b32 v245, v247
    s_nop 0
    v_permlane16_swap_b32 v246, v244
    v_permlane16_swap_b32 v247, v245
    v_add_f32 v246, v246, v244
    v_add_f32 v247, v247, v245
    v_mov_b32 v244, v246
    v_mov_b32 v245, v247
    s_nop 0
    v_permlane32_swap_b32 v246, v244
    v_permlane32_swap_b32 v247, v245
    v_add_f32 v246, v246, v244
    v_add_f32 v247, v247, v245
    ds_write_b64 v51, v[246:247]
    s_waitcnt lgkmcnt(0)
    s_barrier
    buffer_load_dwordx4 v[64:67], v227, s[28:31], s68 offen offset:0 sc1
    buffer_load_dwordx4 v[68:71], v228, s[28:31], s68 offen offset:0 sc1
    buffer_load_dwordx4 v[72:75], v227, s[28:31], s68 offen offset:512 sc1
    buffer_load_dwordx4 v[76:79], v228, s[28:31], s68 offen offset:512 sc1
    buffer_load_dwordx4 v[80:83], v227, s[28:31], s68 offen offset:1024 sc1
    buffer_load_dwordx4 v[84:87], v228, s[28:31], s68 offen offset:1024 sc1
    buffer_load_dwordx4 v[88:91], v227, s[28:31], s68 offen offset:1536 sc1
    buffer_load_dwordx4 v[92:95], v228, s[28:31], s68 offen offset:1536 sc1
    buffer_load_dwordx4 v[96:99], v227, s[28:31], s68 offen offset:2048 sc1
    buffer_load_dwordx4 v[100:103], v228, s[28:31], s68 offen offset:2048 sc1
    buffer_load_dwordx4 v[104:107], v227, s[28:31], s68 offen offset:2560 sc1
    buffer_load_dwordx4 v[108:111], v228, s[28:31], s68 offen offset:2560 sc1
    s_cmp_lg_u32 s36, 0
    s_cbranch_scc1 Lst_13
    ds_read_b128 v[236:239], v52
    ds_read_b128 v[240:243], v52 offset:16
    s_waitcnt lgkmcnt(1)
    v_pk_add_f32 v[236:237], v[236:237], v[238:239]
    s_waitcnt lgkmcnt(0)
    v_pk_add_f32 v[240:241], v[240:241], v[242:243]
    v_pk_add_f32 v[246:247], v[236:237], v[240:241]
    v_mul_f32 v246, 0x3acccccd, v246
    v_mul_f32 v247, 0x3acccccd, v247
    v_fma_f32 v247, -v246, v246, v247
    v_max_f32 v247, 0, v247
    v_cvt_pk_bf16_f32 v247, v247, v247
    v_lshlrev_b32 v247, 16, v247
    v_add_f32 v247, 0x3727c5ac, v247
    v_cvt_pk_bf16_f32 v247, v247, v247
    v_lshlrev_b32 v247, 16, v247
    v_sqrt_f32 v247, v247
    s_nop 0
    v_cvt_pk_bf16_f32 v247, v247, v247
    v_lshlrev_b32 v247, 16, v247
    v_lshrrev_b32 v246, 16, v27
    v_or_b32 v244, v246, v247
    v_mov_b32 v245, v5
    buffer_store_dwordx4 v[244:247], v54, s[28:31], s67 offen offset:2048 sc1
    s_nop 1
Lst_13:
    s_lshl2_add_u32 s50, s2, s36
    s_cmp_lg_u32 s50, 3
    s_cbranch_scc1 Lep_14
    s_mov_b32 s50, 21069824
    s_mov_b64 exec, 1
    buffer_store_dword v5, off, s[28:31], s50 sc1
    s_mov_b64 exec, -1
Lep_14:
    ds_read_b64_tr_b16 a[88:89], v224 offset:0
    ds_read_b64_tr_b16 a[90:91], v224 offset:3584
    ds_read_b64_tr_b16 a[92:93], v224 offset:32
    ds_read_b64_tr_b16 a[94:95], v224 offset:3616
    ds_read_b64_tr_b16 a[96:97], v224 offset:64
    ds_read_b64_tr_b16 a[98:99], v224 offset:3648
    ds_read_b64_tr_b16 a[100:101], v224 offset:96
    ds_read_b64_tr_b16 a[102:103], v224 offset:3680
    ds_read_b64_tr_b16 a[104:105], v224 offset:7168
    ds_read_b64_tr_b16 a[106:107], v224 offset:10752
    ds_read_b64_tr_b16 a[108:109], v224 offset:7200
    ds_read_b64_tr_b16 a[110:111], v224 offset:10784
    ds_read_b64_tr_b16 a[112:113], v224 offset:7232
    ds_read_b64_tr_b16 a[114:115], v224 offset:10816
    s_waitcnt vmcnt(9)
    v_max3_u32 v234, v67, v71, v75
    s_waitcnt vmcnt(8)
    v_max_u32 v234, v234, v79
    v_cmp_eq_u32 vcc, -1, v234
    s_nop 0
    s_cbranch_vccz Lok_16
Lfix_15:
    s_add_i32 s49, s49, -1
    s_cmp_lt_i32 s49, 0
    s_cbranch_scc1 Lok_16
    buffer_load_dwordx4 v[64:67], v227, s[28:31], s68 offen offset:0 sc1
    buffer_load_dwordx4 v[68:71], v228, s[28:31], s68 offen offset:0 sc1
    buffer_load_dwordx4 v[72:75], v227, s[28:31], s68 offen offset:512 sc1
    buffer_load_dwordx4 v[76:79], v228, s[28:31], s68 offen offset:512 sc1
    buffer_load_dwordx4 v[80:83], v227, s[28:31], s68 offen offset:1024 sc1
    buffer_load_dwordx4 v[84:87], v228, s[28:31], s68 offen offset:1024 sc1
    buffer_load_dwordx4 v[88:91], v227, s[28:31], s68 offen offset:1536 sc1
    buffer_load_dwordx4 v[92:95], v228, s[28:31], s68 offen offset:1536 sc1
    buffer_load_dwordx4 v[96:99], v227, s[28:31], s68 offen offset:2048 sc1
    buffer_load_dwordx4 v[100:103], v228, s[28:31], s68 offen offset:2048 sc1
    buffer_load_dwordx4 v[104:107], v227, s[28:31], s68 offen offset:2560 sc1
    buffer_load_dwordx4 v[108:111], v228, s[28:31], s68 offen offset:2560 sc1
    s_waitcnt vmcnt(0)
    v_max3_u32 v234, v67, v71, v75
    v_max_u32 v234, v234, v79
    v_cmp_eq_u32 vcc, -1, v234
    s_nop 0
    s_cbranch_vccnz Lfix_15
Lok_16:
    s_waitcnt lgkmcnt(10)
    v_mfma_f32_16x16x32_bf16 v[8:11], a[88:91], v[64:67], 0
    ds_read_b64_tr_b16 a[116:117], v224 offset:7264
    buffer_load_dwordx4 v[112:115], v227, s[28:31], s68 offen offset:3072 sc1
    v_mfma_f32_16x16x32_bf16 v[36:39], a[88:91], v[68:71], 0
    ds_read_b64_tr_b16 a[118:119], v224 offset:10848
    buffer_load_dwordx4 v[116:119], v228, s[28:31], s68 offen offset:3072 sc1
    v_mfma_f32_16x16x32_bf16 v[12:15], a[92:95], v[64:67], 0
    ds_read_b64_tr_b16 a[120:121], v224 offset:14336
    s_lshr_b32 s55, s38, 1
    v_mfma_f32_16x16x32_bf16 v[40:43], a[92:95], v[68:71], 0
    ds_read_b64_tr_b16 a[122:123], v224 offset:17920
    s_waitcnt lgkmcnt(10)
    v_mfma_f32_16x16x32_bf16 v[16:19], a[96:99], v[64:67], 0
    ds_read_b64_tr_b16 a[124:125], v224 offset:14368
    s_and_b32 s55, s55, 4
    v_mfma_f32_16x16x32_bf16 v[44:47], a[96:99], v[68:71], 0
    ds_read_b64_tr_b16 a[126:127], v224 offset:17952
    s_lshl3_add_u32 s55, s37, s55
    v_mfma_f32_16x16x32_bf16 v[20:23], a[100:103], v[64:67], 0
    ds_read_b64_tr_b16 a[88:89], v224 offset:14400
    s_mul_i32 s53, s36, 14336
    v_mfma_f32_16x16x32_bf16 v[48:51], a[100:103], v[68:71], 0
    ds_read_b64_tr_b16 a[90:91], v224 offset:17984
    s_waitcnt lgkmcnt(10)
    v_mfma_f32_16x16x32_bf16 v[8:11], a[104:107], v[72:75], v[8:11]
    ds_read_b64_tr_b16 a[92:93], v224 offset:14432
    buffer_load_dwordx4 v[120:123], v227, s[28:31], s68 offen offset:3584 sc1
    v_mfma_f32_16x16x32_bf16 v[36:39], a[104:107], v[76:79], v[36:39]
    ds_read_b64_tr_b16 a[94:95], v224 offset:18016
    buffer_load_dwordx4 v[124:127], v228, s[28:31], s68 offen offset:3584 sc1
    v_mfma_f32_16x16x32_bf16 v[12:15], a[108:111], v[72:75], v[12:15]
    ds_read_b64_tr_b16 a[96:97], v224 offset:21504
    s_waitcnt vmcnt(8)
    v_mfma_f32_16x16x32_bf16 v[40:43], a[108:111], v[76:79], v[40:43]
    ds_read_b64_tr_b16 a[98:99], v224 offset:25088
    s_waitcnt lgkmcnt(10)
    v_mfma_f32_16x16x32_bf16 v[16:19], a[112:115], v[72:75], v[16:19]
    ds_read_b64_tr_b16 a[100:101], v224 offset:21536
    v_max3_u32 v234, v83, v87, v91
    v_mfma_f32_16x16x32_bf16 v[44:47], a[112:115], v[76:79], v[44:47]
    ds_read_b64_tr_b16 a[102:103], v224 offset:25120
    v_max_u32 v234, v234, v95
    v_mfma_f32_16x16x32_bf16 v[20:23], a[116:119], v[72:75], v[20:23]
    ds_read_b64_tr_b16 a[104:105], v224 offset:21568
    v_cmp_eq_u32 vcc, -1, v234
    v_mfma_f32_16x16x32_bf16 v[48:51], a[116:119], v[76:79], v[48:51]
    ds_read_b64_tr_b16 a[106:107], v224 offset:25152
    s_cbranch_vccnz Lfix_19
Lok_20:
    s_waitcnt lgkmcnt(10)
    v_mfma_f32_16x16x32_bf16 v[8:11], a[120:123], v[80:83], v[8:11]
    ds_read_b64_tr_b16 a[108:109], v224 offset:21600
    buffer_load_dwordx4 v[128:131], v227, s[28:31], s69 offen offset:0 sc1
    v_mfma_f32_16x16x32_bf16 v[36:39], a[120:123], v[84:87], v[36:39]
    ds_read_b64_tr_b16 a[110:111], v224 offset:25184
    buffer_load_dwordx4 v[132:135], v228, s[28:31], s69 offen offset:0 sc1
    v_mfma_f32_16x16x32_bf16 v[12:15], a[124:127], v[80:83], v[12:15]
    ds_read_b64_tr_b16 a[112:113], v224 offset:28672
    s_add_u32 s52, s36, 0
    v_mfma_f32_16x16x32_bf16 v[40:43], a[124:127], v[84:87], v[40:43]
    ds_read_b64_tr_b16 a[114:115], v224 offset:32256
    s_waitcnt lgkmcnt(10)
    v_mfma_f32_16x16x32_bf16 v[16:19], a[88:91], v[80:83], v[16:19]
    ds_read_b64_tr_b16 a[116:117], v224 offset:28704
    s_and_b32 s52, s52, 3
    v_mfma_f32_16x16x32_bf16 v[44:47], a[88:91], v[84:87], v[44:47]
    ds_read_b64_tr_b16 a[118:119], v224 offset:32288
    s_add_u32 s52, s52, s55
    v_mfma_f32_16x16x32_bf16 v[20:23], a[92:95], v[80:83], v[20:23]
    ds_read_b64_tr_b16 a[120:121], v224 offset:28736
    s_mul_i32 s52, s52, 57344
    v_mfma_f32_16x16x32_bf16 v[48:51], a[92:95], v[84:87], v[48:51]
    ds_read_b64_tr_b16 a[122:123], v224 offset:32320
    s_waitcnt lgkmcnt(10)
    v_mfma_f32_16x16x32_bf16 v[8:11], a[96:99], v[88:91], v[8:11]
    ds_read_b64_tr_b16 a[124:125], v224 offset:28768
    buffer_load_dwordx4 v[136:139], v227, s[28:31], s69 offen offset:512 sc1
    v_mfma_f32_16x16x32_bf16 v[36:39], a[96:99], v[92:95], v[36:39]
    ds_read_b64_tr_b16 a[126:127], v224 offset:32352
    buffer_load_dwordx4 v[140:143], v228, s[28:31], s69 offen offset:512 sc1
    v_mfma_f32_16x16x32_bf16 v[12:15], a[100:103], v[88:91], v[12:15]
    ds_read_b64_tr_b16 a[88:89], v224 offset:35840
    s_waitcnt vmcnt(8)
    v_mfma_f32_16x16x32_bf16 v[40:43], a[100:103], v[92:95], v[40:43]
    ds_read_b64_tr_b16 a[90:91], v224 offset:39424
    s_waitcnt lgkmcnt(10)
    v_mfma_f32_16x16x32_bf16 v[16:19], a[104:107], v[88:91], v[16:19]
    ds_read_b64_tr_b16 a[92:93], v224 offset:35872
    v_max3_u32 v234, v99, v103, v107
    v_mfma_f32_16x16x32_bf16 v[44:47], a[104:107], v[92:95], v[44:47]
    ds_read_b64_tr_b16 a[94:95], v224 offset:39456
    v_max_u32 v234, v234, v111
    v_mfma_f32_16x16x32_bf16 v[20:23], a[108:111], v[88:91], v[20:23]
    ds_read_b64_tr_b16 a[96:97], v224 offset:35904
    v_cmp_eq_u32 vcc, -1, v234
    v_mfma_f32_16x16x32_bf16 v[48:51], a[108:111], v[92:95], v[48:51]
    ds_read_b64_tr_b16 a[98:99], v224 offset:39488
    s_cbranch_vccnz Lfix_21
Lok_22:
    s_waitcnt lgkmcnt(10)
    v_mfma_f32_16x16x32_bf16 v[8:11], a[112:115], v[96:99], v[8:11]
    ds_read_b64_tr_b16 a[100:101], v224 offset:35936
    buffer_load_dwordx4 v[144:147], v227, s[28:31], s69 offen offset:1024 sc1
    v_mfma_f32_16x16x32_bf16 v[36:39], a[112:115], v[100:103], v[36:39]
    ds_read_b64_tr_b16 a[102:103], v224 offset:39520
    buffer_load_dwordx4 v[148:151], v228, s[28:31], s69 offen offset:1024 sc1
    v_mfma_f32_16x16x32_bf16 v[12:15], a[116:119], v[96:99], v[12:15]
    ds_read_b64_tr_b16 a[104:105], v224 offset:43008
    s_add_u32 s52, s52, s53
    v_mfma_f32_16x16x32_bf16 v[40:43], a[116:119], v[100:103], v[40:43]
    ds_read_b64_tr_b16 a[106:107], v224 offset:46592
    s_waitcnt lgkmcnt(10)
    v_mfma_f32_16x16x32_bf16 v[16:19], a[120:123], v[96:99], v[16:19]
    ds_read_b64_tr_b16 a[108:109], v224 offset:43040
    s_add_u32 s64, s52, 8388608
    v_mfma_f32_16x16x32_bf16 v[44:47], a[120:123], v[100:103], v[44:47]
    ds_read_b64_tr_b16 a[110:111], v224 offset:46624
    s_add_u32 s65, s52, 8392704
    v_mfma_f32_16x16x32_bf16 v[20:23], a[124:127], v[96:99], v[20:23]
    ds_read_b64_tr_b16 a[112:113], v224 offset:43072
    s_add_u32 s66, s52, 8396800
    v_mfma_f32_16x16x32_bf16 v[48:51], a[124:127], v[100:103], v[48:51]
    ds_read_b64_tr_b16 a[114:115], v224 offset:46656
    s_waitcnt lgkmcnt(10)
    v_mfma_f32_16x16x32_bf16 v[8:11], a[88:91], v[104:107], v[8:11]
    ds_read_b64_tr_b16 a[116:117], v224 offset:43104
    buffer_load_dwordx4 v[152:155], v227, s[28:31], s69 offen offset:1536 sc1
    v_mfma_f32_16x16x32_bf16 v[36:39], a[88:91], v[108:111], v[36:39]
    ds_read_b64_tr_b16 a[118:119], v224 offset:46688
    buffer_load_dwordx4 v[156:159], v228, s[28:31], s69 offen offset:1536 sc1
    v_mfma_f32_16x16x32_bf16 v[12:15], a[92:95], v[104:107], v[12:15]
    ds_read_b64_tr_b16 a[120:121], v224 offset:50176
    s_waitcnt vmcnt(8)
    v_mfma_f32_16x16x32_bf16 v[40:43], a[92:95], v[108:111], v[40:43]
    ds_read_b64_tr_b16 a[122:123], v224 offset:53760
    s_waitcnt lgkmcnt(10)
    v_mfma_f32_16x16x32_bf16 v[16:19], a[96:99], v[104:107], v[16:19]
    ds_read_b64_tr_b16 a[124:125], v224 offset:50208
    v_max3_u32 v234, v115, v119, v123
    v_mfma_f32_16x16x32_bf16 v[44:47], a[96:99], v[108:111], v[44:47]
    ds_read_b64_tr_b16 a[126:127], v224 offset:53792
    v_max_u32 v234, v234, v127
    v_mfma_f32_16x16x32_bf16 v[20:23], a[100:103], v[104:107], v[20:23]
    ds_read_b64_tr_b16 a[88:89], v224 offset:50240
    v_cmp_eq_u32 vcc, -1, v234
    v_mfma_f32_16x16x32_bf16 v[48:51], a[100:103], v[108:111], v[48:51]
    ds_read_b64_tr_b16 a[90:91], v224 offset:53824
    s_cbranch_vccnz Lfix_23
Lok_24:
    s_waitcnt lgkmcnt(10)
    v_mfma_f32_16x16x32_bf16 v[8:11], a[104:107], v[112:115], v[8:11]
    ds_read_b64_tr_b16 a[92:93], v224 offset:50272
    buffer_load_dwordx4 v[160:163], v227, s[28:31], s69 offen offset:2048 sc1
    v_mfma_f32_16x16x32_bf16 v[36:39], a[104:107], v[116:119], v[36:39]
    ds_read_b64_tr_b16 a[94:95], v224 offset:53856
    buffer_load_dwordx4 v[164:167], v228, s[28:31], s69 offen offset:2048 sc1
    v_mfma_f32_16x16x32_bf16 v[12:15], a[108:111], v[112:115], v[12:15]
    ds_read_b64_tr_b16 a[96:97], v225 offset:0
    s_add_u32 s67, s52, 8400896
    v_mfma_f32_16x16x32_bf16 v[40:43], a[108:111], v[116:119], v[40:43]
    ds_read_b64_tr_b16 a[98:99], v225 offset:3584
    s_waitcnt lgkmcnt(10)
    v_mfma_f32_16x16x32_bf16 v[16:19], a[112:115], v[112:115], v[16:19]
    ds_read_b64_tr_b16 a[100:101], v225 offset:32
    s_mov_b32 s44, 0xbfb8aa3b
    v_mfma_f32_16x16x32_bf16 v[44:47], a[112:115], v[116:119], v[44:47]
    ds_read_b64_tr_b16 a[102:103], v225 offset:3616
    s_lshl_b32 s46, s37, 15
    v_mfma_f32_16x16x32_bf16 v[20:23], a[116:119], v[112:115], v[20:23]
    ds_read_b64_tr_b16 a[104:105], v225 offset:64
    s_add_u32 s46, s46, 21102592
    v_mfma_f32_16x16x32_bf16 v[48:51], a[116:119], v[116:119], v[48:51]
    ds_read_b64_tr_b16 a[106:107], v225 offset:3648
    s_waitcnt lgkmcnt(10)
    v_mfma_f32_16x16x32_bf16 v[8:11], a[120:123], v[120:123], v[8:11]
    ds_read_b64_tr_b16 a[108:109], v225 offset:96
    buffer_load_dwordx4 v[168:171], v227, s[28:31], s69 offen offset:2560 sc1
    v_mfma_f32_16x16x32_bf16 v[36:39], a[120:123], v[124:127], v[36:39]
    ds_read_b64_tr_b16 a[110:111], v225 offset:3680
    buffer_load_dwordx4 v[172:175], v228, s[28:31], s69 offen offset:2560 sc1
    v_mfma_f32_16x16x32_bf16 v[12:15], a[124:127], v[120:123], v[12:15]
    ds_read_b64_tr_b16 a[112:113], v225 offset:7168
    s_waitcnt vmcnt(8)
    v_mfma_f32_16x16x32_bf16 v[40:43], a[124:127], v[124:127], v[40:43]
    ds_read_b64_tr_b16 a[114:115], v225 offset:10752
    s_waitcnt lgkmcnt(10)
    v_mfma_f32_16x16x32_bf16 v[16:19], a[88:91], v[120:123], v[16:19]
    ds_read_b64_tr_b16 a[116:117], v225 offset:7200
    v_max3_u32 v234, v131, v135, v139
    v_mfma_f32_16x16x32_bf16 v[44:47], a[88:91], v[124:127], v[44:47]
    ds_read_b64_tr_b16 a[118:119], v225 offset:10784
    v_max_u32 v234, v234, v143
    v_mfma_f32_16x16x32_bf16 v[20:23], a[92:95], v[120:123], v[20:23]
    ds_read_b64_tr_b16 a[120:121], v225 offset:7232
    v_cmp_eq_u32 vcc, -1, v234
    v_mfma_f32_16x16x32_bf16 v[48:51], a[92:95], v[124:127], v[48:51]
    ds_read_b64_tr_b16 a[122:123], v225 offset:10816
    s_cbranch_vccnz Lfix_25
Lok_26:
    s_waitcnt lgkmcnt(10)
    v_mfma_f32_16x16x32_bf16 v[8:11], a[96:99], v[128:131], v[8:11]
    ds_read_b64_tr_b16 a[124:125], v225 offset:7264
    buffer_load_dwordx4 v[176:179], v227, s[28:31], s69 offen offset:3072 sc1
    v_mfma_f32_16x16x32_bf16 v[36:39], a[96:99], v[132:135], v[36:39]
    ds_read_b64_tr_b16 a[126:127], v225 offset:10848
    buffer_load_dwordx4 v[180:183], v228, s[28:31], s69 offen offset:3072 sc1
    v_mfma_f32_16x16x32_bf16 v[12:15], a[100:103], v[128:131], v[12:15]
    ds_read_b64_tr_b16 a[88:89], v225 offset:14336
    s_lshr_b32 s50, s36, 1
    v_mfma_f32_16x16x32_bf16 v[40:43], a[100:103], v[132:135], v[40:43]
    ds_read_b64_tr_b16 a[90:91], v225 offset:17920
    s_waitcnt lgkmcnt(10)
    v_mfma_f32_16x16x32_bf16 v[16:19], a[104:107], v[128:131], v[16:19]
    ds_read_b64_tr_b16 a[92:93], v225 offset:14368
    s_lshl4_add_u32 s50, s50, s38
    v_mfma_f32_16x16x32_bf16 v[44:47], a[104:107], v[132:135], v[44:47]
    ds_read_b64_tr_b16 a[94:95], v225 offset:17952
    s_and_b32 s51, s36, 1
    v_mfma_f32_16x16x32_bf16 v[20:23], a[108:111], v[128:131], v[20:23]
    ds_read_b64_tr_b16 a[96:97], v225 offset:14400
    s_lshl1_add_u32 s50, s50, s51
    v_mfma_f32_16x16x32_bf16 v[48:51], a[108:111], v[132:135], v[48:51]
    ds_read_b64_tr_b16 a[98:99], v225 offset:17984
    s_waitcnt lgkmcnt(10)
    v_mfma_f32_16x16x32_bf16 v[8:11], a[112:115], v[136:139], v[8:11]
    ds_read_b64_tr_b16 a[100:101], v225 offset:14432
    buffer_load_dwordx4 v[184:187], v227, s[28:31], s69 offen offset:3584 sc1
    v_mfma_f32_16x16x32_bf16 v[36:39], a[112:115], v[140:143], v[36:39]
    ds_read_b64_tr_b16 a[102:103], v225 offset:18016
    buffer_load_dwordx4 v[188:191], v228, s[28:31], s69 offen offset:3584 sc1
    v_mfma_f32_16x16x32_bf16 v[12:15], a[116:119], v[136:139], v[12:15]
    ds_read_b64_tr_b16 a[104:105], v225 offset:21504
    s_waitcnt vmcnt(8)
    v_mfma_f32_16x16x32_bf16 v[40:43], a[116:119], v[140:143], v[40:43]
    ds_read_b64_tr_b16 a[106:107], v225 offset:25088
    s_waitcnt lgkmcnt(10)
    v_mfma_f32_16x16x32_bf16 v[16:19], a[120:123], v[136:139], v[16:19]
    ds_read_b64_tr_b16 a[108:109], v225 offset:21536
    v_max3_u32 v234, v147, v151, v155
    v_mfma_f32_16x16x32_bf16 v[44:47], a[120:123], v[140:143], v[44:47]
    ds_read_b64_tr_b16 a[110:111], v225 offset:25120
    v_max_u32 v234, v234, v159
    v_mfma_f32_16x16x32_bf16 v[20:23], a[124:127], v[136:139], v[20:23]
    ds_read_b64_tr_b16 a[112:113], v225 offset:21568
    v_cmp_eq_u32 vcc, -1, v234
    v_mfma_f32_16x16x32_bf16 v[48:51], a[124:127], v[140:143], v[48:51]
    ds_read_b64_tr_b16 a[114:115], v225 offset:25152
    s_cbranch_vccnz Lfix_27
Lok_28:
    s_waitcnt lgkmcnt(10)
    v_mfma_f32_16x16x32_bf16 v[8:11], a[88:91], v[144:147], v[8:11]
    ds_read_b64_tr_b16 a[116:117], v225 offset:21600
    buffer_load_dwordx4 v[192:195], v227, s[28:31], s70 offen offset:0 sc1
    v_mfma_f32_16x16x32_bf16 v[36:39], a[88:91], v[148:151], v[36:39]
    ds_read_b64_tr_b16 a[118:119], v225 offset:25184
    buffer_load_dwordx4 v[196:199], v228, s[28:31], s70 offen offset:0 sc1
    v_mfma_f32_16x16x32_bf16 v[12:15], a[92:95], v[144:147], v[12:15]
    ds_read_b64_tr_b16 a[120:121], v225 offset:28672
    s_lshl_b32 s50, s50, 9
    v_mfma_f32_16x16x32_bf16 v[40:43], a[92:95], v[148:151], v[40:43]
    ds_read_b64_tr_b16 a[122:123], v225 offset:32256
    s_waitcnt lgkmcnt(10)
    v_mfma_f32_16x16x32_bf16 v[16:19], a[96:99], v[144:147], v[16:19]
    ds_read_b64_tr_b16 a[124:125], v225 offset:28704
    s_add_u32 s45, s46, s50
    v_mfma_f32_16x16x32_bf16 v[44:47], a[96:99], v[148:151], v[44:47]
    ds_read_b64_tr_b16 a[126:127], v225 offset:32288
    s_and_b32 s50, s55, 4
    v_mfma_f32_16x16x32_bf16 v[20:23], a[100:103], v[144:147], v[20:23]
    ds_read_b64_tr_b16 a[88:89], v225 offset:28736
    s_add_u32 s50, s50, s36
    v_mfma_f32_16x16x32_bf16 v[48:51], a[100:103], v[148:151], v[48:51]
    ds_read_b64_tr_b16 a[90:91], v225 offset:32320
    s_waitcnt lgkmcnt(10)
    v_mfma_f32_16x16x32_bf16 v[8:11], a[104:107], v[152:155], v[8:11]
    ds_read_b64_tr_b16 a[92:93], v225 offset:28768
    buffer_load_dwordx4 v[200:203], v227, s[28:31], s70 offen offset:512 sc1
    v_mfma_f32_16x16x32_bf16 v[36:39], a[104:107], v[156:159], v[36:39]
    ds_read_b64_tr_b16 a[94:95], v225 offset:32352
    buffer_load_dwordx4 v[204:207], v228, s[28:31], s70 offen offset:512 sc1
    v_mfma_f32_16x16x32_bf16 v[12:15], a[108:111], v[152:155], v[12:15]
    ds_read_b64_tr_b16 a[96:97], v225 offset:35840
    s_waitcnt vmcnt(8)
    v_mfma_f32_16x16x32_bf16 v[40:43], a[108:111], v[156:159], v[40:43]
    ds_read_b64_tr_b16 a[98:99], v225 offset:39424
    s_waitcnt lgkmcnt(10)
    v_mfma_f32_16x16x32_bf16 v[16:19], a[112:115], v[152:155], v[16:19]
    ds_read_b64_tr_b16 a[100:101], v225 offset:35872
    v_max3_u32 v234, v163, v167, v171
    v_mfma_f32_16x16x32_bf16 v[44:47], a[112:115], v[156:159], v[44:47]
    ds_read_b64_tr_b16 a[102:103], v225 offset:39456
    v_max_u32 v234, v234, v175
    v_mfma_f32_16x16x32_bf16 v[20:23], a[116:119], v[152:155], v[20:23]
    ds_read_b64_tr_b16 a[104:105], v225 offset:35904
    v_cmp_eq_u32 vcc, -1, v234
    v_mfma_f32_16x16x32_bf16 v[48:51], a[116:119], v[156:159], v[48:51]
    ds_read_b64_tr_b16 a[106:107], v225 offset:39488
    s_cbranch_vccnz Lfix_29
Lok_30:
    s_waitcnt lgkmcnt(10)
    v_mfma_f32_16x16x32_bf16 v[8:11], a[120:123], v[160:163], v[8:11]
    ds_read_b64_tr_b16 a[108:109], v225 offset:35936
    buffer_load_dwordx4 v[208:211], v227, s[28:31], s70 offen offset:1024 sc1
    v_mfma_f32_16x16x32_bf16 v[36:39], a[120:123], v[164:167], v[36:39]
    ds_read_b64_tr_b16 a[110:111], v225 offset:39520
    buffer_load_dwordx4 v[212:215], v228, s[28:31], s70 offen offset:1024 sc1
    v_mfma_f32_16x16x32_bf16 v[12:15], a[124:127], v[160:163], v[12:15]
    ds_read_b64_tr_b16 a[112:113], v225 offset:43008
    s_lshl_b32 s50, s50, 12
    v_mfma_f32_16x16x32_bf16 v[40:43], a[124:127], v[164:167], v[40:43]
    ds_read_b64_tr_b16 a[114:115], v225 offset:46592
    s_waitcnt lgkmcnt(10)
    v_mfma_f32_16x16x32_bf16 v[16:19], a[88:91], v[160:163], v[16:19]
    ds_read_b64_tr_b16 a[116:117], v225 offset:43040
    s_add_u32 s46, s46, s50
    v_mfma_f32_16x16x32_bf16 v[44:47], a[88:91], v[164:167], v[44:47]
    ds_read_b64_tr_b16 a[118:119], v225 offset:46624
    v_lshrrev_b32 v235, 5, v1
    v_mfma_f32_16x16x32_bf16 v[20:23], a[92:95], v[160:163], v[20:23]
    ds_read_b64_tr_b16 a[120:121], v225 offset:43072
    v_lshlrev_b32 v235, 26, v235
    v_mfma_f32_16x16x32_bf16 v[48:51], a[92:95], v[164:167], v[48:51]
    ds_read_b64_tr_b16 a[122:123], v225 offset:46656
    s_waitcnt lgkmcnt(10)
    v_mfma_f32_16x16x32_bf16 v[8:11], a[96:99], v[168:171], v[8:11]
    ds_read_b64_tr_b16 a[124:125], v225 offset:43104
    buffer_load_dwordx4 v[216:219], v227, s[28:31], s70 offen offset:1536 sc1
    v_mfma_f32_16x16x32_bf16 v[36:39], a[96:99], v[172:175], v[36:39]
    ds_read_b64_tr_b16 a[126:127], v225 offset:46688
    buffer_load_dwordx4 v[220:223], v228, s[28:31], s70 offen offset:1536 sc1
    v_mfma_f32_16x16x32_bf16 v[12:15], a[100:103], v[168:171], v[12:15]
    ds_read_b64_tr_b16 a[88:89], v225 offset:50176
    s_waitcnt vmcnt(8)
    v_mfma_f32_16x16x32_bf16 v[40:43], a[100:103], v[172:175], v[40:43]
    ds_read_b64_tr_b16 a[90:91], v225 offset:53760
    s_waitcnt lgkmcnt(10)
    v_mfma_f32_16x16x32_bf16 v[16:19], a[104:107], v[168:171], v[16:19]
    ds_read_b64_tr_b16 a[92:93], v225 offset:50208
    v_max3_u32 v234, v179, v183, v187
    v_mfma_f32_16x16x32_bf16 v[44:47], a[104:107], v[172:175], v[44:47]
    ds_read_b64_tr_b16 a[94:95], v225 offset:53792
    v_max_u32 v234, v234, v191
    v_mfma_f32_16x16x32_bf16 v[20:23], a[108:111], v[168:171], v[20:23]
    ds_read_b64_tr_b16 a[96:97], v225 offset:50240
    v_cmp_eq_u32 vcc, -1, v234
    v_mfma_f32_16x16x32_bf16 v[48:51], a[108:111], v[172:175], v[48:51]
    ds_read_b64_tr_b16 a[98:99], v225 offset:53824
    s_cbranch_vccnz Lfix_31
Lok_32:
    s_waitcnt lgkmcnt(10)
    v_mfma_f32_16x16x32_bf16 v[8:11], a[112:115], v[176:179], v[8:11]
    ds_read_b64_tr_b16 a[100:101], v225 offset:50272
    v_lshl_add_u32 v235, v1, 2, v235
    v_mfma_f32_16x16x32_bf16 v[36:39], a[112:115], v[180:183], v[36:39]
    ds_read_b64_tr_b16 a[102:103], v225 offset:53856
    v_and_b32 v0, 7, v1
    v_mfma_f32_16x16x32_bf16 v[12:15], a[116:119], v[176:179], v[12:15]
    ds_read_b64_tr_b16 a[104:105], v226 offset:0
    v_lshlrev_b32 v0, 9, v0
    v_mfma_f32_16x16x32_bf16 v[40:43], a[116:119], v[180:183], v[40:43]
    ds_read_b64_tr_b16 a[106:107], v226 offset:3584
    s_waitcnt lgkmcnt(10)
    v_mfma_f32_16x16x32_bf16 v[16:19], a[120:123], v[176:179], v[16:19]
    ds_read_b64_tr_b16 a[108:109], v226 offset:32
    v_mfma_f32_16x16x32_bf16 v[44:47], a[120:123], v[180:183], v[44:47]
    ds_read_b64_tr_b16 a[110:111], v226 offset:3616
    v_mfma_f32_16x16x32_bf16 v[20:23], a[124:127], v[176:179], v[20:23]
    ds_read_b64_tr_b16 a[112:113], v226 offset:64
    v_mfma_f32_16x16x32_bf16 v[48:51], a[124:127], v[180:183], v[48:51]
    ds_read_b64_tr_b16 a[114:115], v226 offset:3648
    s_waitcnt lgkmcnt(10)
    v_mfma_f32_16x16x32_bf16 v[8:11], a[88:91], v[184:187], v[8:11]
    ds_read_b64_tr_b16 a[116:117], v226 offset:96
    buffer_load_dwordx2 v[230:231], v227, s[28:31], s70 offen offset:2048 sc1
    v_mfma_f32_16x16x32_bf16 v[36:39], a[88:91], v[188:191], v[36:39]
    ds_read_b64_tr_b16 a[118:119], v226 offset:3680
    buffer_load_dwordx2 v[232:233], v228, s[28:31], s70 offen offset:2048 sc1
    v_mfma_f32_16x16x32_bf16 v[12:15], a[92:95], v[184:187], v[12:15]
    ds_read_b64_tr_b16 a[120:121], v226 offset:7168
    s_waitcnt vmcnt(6)
    v_mfma_f32_16x16x32_bf16 v[40:43], a[92:95], v[188:191], v[40:43]
    ds_read_b64_tr_b16 a[122:123], v226 offset:10752
    s_waitcnt lgkmcnt(10)
    v_mfma_f32_16x16x32_bf16 v[16:19], a[96:99], v[184:187], v[16:19]
    ds_read_b64_tr_b16 a[124:125], v226 offset:7200
    v_max3_u32 v234, v195, v199, v203
    v_mfma_f32_16x16x32_bf16 v[44:47], a[96:99], v[188:191], v[44:47]
    ds_read_b64_tr_b16 a[126:127], v226 offset:10784
    v_max_u32 v234, v234, v207
    v_mfma_f32_16x16x32_bf16 v[20:23], a[100:103], v[184:187], v[20:23]
    ds_read_b64_tr_b16 a[88:89], v226 offset:7232
    v_cmp_eq_u32 vcc, -1, v234
    v_mfma_f32_16x16x32_bf16 v[48:51], a[100:103], v[188:191], v[48:51]
    ds_read_b64_tr_b16 a[90:91], v226 offset:10816
    s_cbranch_vccnz Lfix_33
Lok_34:
    s_waitcnt lgkmcnt(10)
    v_mfma_f32_16x16x32_bf16 v[8:11], a[104:107], v[192:195], v[8:11]
    ds_read_b64_tr_b16 a[92:93], v226 offset:7264
    v_mfma_f32_16x16x32_bf16 v[36:39], a[104:107], v[196:199], v[36:39]
    ds_read_b64_tr_b16 a[94:95], v226 offset:10848
    v_mfma_f32_16x16x32_bf16 v[12:15], a[108:111], v[192:195], v[12:15]
    ds_read_b64_tr_b16 a[96:97], v226 offset:14336
    v_mfma_f32_16x16x32_bf16 v[40:43], a[108:111], v[196:199], v[40:43]
    ds_read_b64_tr_b16 a[98:99], v226 offset:17920
    s_waitcnt lgkmcnt(10)
    v_mfma_f32_16x16x32_bf16 v[16:19], a[112:115], v[192:195], v[16:19]
    ds_read_b64_tr_b16 a[100:101], v226 offset:14368
    v_mfma_f32_16x16x32_bf16 v[44:47], a[112:115], v[196:199], v[44:47]
    ds_read_b64_tr_b16 a[102:103], v226 offset:17952
    v_mfma_f32_16x16x32_bf16 v[20:23], a[116:119], v[192:195], v[20:23]
    ds_read_b64_tr_b16 a[104:105], v226 offset:14400
    v_mfma_f32_16x16x32_bf16 v[48:51], a[116:119], v[196:199], v[48:51]
    ds_read_b64_tr_b16 a[106:107], v226 offset:17984
    s_waitcnt lgkmcnt(10)
    v_mfma_f32_16x16x32_bf16 v[8:11], a[120:123], v[200:203], v[8:11]
    ds_read_b64_tr_b16 a[108:109], v226 offset:14432
    v_mfma_f32_16x16x32_bf16 v[36:39], a[120:123], v[204:207], v[36:39]
    ds_read_b64_tr_b16 a[110:111], v226 offset:18016
    v_mfma_f32_16x16x32_bf16 v[12:15], a[124:127], v[200:203], v[12:15]
    ds_read_b64_tr_b16 a[112:113], v226 offset:21504
    s_waitcnt vmcnt(2)
    v_mfma_f32_16x16x32_bf16 v[40:43], a[124:127], v[204:207], v[40:43]
    ds_read_b64_tr_b16 a[114:115], v226 offset:25088
    s_waitcnt lgkmcnt(10)
    v_mfma_f32_16x16x32_bf16 v[16:19], a[88:91], v[200:203], v[16:19]
    ds_read_b64_tr_b16 a[116:117], v226 offset:21536
    v_max3_u32 v234, v211, v215, v219
    v_mfma_f32_16x16x32_bf16 v[44:47], a[88:91], v[204:207], v[44:47]
    ds_read_b64_tr_b16 a[118:119], v226 offset:25120
    v_max_u32 v234, v234, v223
    v_mfma_f32_16x16x32_bf16 v[20:23], a[92:95], v[200:203], v[20:23]
    ds_read_b64_tr_b16 a[120:121], v226 offset:21568
    v_cmp_eq_u32 vcc, -1, v234
    v_mfma_f32_16x16x32_bf16 v[48:51], a[92:95], v[204:207], v[48:51]
    ds_read_b64_tr_b16 a[122:123], v226 offset:25152
    s_cbranch_vccnz Lfix_35
Lok_36:
    s_waitcnt lgkmcnt(10)
    v_mfma_f32_16x16x32_bf16 v[8:11], a[96:99], v[208:211], v[8:11]
    ds_read_b64_tr_b16 a[124:125], v226 offset:21600
    s_waitcnt vmcnt(0)
    v_mfma_f32_16x16x32_bf16 v[36:39], a[96:99], v[212:215], v[36:39]
    ds_read_b64_tr_b16 a[126:127], v226 offset:25184
    v_cmp_ne_u32 vcc, s62, v231
    v_mfma_f32_16x16x32_bf16 v[12:15], a[100:103], v[208:211], v[12:15]
    ds_read_b64_tr_b16 a[88:89], v224 offset:128
    v_cmp_ne_u32 s[58:59], s62, v233
    v_mfma_f32_16x16x32_bf16 v[40:43], a[100:103], v[212:215], v[40:43]
    ds_read_b64_tr_b16 a[90:91], v224 offset:3712
    s_waitcnt lgkmcnt(10)
    v_mfma_f32_16x16x32_bf16 v[16:19], a[104:107], v[208:211], v[16:19]
    ds_read_b64_tr_b16 a[92:93], v224 offset:160
    s_or_b64 vcc, vcc, s[58:59]
    s_cbranch_scc1 Lfix_17
Lok_18:
    v_mfma_f32_16x16x32_bf16 v[44:47], a[104:107], v[212:215], v[44:47]
    ds_read_b64_tr_b16 a[94:95], v224 offset:3744
    v_mfma_f32_16x16x32_bf16 v[20:23], a[108:111], v[208:211], v[20:23]
    ds_read_b64_tr_b16 a[96:97], v224 offset:7296
    v_mfma_f32_16x16x32_bf16 v[48:51], a[108:111], v[212:215], v[48:51]
    ds_read_b64_tr_b16 a[98:99], v224 offset:10880
    s_waitcnt lgkmcnt(10)
    v_mfma_f32_16x16x32_bf16 v[8:11], a[112:115], v[216:219], v[8:11]
    ds_read_b64_tr_b16 a[100:101], v224 offset:7328
    v_and_b32 v231, 0xffff0000, v230
    v_mfma_f32_16x16x32_bf16 v[36:39], a[112:115], v[220:223], v[36:39]
    ds_read_b64_tr_b16 a[102:103], v224 offset:10912
    v_rcp_f32 v230, v231
    v_mfma_f32_16x16x32_bf16 v[12:15], a[116:119], v[216:219], v[12:15]
    ds_read_b64_tr_b16 a[104:105], v224 offset:14464
    v_and_b32 v233, 0xffff0000, v232
    v_mfma_f32_16x16x32_bf16 v[40:43], a[116:119], v[220:223], v[40:43]
    ds_read_b64_tr_b16 a[106:107], v224 offset:18048
    s_waitcnt lgkmcnt(10)
    v_mfma_f32_16x16x32_bf16 v[16:19], a[120:123], v[216:219], v[16:19]
    ds_read_b64_tr_b16 a[108:109], v224 offset:14496
    v_rcp_f32 v232, v233
    v_mfma_f32_16x16x32_bf16 v[44:47], a[120:123], v[220:223], v[44:47]
    ds_read_b64_tr_b16 a[110:111], v224 offset:18080
    v_mul_f32 v230, s44, v230
    v_mfma_f32_16x16x32_bf16 v[20:23], a[124:127], v[216:219], v[20:23]
    ds_read_b64_tr_b16 a[112:113], v224 offset:21632
    v_mul_f32 v232, s44, v232
    v_mfma_f32_16x16x32_bf16 v[48:51], a[124:127], v[220:223], v[48:51]
    ds_read_b64_tr_b16 a[114:115], v224 offset:25216
    v_pk_mul_f32 v[236:237], v[8:9], v[230:231] op_sel:[0,0] op_sel_hi:[1,0]
    v_pk_mul_f32 v[238:239], v[10:11], v[230:231] op_sel:[0,0] op_sel_hi:[1,0]
    v_exp_f32 v236, v236
    v_exp_f32 v237, v237
    v_exp_f32 v238, v238
    v_exp_f32 v239, v239
    buffer_load_dwordx4 a[228:231], v4, s[28:31], s87 offen offset:1024 sc1
    v_pk_fma_f32 v[236:237], v[236:237], v[230:231], v[230:231] op_sel:[0,1,1] op_sel_hi:[1,1,1]
    v_pk_fma_f32 v[238:239], v[238:239], v[230:231], v[230:231] op_sel:[0,1,1] op_sel_hi:[1,1,1]
    v_rcp_f32 v236, v236
    v_rcp_f32 v237, v237
    v_rcp_f32 v238, v238
    v_rcp_f32 v239, v239
    buffer_load_dwordx4 a[232:235], v4, s[28:31], s87 offen offset:2048 sc1
    v_pk_mul_f32 v[236:237], v[236:237], v[8:9]
    v_pk_mul_f32 v[238:239], v[238:239], v[10:11]
    v_cvt_pk_bf16_f32 v244, v236, v237
    v_cvt_pk_bf16_f32 v245, v238, v239
    v_pk_mul_f32 v[240:241], v[12:13], v[230:231] op_sel:[0,0] op_sel_hi:[1,0]
    v_pk_mul_f32 v[242:243], v[14:15], v[230:231] op_sel:[0,0] op_sel_hi:[1,0]
    v_exp_f32 v240, v240
    v_exp_f32 v241, v241
    v_exp_f32 v242, v242
    v_exp_f32 v243, v243
    buffer_load_dwordx4 a[236:239], v4, s[28:31], s87 offen offset:3072 sc1
    v_pk_fma_f32 v[240:241], v[240:241], v[230:231], v[230:231] op_sel:[0,1,1] op_sel_hi:[1,1,1]
    v_pk_fma_f32 v[242:243], v[242:243], v[230:231], v[230:231] op_sel:[0,1,1] op_sel_hi:[1,1,1]
    v_rcp_f32 v240, v240
    v_rcp_f32 v241, v241
    v_rcp_f32 v242, v242
    v_rcp_f32 v243, v243
    v_pk_mul_f32 v[240:241], v[240:241], v[12:13]
    v_pk_mul_f32 v[242:243], v[242:243], v[14:15]
    v_cvt_pk_bf16_f32 v246, v240, v241
    v_cvt_pk_bf16_f32 v247, v242, v243
    buffer_store_dwordx4 v[244:247], v4, s[28:31], s60 offen offset:0 sc1
    v_pk_mul_f32 v[236:237], v[36:37], v[232:233] op_sel:[0,0] op_sel_hi:[1,0]
    v_pk_mul_f32 v[238:239], v[38:39], v[232:233] op_sel:[0,0] op_sel_hi:[1,0]
    v_exp_f32 v236, v236
    v_exp_f32 v237, v237
    v_exp_f32 v238, v238
    v_exp_f32 v239, v239
    s_add_u32 s87, s84, 28672
    buffer_load_dwordx4 a[240:243], v4, s[28:31], s87 offen offset:0 sc1
    v_pk_fma_f32 v[236:237], v[236:237], v[232:233], v[232:233] op_sel:[0,1,1] op_sel_hi:[1,1,1]
    v_pk_fma_f32 v[238:239], v[238:239], v[232:233], v[232:233] op_sel:[0,1,1] op_sel_hi:[1,1,1]
    v_rcp_f32 v236, v236
    v_rcp_f32 v237, v237
    v_rcp_f32 v238, v238
    v_rcp_f32 v239, v239
    buffer_load_dwordx4 a[244:247], v4, s[28:31], s87 offen offset:1024 sc1
    v_pk_mul_f32 v[236:237], v[236:237], v[36:37]
    v_pk_mul_f32 v[238:239], v[238:239], v[38:39]
    v_cvt_pk_bf16_f32 v248, v236, v237
    v_cvt_pk_bf16_f32 v249, v238, v239
    v_pk_mul_f32 v[240:241], v[40:41], v[232:233] op_sel:[0,0] op_sel_hi:[1,0]
    v_pk_mul_f32 v[242:243], v[42:43], v[232:233] op_sel:[0,0] op_sel_hi:[1,0]
    v_exp_f32 v240, v240
    v_exp_f32 v241, v241
    v_exp_f32 v242, v242
    v_exp_f32 v243, v243
    buffer_load_dwordx4 a[248:251], v4, s[28:31], s87 offen offset:2048 sc1
    v_pk_fma_f32 v[240:241], v[240:241], v[232:233], v[232:233] op_sel:[0,1,1] op_sel_hi:[1,1,1]
    v_pk_fma_f32 v[242:243], v[242:243], v[232:233], v[232:233] op_sel:[0,1,1] op_sel_hi:[1,1,1]
    v_rcp_f32 v240, v240
    v_rcp_f32 v241, v241
    v_rcp_f32 v242, v242
    v_rcp_f32 v243, v243
    v_pk_mul_f32 v[240:241], v[240:241], v[40:41]
    v_pk_mul_f32 v[242:243], v[242:243], v[42:43]
    v_cvt_pk_bf16_f32 v250, v240, v241
    v_cvt_pk_bf16_f32 v251, v242, v243
    buffer_store_dwordx4 v[248:251], v4, s[28:31], s61 offen offset:0 sc1
    v_pk_mul_f32 v[236:237], v[16:17], v[230:231] op_sel:[0,0] op_sel_hi:[1,0]
    v_pk_mul_f32 v[238:239], v[18:19], v[230:231] op_sel:[0,0] op_sel_hi:[1,0]
    v_exp_f32 v236, v236
    v_exp_f32 v237, v237
    v_exp_f32 v238, v238
    v_exp_f32 v239, v239
    buffer_load_dwordx4 a[252:255], v4, s[28:31], s87 offen offset:3072 sc1
    v_pk_fma_f32 v[236:237], v[236:237], v[230:231], v[230:231] op_sel:[0,1,1] op_sel_hi:[1,1,1]
    v_pk_fma_f32 v[238:239], v[238:239], v[230:231], v[230:231] op_sel:[0,1,1] op_sel_hi:[1,1,1]
    v_rcp_f32 v236, v236
    v_rcp_f32 v237, v237
    v_rcp_f32 v238, v238
    v_rcp_f32 v239, v239
    s_add_u32 s87, s84, 32768
    buffer_load_dwordx4 a[0:3], v4, s[28:31], s87 offen offset:0 sc1
    v_pk_mul_f32 v[236:237], v[236:237], v[16:17]
    v_pk_mul_f32 v[238:239], v[238:239], v[18:19]
    v_cvt_pk_bf16_f32 v244, v236, v237
    v_cvt_pk_bf16_f32 v245, v238, v239
    v_pk_mul_f32 v[240:241], v[20:21], v[230:231] op_sel:[0,0] op_sel_hi:[1,0]
    v_pk_mul_f32 v[242:243], v[22:23], v[230:231] op_sel:[0,0] op_sel_hi:[1,0]
    v_exp_f32 v240, v240
    v_exp_f32 v241, v241
    v_exp_f32 v242, v242
    v_exp_f32 v243, v243
    buffer_load_dwordx4 a[4:7], v4, s[28:31], s87 offen offset:1024 sc1
    v_pk_fma_f32 v[240:241], v[240:241], v[230:231], v[230:231] op_sel:[0,1,1] op_sel_hi:[1,1,1]
    v_pk_fma_f32 v[242:243], v[242:243], v[230:231], v[230:231] op_sel:[0,1,1] op_sel_hi:[1,1,1]
    v_rcp_f32 v240, v240
    v_rcp_f32 v241, v241
    v_rcp_f32 v242, v242
    v_rcp_f32 v243, v243
    v_pk_mul_f32 v[240:241], v[240:241], v[20:21]
    v_pk_mul_f32 v[242:243], v[242:243], v[22:23]
    v_cvt_pk_bf16_f32 v246, v240, v241
    v_cvt_pk_bf16_f32 v247, v242, v243
    buffer_store_dwordx4 v[244:247], v4, s[28:31], s60 offen offset:1024 sc1
    v_pk_mul_f32 v[236:237], v[44:45], v[232:233] op_sel:[0,0] op_sel_hi:[1,0]
    v_pk_mul_f32 v[238:239], v[46:47], v[232:233] op_sel:[0,0] op_sel_hi:[1,0]
    v_exp_f32 v236, v236
    v_exp_f32 v237, v237
    v_exp_f32 v238, v238
    v_exp_f32 v239, v239
    buffer_load_dwordx4 a[8:11], v4, s[28:31], s87 offen offset:2048 sc1
    v_pk_fma_f32 v[236:237], v[236:237], v[232:233], v[232:233] op_sel:[0,1,1] op_sel_hi:[1,1,1]
    v_pk_fma_f32 v[238:239], v[238:239], v[232:233], v[232:233] op_sel:[0,1,1] op_sel_hi:[1,1,1]
    v_rcp_f32 v236, v236
    v_rcp_f32 v237, v237
    v_rcp_f32 v238, v238
    v_rcp_f32 v239, v239
    buffer_load_dwordx4 a[12:15], v4, s[28:31], s87 offen offset:3072 sc1
    v_pk_mul_f32 v[236:237], v[236:237], v[44:45]
    v_pk_mul_f32 v[238:239], v[238:239], v[46:47]
    v_cvt_pk_bf16_f32 v248, v236, v237
    v_cvt_pk_bf16_f32 v249, v238, v239
    v_pk_mul_f32 v[240:241], v[48:49], v[232:233] op_sel:[0,0] op_sel_hi:[1,0]
    v_pk_mul_f32 v[242:243], v[50:51], v[232:233] op_sel:[0,0] op_sel_hi:[1,0]
    v_exp_f32 v240, v240
    v_exp_f32 v241, v241
    v_exp_f32 v242, v242
    v_exp_f32 v243, v243
    s_add_u32 s87, s84, 36864
    buffer_load_dwordx4 a[16:19], v4, s[28:31], s87 offen offset:0 sc1
    v_pk_fma_f32 v[240:241], v[240:241], v[232:233], v[232:233] op_sel:[0,1,1] op_sel_hi:[1,1,1]
    v_pk_fma_f32 v[242:243], v[242:243], v[232:233], v[232:233] op_sel:[0,1,1] op_sel_hi:[1,1,1]
    v_rcp_f32 v240, v240
    v_rcp_f32 v241, v241
    v_rcp_f32 v242, v242
    v_rcp_f32 v243, v243
    v_pk_mul_f32 v[240:241], v[240:241], v[48:49]
    v_pk_mul_f32 v[242:243], v[242:243], v[50:51]
    v_cvt_pk_bf16_f32 v250, v240, v241
    v_cvt_pk_bf16_f32 v251, v242, v243
    buffer_store_dwordx4 v[248:251], v4, s[28:31], s61 offen offset:1024 sc1
    s_waitcnt lgkmcnt(10)
    v_mfma_f32_16x16x32_bf16 v[24:27], a[88:91], v[64:67], 0
    ds_read_b64_tr_b16 a[116:117], v224 offset:21664
    buffer_load_dwordx4 a[20:23], v4, s[28:31], s87 offen offset:1024 sc1
    v_mfma_f32_16x16x32_bf16 v[52:55], a[88:91], v[68:71], 0
    ds_read_b64_tr_b16 a[118:119], v224 offset:25248
    v_mfma_f32_16x16x32_bf16 v[28:31], a[92:95], v[64:67], 0
    ds_read_b64_tr_b16 a[120:121], v224 offset:28800
    v_mfma_f32_16x16x32_bf16 v[56:59], a[92:95], v[68:71], 0
    ds_read_b64_tr_b16 a[122:123], v224 offset:32384
    s_waitcnt lgkmcnt(10)
    v_mfma_f32_16x16x32_bf16 v[24:27], a[96:99], v[72:75], v[24:27]
    ds_read_b64_tr_b16 a[124:125], v224 offset:28832
    buffer_load_dwordx4 a[24:27], v4, s[28:31], s87 offen offset:2048 sc1
    v_mfma_f32_16x16x32_bf16 v[52:55], a[96:99], v[76:79], v[52:55]
    ds_read_b64_tr_b16 a[126:127], v224 offset:32416
    v_mfma_f32_16x16x32_bf16 v[28:31], a[100:103], v[72:75], v[28:31]
    ds_read_b64_tr_b16 a[88:89], v224 offset:35968
    v_mfma_f32_16x16x32_bf16 v[56:59], a[100:103], v[76:79], v[56:59]
    ds_read_b64_tr_b16 a[90:91], v224 offset:39552
    s_waitcnt lgkmcnt(10)
    v_mfma_f32_16x16x32_bf16 v[24:27], a[104:107], v[80:83], v[24:27]
    ds_read_b64_tr_b16 a[92:93], v224 offset:36000
    buffer_load_dwordx4 a[28:31], v4, s[28:31], s87 offen offset:3072 sc1
    v_mfma_f32_16x16x32_bf16 v[52:55], a[104:107], v[84:87], v[52:55]
    ds_read_b64_tr_b16 a[94:95], v224 offset:39584
    v_mfma_f32_16x16x32_bf16 v[28:31], a[108:111], v[80:83], v[28:31]
    ds_read_b64_tr_b16 a[96:97], v224 offset:43136
    v_mfma_f32_16x16x32_bf16 v[56:59], a[108:111], v[84:87], v[56:59]
    ds_read_b64_tr_b16 a[98:99], v224 offset:46720
    s_waitcnt lgkmcnt(10)
    v_mfma_f32_16x16x32_bf16 v[24:27], a[112:115], v[88:91], v[24:27]
    ds_read_b64_tr_b16 a[100:101], v224 offset:43168
    s_add_u32 s87, s84, 40960
    v_mfma_f32_16x16x32_bf16 v[52:55], a[112:115], v[92:95], v[52:55]
    ds_read_b64_tr_b16 a[102:103], v224 offset:46752
    buffer_load_dwordx4 a[32:35], v4, s[28:31], s87 offen offset:0 sc1
    v_mfma_f32_16x16x32_bf16 v[28:31], a[116:119], v[88:91], v[28:31]
    ds_read_b64_tr_b16 a[104:105], v224 offset:50304
    v_mfma_f32_16x16x32_bf16 v[56:59], a[116:119], v[92:95], v[56:59]
    ds_read_b64_tr_b16 a[106:107], v224 offset:53888
    s_waitcnt lgkmcnt(10)
    v_mfma_f32_16x16x32_bf16 v[24:27], a[120:123], v[96:99], v[24:27]
    ds_read_b64_tr_b16 a[108:109], v224 offset:50336
    buffer_load_dwordx4 a[36:39], v4, s[28:31], s87 offen offset:1024 sc1
    v_mfma_f32_16x16x32_bf16 v[52:55], a[120:123], v[100:103], v[52:55]
    ds_read_b64_tr_b16 a[110:111], v224 offset:53920
    v_mfma_f32_16x16x32_bf16 v[28:31], a[124:127], v[96:99], v[28:31]
    ds_read_b64_tr_b16 a[112:113], v225 offset:128
    v_mfma_f32_16x16x32_bf16 v[56:59], a[124:127], v[100:103], v[56:59]
    ds_read_b64_tr_b16 a[114:115], v225 offset:3712
    s_waitcnt lgkmcnt(10)
    v_mfma_f32_16x16x32_bf16 v[24:27], a[88:91], v[104:107], v[24:27]
    ds_read_b64_tr_b16 a[116:117], v225 offset:160
    buffer_load_dwordx4 a[40:43], v4, s[28:31], s87 offen offset:2048 sc1
    v_mfma_f32_16x16x32_bf16 v[52:55], a[88:91], v[108:111], v[52:55]
    ds_read_b64_tr_b16 a[118:119], v225 offset:3744
    v_mfma_f32_16x16x32_bf16 v[28:31], a[92:95], v[104:107], v[28:31]
    ds_read_b64_tr_b16 a[120:121], v225 offset:7296
    v_mfma_f32_16x16x32_bf16 v[56:59], a[92:95], v[108:111], v[56:59]
    ds_read_b64_tr_b16 a[122:123], v225 offset:10880
    s_waitcnt lgkmcnt(10)
    v_mfma_f32_16x16x32_bf16 v[24:27], a[96:99], v[112:115], v[24:27]
    ds_read_b64_tr_b16 a[124:125], v225 offset:7328
    buffer_load_dwordx4 a[44:47], v4, s[28:31], s87 offen offset:3072 sc1
    v_mfma_f32_16x16x32_bf16 v[52:55], a[96:99], v[116:119], v[52:55]
    ds_read_b64_tr_b16 a[126:127], v225 offset:10912
    v_mfma_f32_16x16x32_bf16 v[28:31], a[100:103], v[112:115], v[28:31]
    ds_read_b64_tr_b16 a[88:89], v225 offset:14464
    v_mfma_f32_16x16x32_bf16 v[56:59], a[100:103], v[116:119], v[56:59]
    ds_read_b64_tr_b16 a[90:91], v225 offset:18048
    s_waitcnt lgkmcnt(10)
    v_mfma_f32_16x16x32_bf16 v[24:27], a[104:107], v[120:123], v[24:27]
    ds_read_b64_tr_b16 a[92:93], v225 offset:14496
    s_add_u32 s87, s84, 45056
    v_mfma_f32_16x16x32_bf16 v[52:55], a[104:107], v[124:127], v[52:55]
    ds_read_b64_tr_b16 a[94:95], v225 offset:18080
    buffer_load_dwordx4 a[48:51], v4, s[28:31], s87 offen offset:0 sc1
    v_mfma_f32_16x16x32_bf16 v[28:31], a[108:111], v[120:123], v[28:31]
    ds_read_b64_tr_b16 a[96:97], v225 offset:21632
    v_mfma_f32_16x16x32_bf16 v[56:59], a[108:111], v[124:127], v[56:59]
    ds_read_b64_tr_b16 a[98:99], v225 offset:25216
    s_waitcnt lgkmcnt(10)
    v_mfma_f32_16x16x32_bf16 v[24:27], a[112:115], v[128:131], v[24:27]
    ds_read_b64_tr_b16 a[100:101], v225 offset:21664
    buffer_load_dwordx4 a[52:55], v4, s[28:31], s87 offen offset:1024 sc1
    v_mfma_f32_16x16x32_bf16 v[52:55], a[112:115], v[132:135], v[52:55]
    ds_read_b64_tr_b16 a[102:103], v225 offset:25248
    v_mfma_f32_16x16x32_bf16 v[28:31], a[116:119], v[128:131], v[28:31]
    ds_read_b64_tr_b16 a[104:105], v225 offset:28800
    v_mfma_f32_16x16x32_bf16 v[56:59], a[116:119], v[132:135], v[56:59]
    ds_read_b64_tr_b16 a[106:107], v225 offset:32384
    s_waitcnt lgkmcnt(10)
    v_mfma_f32_16x16x32_bf16 v[24:27], a[120:123], v[136:139], v[24:27]
    ds_read_b64_tr_b16 a[108:109], v225 offset:28832
    buffer_load_dwordx4 a[56:59], v4, s[28:31], s87 offen offset:2048 sc1
    v_mfma_f32_16x16x32_bf16 v[52:55], a[120:123], v[140:143], v[52:55]
    ds_read_b64_tr_b16 a[110:111], v225 offset:32416
    v_mfma_f32_16x16x32_bf16 v[28:31], a[124:127], v[136:139], v[28:31]
    ds_read_b64_tr_b16 a[112:113], v225 offset:35968
    v_mfma_f32_16x16x32_bf16 v[56:59], a[124:127], v[140:143], v[56:59]
    ds_read_b64_tr_b16 a[114:115], v225 offset:39552
    s_waitcnt lgkmcnt(10)
    v_mfma_f32_16x16x32_bf16 v[24:27], a[88:91], v[144:147], v[24:27]
    ds_read_b64_tr_b16 a[116:117], v225 offset:36000
    buffer_load_dwordx4 a[60:63], v4, s[28:31], s87 offen offset:3072 sc1
    v_mfma_f32_16x16x32_bf16 v[52:55], a[88:91], v[148:151], v[52:55]
    ds_read_b64_tr_b16 a[118:119], v225 offset:39584
    v_mfma_f32_16x16x32_bf16 v[28:31], a[92:95], v[144:147], v[28:31]
    ds_read_b64_tr_b16 a[120:121], v225 offset:43136
    v_mfma_f32_16x16x32_bf16 v[56:59], a[92:95], v[148:151], v[56:59]
    ds_read_b64_tr_b16 a[122:123], v225 offset:46720
    s_waitcnt lgkmcnt(10)
    v_mfma_f32_16x16x32_bf16 v[24:27], a[96:99], v[152:155], v[24:27]
    ds_read_b64_tr_b16 a[124:125], v225 offset:43168
    s_add_u32 s87, s84, 49152
    v_mfma_f32_16x16x32_bf16 v[52:55], a[96:99], v[156:159], v[52:55]
    ds_read_b64_tr_b16 a[126:127], v225 offset:46752
    buffer_load_dwordx4 a[64:67], v4, s[28:31], s87 offen offset:0 sc1
    v_mfma_f32_16x16x32_bf16 v[28:31], a[100:103], v[152:155], v[28:31]
    ds_read_b64_tr_b16 a[88:89], v225 offset:50304
    v_mfma_f32_16x16x32_bf16 v[56:59], a[100:103], v[156:159], v[56:59]
    ds_read_b64_tr_b16 a[90:91], v225 offset:53888
    s_waitcnt lgkmcnt(10)
    v_mfma_f32_16x16x32_bf16 v[24:27], a[104:107], v[160:163], v[24:27]
    ds_read_b64_tr_b16 a[92:93], v225 offset:50336
    buffer_load_dwordx4 a[68:71], v4, s[28:31], s87 offen offset:1024 sc1
    v_mfma_f32_16x16x32_bf16 v[52:55], a[104:107], v[164:167], v[52:55]
    ds_read_b64_tr_b16 a[94:95], v225 offset:53920
    v_mfma_f32_16x16x32_bf16 v[28:31], a[108:111], v[160:163], v[28:31]
    ds_read_b64_tr_b16 a[96:97], v226 offset:128
    v_mfma_f32_16x16x32_bf16 v[56:59], a[108:111], v[164:167], v[56:59]
    ds_read_b64_tr_b16 a[98:99], v226 offset:3712
    s_waitcnt lgkmcnt(10)
    v_mfma_f32_16x16x32_bf16 v[24:27], a[112:115], v[168:171], v[24:27]
    ds_read_b64_tr_b16 a[100:101], v226 offset:160
    buffer_load_dwordx4 a[72:75], v4, s[28:31], s87 offen offset:2048 sc1
    v_mfma_f32_16x16x32_bf16 v[52:55], a[112:115], v[172:175], v[52:55]
    ds_read_b64_tr_b16 a[102:103], v226 offset:3744
    v_mfma_f32_16x16x32_bf16 v[28:31], a[116:119], v[168:171], v[28:31]
    ds_read_b64_tr_b16 a[104:105], v226 offset:7296
    v_mfma_f32_16x16x32_bf16 v[56:59], a[116:119], v[172:175], v[56:59]
    ds_read_b64_tr_b16 a[106:107], v226 offset:10880
    s_waitcnt lgkmcnt(10)
    v_mfma_f32_16x16x32_bf16 v[24:27], a[120:123], v[176:179], v[24:27]
    ds_read_b64_tr_b16 a[108:109], v226 offset:7328
    buffer_load_dwordx4 a[76:79], v4, s[28:31], s87 offen offset:3072 sc1
    v_mfma_f32_16x16x32_bf16 v[52:55], a[120:123], v[180:183], v[52:55]
    ds_read_b64_tr_b16 a[110:111], v226 offset:10912
    v_mfma_f32_16x16x32_bf16 v[28:31], a[124:127], v[176:179], v[28:31]
    ds_read_b64_tr_b16 a[112:113], v226 offset:14464
    v_mfma_f32_16x16x32_bf16 v[56:59], a[124:127], v[180:183], v[56:59]
    ds_read_b64_tr_b16 a[114:115], v226 offset:18048
    s_waitcnt lgkmcnt(10)
    v_mfma_f32_16x16x32_bf16 v[24:27], a[88:91], v[184:187], v[24:27]
    ds_read_b64_tr_b16 a[116:117], v226 offset:14496
    s_waitcnt vmcnt(23)
    v_mfma_f32_16x16x32_bf16 v[52:55], a[88:91], v[188:191], v[52:55]
    ds_read_b64_tr_b16 a[118:119], v226 offset:18080
    buffer_store_dword v5, v235, s[28:31], s45 offen offset:0 sc1
    v_mfma_f32_16x16x32_bf16 v[28:31], a[92:95], v[184:187], v[28:31]
    ds_read_b64_tr_b16 a[120:121], v226 offset:21632
    v_mfma_f32_16x16x32_bf16 v[56:59], a[92:95], v[188:191], v[56:59]
    ds_read_b64_tr_b16 a[122:123], v226 offset:25216
    s_waitcnt lgkmcnt(10)
    v_mfma_f32_16x16x32_bf16 v[24:27], a[96:99], v[192:195], v[24:27]
    ds_read_b64_tr_b16 a[124:125], v226 offset:21664
    s_add_u32 s87, s84, 53248
    v_mfma_f32_16x16x32_bf16 v[52:55], a[96:99], v[196:199], v[52:55]
    ds_read_b64_tr_b16 a[126:127], v226 offset:25248
    buffer_load_dwordx4 a[80:83], v4, s[28:31], s87 offen offset:0 sc1
    v_mfma_f32_16x16x32_bf16 v[28:31], a[100:103], v[192:195], v[28:31]
    ds_read_b64_tr_b16 a[88:89], v252 offset:0
    v_mfma_f32_16x16x32_bf16 v[56:59], a[100:103], v[196:199], v[56:59]
    ds_read_b64_tr_b16 a[90:91], v252 offset:3584
    s_waitcnt lgkmcnt(10)
    v_mfma_f32_16x16x32_bf16 v[24:27], a[104:107], v[200:203], v[24:27]
    ds_read_b64_tr_b16 a[92:93], v252 offset:7168
    buffer_load_dwordx4 a[84:87], v4, s[28:31], s87 offen offset:1024 sc1
    v_mfma_f32_16x16x32_bf16 v[52:55], a[104:107], v[204:207], v[52:55]
    ds_read_b64_tr_b16 a[94:95], v252 offset:10752
    v_mfma_f32_16x16x32_bf16 v[28:31], a[108:111], v[200:203], v[28:31]
    ds_read_b64_tr_b16 a[96:97], v252 offset:14336
    v_mfma_f32_16x16x32_bf16 v[56:59], a[108:111], v[204:207], v[56:59]
    ds_read_b64_tr_b16 a[98:99], v252 offset:17920
    s_waitcnt lgkmcnt(10)
    v_mfma_f32_16x16x32_bf16 v[24:27], a[112:115], v[208:211], v[24:27]
    ds_read_b64_tr_b16 a[100:101], v252 offset:21504
    buffer_load_dwordx4 v[8:11], v4, s[28:31], s87 offen offset:2048 sc1
    v_mfma_f32_16x16x32_bf16 v[52:55], a[112:115], v[212:215], v[52:55]
    ds_read_b64_tr_b16 a[102:103], v252 offset:25088
    v_mfma_f32_16x16x32_bf16 v[28:31], a[116:119], v[208:211], v[28:31]
    ds_read_b64_tr_b16 a[104:105], v252 offset:28672
    s_waitcnt vmcnt(19)
    v_mfma_f32_16x16x32_bf16 v[56:59], a[116:119], v[212:215], v[56:59]
    ds_read_b64_tr_b16 a[106:107], v252 offset:32256
    s_waitcnt lgkmcnt(10)
    v_mfma_f32_16x16x32_bf16 v[24:27], a[120:123], v[216:219], v[24:27]
    ds_read_b64_tr_b16 a[108:109], v252 offset:35840
    buffer_store_dword v5, v235, s[28:31], s45 offen offset:128 sc1
    v_mfma_f32_16x16x32_bf16 v[52:55], a[120:123], v[220:223], v[52:55]
    ds_read_b64_tr_b16 a[110:111], v252 offset:39424
    v_mfma_f32_16x16x32_bf16 v[28:31], a[124:127], v[216:219], v[28:31]
    ds_read_b64_tr_b16 a[112:113], v252 offset:43008
    v_mfma_f32_16x16x32_bf16 v[56:59], a[124:127], v[220:223], v[56:59]
    ds_read_b64_tr_b16 a[114:115], v252 offset:46592
    v_pk_mul_f32 v[236:237], v[24:25], v[230:231] op_sel:[0,0] op_sel_hi:[1,0]
    v_pk_mul_f32 v[238:239], v[26:27], v[230:231] op_sel:[0,0] op_sel_hi:[1,0]
    v_exp_f32 v236, v236
    v_exp_f32 v237, v237
    v_exp_f32 v238, v238
    v_exp_f32 v239, v239
    buffer_load_dwordx4 v[12:15], v4, s[28:31], s87 offen offset:3072 sc1
    v_pk_fma_f32 v[236:237], v[236:237], v[230:231], v[230:231] op_sel:[0,1,1] op_sel_hi:[1,1,1]
    v_pk_fma_f32 v[238:239], v[238:239], v[230:231], v[230:231] op_sel:[0,1,1] op_sel_hi:[1,1,1]
    v_rcp_f32 v236, v236
    v_rcp_f32 v237, v237
    v_rcp_f32 v238, v238
    v_rcp_f32 v239, v239
    s_add_u32 s87, s84, 57344
    buffer_load_dwordx4 v[36:39], v4, s[28:31], s87 offen offset:0 sc1
    v_pk_mul_f32 v[236:237], v[236:237], v[24:25]
    v_pk_mul_f32 v[238:239], v[238:239], v[26:27]
    v_cvt_pk_bf16_f32 v244, v236, v237
    v_cvt_pk_bf16_f32 v245, v238, v239
    v_pk_mul_f32 v[240:241], v[28:29], v[230:231] op_sel:[0,0] op_sel_hi:[1,0]
    v_pk_mul_f32 v[242:243], v[30:31], v[230:231] op_sel:[0,0] op_sel_hi:[1,0]
    v_exp_f32 v240, v240
    v_exp_f32 v241, v241
    v_exp_f32 v242, v242
    v_exp_f32 v243, v243
    buffer_load_dwordx4 v[40:43], v4, s[28:31], s87 offen offset:1024 sc1
    v_pk_fma_f32 v[240:241], v[240:241], v[230:231], v[230:231] op_sel:[0,1,1] op_sel_hi:[1,1,1]
    v_pk_fma_f32 v[242:243], v[242:243], v[230:231], v[230:231] op_sel:[0,1,1] op_sel_hi:[1,1,1]
    v_rcp_f32 v240, v240
    v_rcp_f32 v241, v241
    v_rcp_f32 v242, v242
    v_rcp_f32 v243, v243
    v_pk_mul_f32 v[240:241], v[240:241], v[28:29]
    v_pk_mul_f32 v[242:243], v[242:243], v[30:31]
    v_cvt_pk_bf16_f32 v246, v240, v241
    v_cvt_pk_bf16_f32 v247, v242, v243
    buffer_store_dwordx4 v[244:247], v4, s[28:31], s60 offen offset:2048 sc1
    v_pk_mul_f32 v[236:237], v[52:53], v[232:233] op_sel:[0,0] op_sel_hi:[1,0]
    v_pk_mul_f32 v[238:239], v[54:55], v[232:233] op_sel:[0,0] op_sel_hi:[1,0]
    v_exp_f32 v236, v236
    v_exp_f32 v237, v237
    v_exp_f32 v238, v238
    v_exp_f32 v239, v239
    buffer_load_dwordx4 v[16:19], v4, s[28:31], s87 offen offset:2048 sc1
    v_pk_fma_f32 v[236:237], v[236:237], v[232:233], v[232:233] op_sel:[0,1,1] op_sel_hi:[1,1,1]
    v_pk_fma_f32 v[238:239], v[238:239], v[232:233], v[232:233] op_sel:[0,1,1] op_sel_hi:[1,1,1]
    v_rcp_f32 v236, v236
    v_rcp_f32 v237, v237
    v_rcp_f32 v238, v238
    v_rcp_f32 v239, v239
    buffer_load_dwordx4 v[20:23], v4, s[28:31], s87 offen offset:3072 sc1
    v_pk_mul_f32 v[236:237], v[236:237], v[52:53]
    v_pk_mul_f32 v[238:239], v[238:239], v[54:55]
    v_cvt_pk_bf16_f32 v248, v236, v237
    v_cvt_pk_bf16_f32 v249, v238, v239
    v_pk_mul_f32 v[240:241], v[56:57], v[232:233] op_sel:[0,0] op_sel_hi:[1,0]
    v_pk_mul_f32 v[242:243], v[58:59], v[232:233] op_sel:[0,0] op_sel_hi:[1,0]
    v_exp_f32 v240, v240
    v_exp_f32 v241, v241
    v_exp_f32 v242, v242
    v_exp_f32 v243, v243
    s_add_u32 s87, s84, 61440
    buffer_load_dwordx4 v[44:47], v4, s[28:31], s87 offen offset:0 sc1
    v_pk_fma_f32 v[240:241], v[240:241], v[232:233], v[232:233] op_sel:[0,1,1] op_sel_hi:[1,1,1]
    v_pk_fma_f32 v[242:243], v[242:243], v[232:233], v[232:233] op_sel:[0,1,1] op_sel_hi:[1,1,1]
    v_rcp_f32 v240, v240
    v_rcp_f32 v241, v241
    v_rcp_f32 v242, v242
    v_rcp_f32 v243, v243
    v_pk_mul_f32 v[240:241], v[240:241], v[56:57]
    v_pk_mul_f32 v[242:243], v[242:243], v[58:59]
    v_cvt_pk_bf16_f32 v250, v240, v241
    v_cvt_pk_bf16_f32 v251, v242, v243
    buffer_store_dwordx4 v[248:251], v4, s[28:31], s61 offen offset:2048 sc1
    s_waitcnt lgkmcnt(10)
    v_mfma_f32_16x16x32_bf16 v[32:35], a[88:91], v[64:67], 0
    ds_read_b64_tr_b16 a[116:117], v252 offset:50176
    buffer_load_dwordx4 v[48:51], v4, s[28:31], s87 offen offset:1024 sc1
    v_mfma_f32_16x16x32_bf16 v[60:63], a[88:91], v[68:71], 0
    ds_read_b64_tr_b16 a[118:119], v252 offset:53760
    v_mfma_f32_16x16x32_bf16 v[32:35], a[92:95], v[72:75], v[32:35]
    ds_read_b64_tr_b16 a[120:121], v253 offset:0
    buffer_load_dword v234, v0, s[28:31], s46 offen offset:0 sc1
    v_mfma_f32_16x16x32_bf16 v[60:63], a[92:95], v[76:79], v[60:63]
    ds_read_b64_tr_b16 a[122:123], v253 offset:3584
    s_waitcnt lgkmcnt(10)
    v_mfma_f32_16x16x32_bf16 v[32:35], a[96:99], v[80:83], v[32:35]
    ds_read_b64_tr_b16 a[124:125], v253 offset:7168
    buffer_load_dwordx4 v[24:27], v4, s[28:31], s87 offen offset:2048 sc1
    v_mfma_f32_16x16x32_bf16 v[60:63], a[96:99], v[84:87], v[60:63]
    ds_read_b64_tr_b16 a[126:127], v253 offset:10752
    v_mfma_f32_16x16x32_bf16 v[32:35], a[100:103], v[88:91], v[32:35]
    ds_read_b64_tr_b16 a[88:89], v253 offset:14336
    v_mfma_f32_16x16x32_bf16 v[60:63], a[100:103], v[92:95], v[60:63]
    ds_read_b64_tr_b16 a[90:91], v253 offset:17920
    s_waitcnt lgkmcnt(10)
    v_mfma_f32_16x16x32_bf16 v[32:35], a[104:107], v[96:99], v[32:35]
    ds_read_b64_tr_b16 a[92:93], v253 offset:21504
    buffer_load_dwordx4 v[28:31], v4, s[28:31], s87 offen offset:3072 sc1
    v_mfma_f32_16x16x32_bf16 v[60:63], a[104:107], v[100:103], v[60:63]
    ds_read_b64_tr_b16 a[94:95], v253 offset:25088
    v_mfma_f32_16x16x32_bf16 v[32:35], a[108:111], v[104:107], v[32:35]
    ds_read_b64_tr_b16 a[96:97], v253 offset:28672
    v_mfma_f32_16x16x32_bf16 v[60:63], a[108:111], v[108:111], v[60:63]
    ds_read_b64_tr_b16 a[98:99], v253 offset:32256
    s_waitcnt lgkmcnt(10)
    v_mfma_f32_16x16x32_bf16 v[32:35], a[112:115], v[112:115], v[32:35]
    ds_read_b64_tr_b16 a[100:101], v253 offset:35840
    s_add_u32 s87, s84, 65536
    v_mfma_f32_16x16x32_bf16 v[60:63], a[112:115], v[116:119], v[60:63]
    ds_read_b64_tr_b16 a[102:103], v253 offset:39424
    buffer_load_dwordx4 v[52:55], v4, s[28:31], s87 offen offset:0 sc1
    v_mfma_f32_16x16x32_bf16 v[32:35], a[116:119], v[120:123], v[32:35]
    ds_read_b64_tr_b16 a[104:105], v253 offset:43008
    v_mfma_f32_16x16x32_bf16 v[60:63], a[116:119], v[124:127], v[60:63]
    ds_read_b64_tr_b16 a[106:107], v253 offset:46592
    s_waitcnt lgkmcnt(10)
    v_mfma_f32_16x16x32_bf16 v[32:35], a[120:123], v[128:131], v[32:35]
    ds_read_b64_tr_b16 a[108:109], v253 offset:50176
    buffer_load_dwordx4 v[56:59], v4, s[28:31], s87 offen offset:1024 sc1
    v_mfma_f32_16x16x32_bf16 v[60:63], a[120:123], v[132:135], v[60:63]
    ds_read_b64_tr_b16 a[110:111], v253 offset:53760
    v_mfma_f32_16x16x32_bf16 v[32:35], a[124:127], v[136:139], v[32:35]
    ds_read_b64_tr_b16 a[112:113], v254 offset:0
    s_waitcnt vmcnt(4)
    v_mfma_f32_16x16x32_bf16 v[60:63], a[124:127], v[140:143], v[60:63]
    ds_read_b64_tr_b16 a[114:115], v254 offset:3584
    s_waitcnt lgkmcnt(10)
    v_mfma_f32_16x16x32_bf16 v[32:35], a[88:91], v[144:147], v[32:35]
    ds_read_b64_tr_b16 a[116:117], v254 offset:7168
    v_cmp_ne_u32 vcc, s62, v234
    v_mfma_f32_16x16x32_bf16 v[60:63], a[88:91], v[148:151], v[60:63]
    ds_read_b64_tr_b16 a[118:119], v254 offset:10752
    s_cbranch_vccnz Lfix_37
Lok_38:
    v_mfma_f32_16x16x32_bf16 v[32:35], a[92:95], v[152:155], v[32:35]
    ds_read_b64_tr_b16 a[120:121], v254 offset:14336
    buffer_load_dwordx4 v[64:67], v4, s[28:31], s72 offen offset:0 sc1
    v_mfma_f32_16x16x32_bf16 v[60:63], a[92:95], v[156:159], v[60:63]
    ds_read_b64_tr_b16 a[122:123], v254 offset:17920
    s_waitcnt lgkmcnt(10)
    v_mfma_f32_16x16x32_bf16 v[32:35], a[96:99], v[160:163], v[32:35]
    ds_read_b64_tr_b16 a[124:125], v254 offset:21504
    buffer_load_dwordx4 v[68:71], v4, s[28:31], s76 offen offset:0 sc1
    v_mfma_f32_16x16x32_bf16 v[60:63], a[96:99], v[164:167], v[60:63]
    ds_read_b64_tr_b16 a[126:127], v254 offset:25088
    v_mfma_f32_16x16x32_bf16 v[32:35], a[100:103], v[168:171], v[32:35]
    buffer_load_dwordx4 v[72:75], v4, s[28:31], s80 offen offset:0 sc1
    v_mfma_f32_16x16x32_bf16 v[60:63], a[100:103], v[172:175], v[60:63]
    s_waitcnt lgkmcnt(8)
    v_mfma_f32_16x16x32_bf16 v[32:35], a[104:107], v[176:179], v[32:35]
    buffer_load_dwordx4 v[76:79], v4, s[28:31], s73 offen offset:0 sc1
    v_mfma_f32_16x16x32_bf16 v[60:63], a[104:107], v[180:183], v[60:63]
    v_mfma_f32_16x16x32_bf16 v[32:35], a[108:111], v[184:187], v[32:35]
    buffer_load_dwordx4 v[80:83], v4, s[28:31], s77 offen offset:0 sc1
    v_mfma_f32_16x16x32_bf16 v[60:63], a[108:111], v[188:191], v[60:63]
    s_waitcnt lgkmcnt(4)
    v_mfma_f32_16x16x32_bf16 v[32:35], a[112:115], v[192:195], v[32:35]
    buffer_load_dwordx4 v[84:87], v4, s[28:31], s81 offen offset:0 sc1
    v_mfma_f32_16x16x32_bf16 v[60:63], a[112:115], v[196:199], v[60:63]
    v_mfma_f32_16x16x32_bf16 v[32:35], a[116:119], v[200:203], v[32:35]
    buffer_load_dwordx4 v[88:91], v4, s[28:31], s73 offen offset:3072 sc1
    v_mfma_f32_16x16x32_bf16 v[60:63], a[116:119], v[204:207], v[60:63]
    s_waitcnt lgkmcnt(0)
    v_mfma_f32_16x16x32_bf16 v[32:35], a[120:123], v[208:211], v[32:35]
    buffer_load_dwordx4 v[92:95], v4, s[28:31], s77 offen offset:3072 sc1
    v_mfma_f32_16x16x32_bf16 v[60:63], a[120:123], v[212:215], v[60:63]
    v_mfma_f32_16x16x32_bf16 v[32:35], a[124:127], v[216:219], v[32:35]
    buffer_load_dwordx4 v[96:99], v4, s[28:31], s81 offen offset:3072 sc1
    v_mfma_f32_16x16x32_bf16 v[60:63], a[124:127], v[220:223], v[60:63]
    buffer_load_dword v234, v0, s[28:31], s46 offen offset:128 sc1
    s_nop 4
    v_pk_mul_f32 v[236:237], v[32:33], v[230:231] op_sel:[0,0] op_sel_hi:[1,0]
    v_pk_mul_f32 v[238:239], v[34:35], v[230:231] op_sel:[0,0] op_sel_hi:[1,0]
    v_exp_f32 v236, v236
    v_exp_f32 v237, v237
    v_exp_f32 v238, v238
    v_exp_f32 v239, v239
    v_pk_fma_f32 v[236:237], v[236:237], v[230:231], v[230:231] op_sel:[0,1,1] op_sel_hi:[1,1,1]
    v_pk_fma_f32 v[238:239], v[238:239], v[230:231], v[230:231] op_sel:[0,1,1] op_sel_hi:[1,1,1]
    buffer_load_dwordx4 v[100:103], v4, s[28:31], s74 offen offset:3072 sc1
    v_rcp_f32 v236, v236
    v_rcp_f32 v237, v237
    v_rcp_f32 v238, v238
    v_rcp_f32 v239, v239
    v_pk_mul_f32 v[236:237], v[236:237], v[32:33]
    v_pk_mul_f32 v[238:239], v[238:239], v[34:35]
    v_cvt_pk_bf16_f32 v244, v236, v237
    v_cvt_pk_bf16_f32 v245, v238, v239
    buffer_load_dwordx4 v[104:107], v4, s[28:31], s78 offen offset:3072 sc1
    v_pk_mul_f32 v[240:241], v[60:61], v[232:233] op_sel:[0,0] op_sel_hi:[1,0]
    v_pk_mul_f32 v[242:243], v[62:63], v[232:233] op_sel:[0,0] op_sel_hi:[1,0]
    v_exp_f32 v240, v240
    v_exp_f32 v241, v241
    v_exp_f32 v242, v242
    v_exp_f32 v243, v243
    v_pk_fma_f32 v[240:241], v[240:241], v[232:233], v[232:233] op_sel:[0,1,1] op_sel_hi:[1,1,1]
    v_pk_fma_f32 v[242:243], v[242:243], v[232:233], v[232:233] op_sel:[0,1,1] op_sel_hi:[1,1,1]
    buffer_load_dwordx4 v[108:111], v4, s[28:31], s82 offen offset:3072 sc1
    v_rcp_f32 v240, v240
    v_rcp_f32 v241, v241
    v_rcp_f32 v242, v242
    v_rcp_f32 v243, v243
    v_pk_mul_f32 v[240:241], v[240:241], v[60:61]
    v_pk_mul_f32 v[242:243], v[242:243], v[62:63]
    v_cvt_pk_bf16_f32 v246, v240, v241
    v_cvt_pk_bf16_f32 v247, v242, v243
    buffer_load_dwordx4 v[184:187], v4, s[28:31], s87 offen offset:2048 sc1
    v_permlane16_swap_b32 v244, v246
    v_permlane16_swap_b32 v245, v247
    buffer_store_dwordx4 v[244:247], v229, s[28:31], s100 offen offset:3072 sc1
    buffer_load_dwordx4 v[188:191], v4, s[28:31], s87 offen offset:3072 sc1
    s_waitcnt vmcnt(15)
    v_mfma_f32_16x16x32_bf16 a[88:91], a[128:131], v[64:67], 0
    v_lshrrev_b32 v224, 1, v3
    v_sub_u32 v224, v224, v3
    v_mfma_f32_16x16x32_bf16 a[92:95], a[132:135], v[64:67], 0
    s_add_u32 s87, s84, 69632
    buffer_load_dwordx4 v[32:35], v4, s[28:31], s87 offen offset:0 sc1
    v_mfma_f32_16x16x32_bf16 a[96:99], a[136:139], v[64:67], 0
    v_lshl_add_u32 v224, v224, 7, v227
    v_and_b32 v225, 1, v3
    v_mfma_f32_16x16x32_bf16 a[100:103], a[140:143], v[64:67], 0
    v_lshl_add_u32 v224, v225, 3, v224
    s_lshr_b32 s55, s38, 1
    v_mfma_f32_16x16x32_bf16 a[104:107], a[144:147], v[64:67], 0
    s_waitcnt vmcnt(15)
    s_and_b32 s55, s55, 4
    v_mfma_f32_16x16x32_bf16 a[108:111], a[128:131], v[68:71], 0
    s_lshl3_add_u32 s55, s37, s55
    s_and_b32 s53, s38, 7
    v_mfma_f32_16x16x32_bf16 a[112:115], a[132:135], v[68:71], 0
    s_add_u32 s56, s55, s36
    s_mul_i32 s68, s56, 62976
    v_mfma_f32_16x16x32_bf16 a[116:119], a[136:139], v[68:71], 0
    v_mfma_f32_16x16x32_bf16 a[120:123], a[140:143], v[68:71], 0
    buffer_store_dword v5, v235, s[28:31], s45 offen offset:256 sc1
    v_mfma_f32_16x16x32_bf16 a[124:127], a[144:147], v[68:71], 0
    s_waitcnt vmcnt(15)
    s_add_u32 s68, s68, 20480
    v_mfma_f32_16x16x32_bf16 v[144:147], a[128:131], v[72:75], 0
    s_add_u32 s71, s68, 8192
    s_lshl_b32 s54, s53, 8
    v_mfma_f32_16x16x32_bf16 v[148:151], a[132:135], v[72:75], 0
    buffer_load_dwordx4 v[60:63], v4, s[28:31], s87 offen offset:1024 sc1
    s_add_u32 s68, s68, s54
    v_mfma_f32_16x16x32_bf16 v[152:155], a[136:139], v[72:75], 0
    s_waitcnt vmcnt(9)
    v_mfma_f32_16x16x32_bf16 v[156:159], a[140:143], v[72:75], 0
    v_cmp_ne_u32 vcc, s62, v234
    v_mfma_f32_16x16x32_bf16 v[160:163], a[144:147], v[72:75], 0
    s_cbranch_vccnz Lfix_39
Lok_40:
    v_mfma_f32_16x16x32_bf16 a[88:91], a[148:151], v[76:79], a[88:91]
    buffer_load_dwordx4 v[112:115], v4, s[28:31], s72 offen offset:1024 sc1
    s_add_u32 s69, s68, 4096
    v_mfma_f32_16x16x32_bf16 a[92:95], a[152:155], v[76:79], a[92:95]
    s_add_u32 s70, s68, 8192
    s_mul_i32 s44, s56, 1280
    v_mfma_f32_16x16x32_bf16 a[96:99], a[156:159], v[76:79], a[96:99]
    s_mul_i32 s53, s53, 160
    s_add_u32 s44, s44, s53
    v_mfma_f32_16x16x32_bf16 a[100:103], a[160:163], v[76:79], a[100:103]
    buffer_load_dwordx4 v[116:119], v4, s[28:31], s76 offen offset:1024 sc1
    s_add_u32 s52, s36, 1
    v_mfma_f32_16x16x32_bf16 a[104:107], a[164:167], v[76:79], a[104:107]
    s_and_b32 s52, s52, 3
    s_mul_i32 s52, s52, 15360
    v_mfma_f32_16x16x32_bf16 a[108:111], a[148:151], v[80:83], a[108:111]
    buffer_load_dwordx4 v[120:123], v4, s[28:31], s80 offen offset:1024 sc1
    s_add_u32 s52, s52, 0
    v_mfma_f32_16x16x32_bf16 a[112:115], a[152:155], v[80:83], a[112:115]
    v_add_u32 v230, s52, v4
    s_add_u32 s52, s36, 2
    v_mfma_f32_16x16x32_bf16 a[116:119], a[156:159], v[80:83], a[116:119]
    s_and_b32 s52, s52, 3
    s_mul_i32 s52, s52, 15360
    v_mfma_f32_16x16x32_bf16 a[120:123], a[160:163], v[80:83], a[120:123]
    buffer_load_dwordx4 v[124:127], v4, s[28:31], s73 offen offset:1024 sc1
    s_add_u32 s52, s52, 5120
    v_mfma_f32_16x16x32_bf16 a[124:127], a[164:167], v[80:83], a[124:127]
    v_add_u32 v231, s52, v4
    s_add_u32 s52, s36, 3
    v_mfma_f32_16x16x32_bf16 v[144:147], a[148:151], v[84:87], v[144:147]
    buffer_load_dwordx4 v[128:131], v4, s[28:31], s77 offen offset:1024 sc1
    s_and_b32 s52, s52, 3
    v_mfma_f32_16x16x32_bf16 v[148:151], a[152:155], v[84:87], v[148:151]
    s_mul_i32 s52, s52, 15360
    s_add_u32 s52, s52, 10240
    v_mfma_f32_16x16x32_bf16 v[152:155], a[156:159], v[84:87], v[152:155]
    v_add_u32 v232, s52, v4
    s_mul_i32 s52, s36, 15360
    v_mfma_f32_16x16x32_bf16 v[156:159], a[160:163], v[84:87], v[156:159]
    buffer_load_dwordx4 v[132:135], v4, s[28:31], s81 offen offset:1024 sc1
    v_add_u32 v229, s52, v4
    v_mfma_f32_16x16x32_bf16 v[160:163], a[164:167], v[84:87], v[160:163]
    v_mul_u32_u24 v225, 176, v2
    v_mad_u32_u24 v225, v3, 40, v225
    s_barrier
    v_mfma_f32_16x16x32_bf16 a[88:91], a[168:171], v[88:91], a[88:91]
    buffer_load_dwordx4 v[136:139], v4, s[28:31], s74 offen offset:0 sc1
    v_add_u32 v225, s52, v225
    v_mfma_f32_16x16x32_bf16 a[92:95], a[172:175], v[88:91], a[92:95]
    buffer_load_dwordx2 v[192:193], v224, s[28:31], s68 offen offset:0 sc1
    s_movk_i32 s53, 6554
    v_mfma_f32_16x16x32_bf16 a[96:99], a[176:179], v[88:91], a[96:99]
    v_add_u32 v239, 0, v1
    v_mul_u32_u24 v236, s53, v239
    v_mfma_f32_16x16x32_bf16 a[100:103], a[180:183], v[88:91], a[100:103]
    buffer_load_dwordx4 v[140:143], v4, s[28:31], s78 offen offset:0 sc1
    v_lshrrev_b32 v236, 16, v236
    v_mfma_f32_16x16x32_bf16 a[104:107], a[184:187], v[88:91], a[104:107]
    v_add_u32 v240, v239, v236
    v_lshl_add_u32 v240, v240, 4, s52
    v_mfma_f32_16x16x32_bf16 a[108:111], a[168:171], v[92:95], a[108:111]
    buffer_load_dwordx4 v[64:67], v4, s[28:31], s82 offen offset:0 sc1
    v_mul_u32_u24 v236, 163680, v236
    v_mfma_f32_16x16x32_bf16 a[112:115], a[172:175], v[92:95], a[112:115]
    v_lshl_add_u32 v236, v239, 4, v236
    v_add_u32 v239, 64, v1
    v_mfma_f32_16x16x32_bf16 a[116:119], a[176:179], v[92:95], a[116:119]
    v_mul_u32_u24 v237, s53, v239
    v_lshrrev_b32 v237, 16, v237
    v_mfma_f32_16x16x32_bf16 a[120:123], a[180:183], v[92:95], a[120:123]
    buffer_load_dwordx4 v[68:71], v4, s[28:31], s75 offen offset:0 sc1
    v_add_u32 v241, v239, v237
    v_mfma_f32_16x16x32_bf16 a[124:127], a[184:187], v[92:95], a[124:127]
    v_lshl_add_u32 v241, v241, 4, s52
    v_mul_u32_u24 v237, 163680, v237
    v_mfma_f32_16x16x32_bf16 v[144:147], a[168:171], v[96:99], v[144:147]
    buffer_load_dwordx4 v[72:75], v4, s[28:31], s79 offen offset:0 sc1
    v_lshl_add_u32 v237, v239, 4, v237
    v_mfma_f32_16x16x32_bf16 v[148:151], a[172:175], v[96:99], v[148:151]
    buffer_load_dwordx2 v[194:195], v224, s[28:31], s68 offen offset:2048 sc1
    v_add_u32 v239, 128, v1
    v_mfma_f32_16x16x32_bf16 v[152:155], a[176:179], v[96:99], v[152:155]
    buffer_load_dword v234, v0, s[28:31], s46 offen offset:256 sc1
    v_mfma_f32_16x16x32_bf16 v[156:159], a[180:183], v[96:99], v[156:159]
    v_mul_u32_u24 v238, s53, v239
    v_lshrrev_b32 v238, 16, v238
    v_mfma_f32_16x16x32_bf16 v[160:163], a[184:187], v[96:99], v[160:163]
    s_waitcnt vmcnt(22)
    v_add_u32 v242, v239, v238
    v_mfma_f32_16x16x32_bf16 a[88:91], a[188:191], v[100:103], a[88:91]
    buffer_load_dwordx4 v[76:79], v4, s[28:31], s83 offen offset:0 sc1
    v_lshl_add_u32 v242, v242, 4, s52
    v_mfma_f32_16x16x32_bf16 a[92:95], a[192:195], v[100:103], a[92:95]
    v_mul_u32_u24 v238, 163680, v238
    v_lshl_add_u32 v238, v239, 4, v238
    v_mfma_f32_16x16x32_bf16 a[96:99], a[196:199], v[100:103], a[96:99]
    v_mfma_f32_16x16x32_bf16 a[100:103], a[200:203], v[100:103], a[100:103]
    v_mfma_f32_16x16x32_bf16 a[104:107], a[204:207], v[100:103], a[104:107]
    s_waitcnt vmcnt(22)
    v_mfma_f32_16x16x32_bf16 a[108:111], a[188:191], v[104:107], a[108:111]
    v_mfma_f32_16x16x32_bf16 a[112:115], a[192:195], v[104:107], a[112:115]
    buffer_load_dwordx2 v[196:197], v224, s[28:31], s69 offen offset:0 sc1
    v_mfma_f32_16x16x32_bf16 a[116:119], a[196:199], v[104:107], a[116:119]
    v_mfma_f32_16x16x32_bf16 a[120:123], a[200:203], v[104:107], a[120:123]
    v_mfma_f32_16x16x32_bf16 a[124:127], a[204:207], v[104:107], a[124:127]
    s_waitcnt vmcnt(22)
    v_mfma_f32_16x16x32_bf16 v[144:147], a[188:191], v[108:111], v[144:147]
    v_mfma_f32_16x16x32_bf16 v[148:151], a[192:195], v[108:111], v[148:151]
    v_mfma_f32_16x16x32_bf16 v[152:155], a[196:199], v[108:111], v[152:155]
    v_mfma_f32_16x16x32_bf16 v[156:159], a[200:203], v[108:111], v[156:159]
    v_mfma_f32_16x16x32_bf16 v[160:163], a[204:207], v[108:111], v[160:163]
    s_waitcnt vmcnt(15)
    v_mfma_f32_16x16x32_bf16 a[88:91], a[208:211], v[112:115], a[88:91]
    v_mfma_f32_16x16x32_bf16 a[92:95], a[212:215], v[112:115], a[92:95]
    buffer_load_dwordx2 v[198:199], v224, s[28:31], s69 offen offset:2048 sc1
    v_mfma_f32_16x16x32_bf16 a[96:99], a[216:219], v[112:115], a[96:99]
    v_mfma_f32_16x16x32_bf16 a[100:103], a[220:223], v[112:115], a[100:103]
    buffer_store_dword v5, v235, s[28:31], s45 offen offset:384 sc1
    v_mfma_f32_16x16x32_bf16 a[104:107], a[224:227], v[112:115], a[104:107]
    s_waitcnt vmcnt(16)
    v_mfma_f32_16x16x32_bf16 a[108:111], a[208:211], v[116:119], a[108:111]
    v_mfma_f32_16x16x32_bf16 a[112:115], a[212:215], v[116:119], a[112:115]
    v_mfma_f32_16x16x32_bf16 a[116:119], a[216:219], v[116:119], a[116:119]
    v_mfma_f32_16x16x32_bf16 a[120:123], a[220:223], v[116:119], a[120:123]
    v_mfma_f32_16x16x32_bf16 a[124:127], a[224:227], v[116:119], a[124:127]
    s_waitcnt vmcnt(15)
    v_mfma_f32_16x16x32_bf16 v[144:147], a[208:211], v[120:123], v[144:147]
    v_mfma_f32_16x16x32_bf16 v[148:151], a[212:215], v[120:123], v[148:151]
    buffer_load_dwordx2 v[200:201], v224, s[28:31], s70 offen offset:0 sc1
    v_mfma_f32_16x16x32_bf16 v[152:155], a[216:219], v[120:123], v[152:155]
    v_mfma_f32_16x16x32_bf16 v[156:159], a[220:223], v[120:123], v[156:159]
    v_mfma_f32_16x16x32_bf16 v[160:163], a[224:227], v[120:123], v[160:163]
    s_waitcnt vmcnt(15)
    v_mfma_f32_16x16x32_bf16 a[88:91], a[228:231], v[124:127], a[88:91]
    v_mfma_f32_16x16x32_bf16 a[92:95], a[232:235], v[124:127], a[92:95]
    v_mfma_f32_16x16x32_bf16 a[96:99], a[236:239], v[124:127], a[96:99]
    v_mfma_f32_16x16x32_bf16 a[100:103], a[240:243], v[124:127], a[100:103]
    v_mfma_f32_16x16x32_bf16 a[104:107], a[244:247], v[124:127], a[104:107]
    s_waitcnt vmcnt(14)
    v_mfma_f32_16x16x32_bf16 a[108:111], a[228:231], v[128:131], a[108:111]
    v_mfma_f32_16x16x32_bf16 a[112:115], a[232:235], v[128:131], a[112:115]
    buffer_load_dword v222, v227, s[28:31], s71 offen offset:2048 sc1
    v_mfma_f32_16x16x32_bf16 a[116:119], a[236:239], v[128:131], a[116:119]
    s_waitcnt vmcnt(6)
    v_mfma_f32_16x16x32_bf16 a[120:123], a[240:243], v[128:131], a[120:123]
    v_cmp_ne_u32 vcc, s62, v234
    v_mfma_f32_16x16x32_bf16 a[124:127], a[244:247], v[128:131], a[124:127]
    s_cbranch_vccnz Lfix_41
Lok_42:
    v_mfma_f32_16x16x32_bf16 v[144:147], a[228:231], v[132:135], v[144:147]
    buffer_load_dwordx4 v[80:83], v4, s[28:31], s72 offen offset:2048 sc1
    v_mfma_f32_16x16x32_bf16 v[148:151], a[232:235], v[132:135], v[148:151]
    v_mfma_f32_16x16x32_bf16 v[152:155], a[236:239], v[132:135], v[152:155]
    v_mfma_f32_16x16x32_bf16 v[156:159], a[240:243], v[132:135], v[156:159]
    buffer_load_dwordx4 v[84:87], v4, s[28:31], s76 offen offset:2048 sc1
    v_mfma_f32_16x16x32_bf16 v[160:163], a[244:247], v[132:135], v[160:163]
    v_mfma_f32_16x16x32_bf16 a[88:91], a[248:251], v[136:139], a[88:91]
    buffer_load_dwordx4 v[88:91], v4, s[28:31], s80 offen offset:2048 sc1
    v_mfma_f32_16x16x32_bf16 a[92:95], a[252:255], v[136:139], a[92:95]
    v_mfma_f32_16x16x32_bf16 a[96:99], a[0:3], v[136:139], a[96:99]
    v_mfma_f32_16x16x32_bf16 a[100:103], a[4:7], v[136:139], a[100:103]
    buffer_load_dwordx4 v[92:95], v4, s[28:31], s73 offen offset:2048 sc1
    v_mfma_f32_16x16x32_bf16 a[104:107], a[8:11], v[136:139], a[104:107]
    v_mfma_f32_16x16x32_bf16 a[108:111], a[248:251], v[140:143], a[108:111]
    buffer_load_dwordx4 v[96:99], v4, s[28:31], s77 offen offset:2048 sc1
    v_mfma_f32_16x16x32_bf16 a[112:115], a[252:255], v[140:143], a[112:115]
    v_mfma_f32_16x16x32_bf16 a[116:119], a[0:3], v[140:143], a[116:119]
    v_mfma_f32_16x16x32_bf16 a[120:123], a[4:7], v[140:143], a[120:123]
    buffer_load_dwordx4 v[100:103], v4, s[28:31], s81 offen offset:2048 sc1
    v_mfma_f32_16x16x32_bf16 a[124:127], a[8:11], v[140:143], a[124:127]
    v_mfma_f32_16x16x32_bf16 v[144:147], a[248:251], v[64:67], v[144:147]
    buffer_load_dwordx4 v[104:107], v4, s[28:31], s74 offen offset:1024 sc1
    v_mfma_f32_16x16x32_bf16 v[148:151], a[252:255], v[64:67], v[148:151]
    v_mfma_f32_16x16x32_bf16 v[152:155], a[0:3], v[64:67], v[152:155]
    buffer_load_dword v234, v0, s[28:31], s46 offen offset:384 sc1
    v_mfma_f32_16x16x32_bf16 v[156:159], a[4:7], v[64:67], v[156:159]
    buffer_load_dwordx4 v[108:111], v4, s[28:31], s78 offen offset:1024 sc1
    v_mfma_f32_16x16x32_bf16 v[160:163], a[8:11], v[64:67], v[160:163]
    v_mfma_f32_16x16x32_bf16 a[88:91], a[12:15], v[68:71], a[88:91]
    buffer_load_dwordx4 v[112:115], v4, s[28:31], s82 offen offset:1024 sc1
    v_mfma_f32_16x16x32_bf16 a[92:95], a[16:19], v[68:71], a[92:95]
    v_mfma_f32_16x16x32_bf16 a[96:99], a[20:23], v[68:71], a[96:99]
    v_mfma_f32_16x16x32_bf16 a[100:103], a[24:27], v[68:71], a[100:103]
    buffer_load_dwordx4 v[116:119], v4, s[28:31], s75 offen offset:1024 sc1
    v_mfma_f32_16x16x32_bf16 a[104:107], a[28:31], v[68:71], a[104:107]
    v_mfma_f32_16x16x32_bf16 a[108:111], a[12:15], v[72:75], a[108:111]
    buffer_load_dwordx4 v[120:123], v4, s[28:31], s79 offen offset:1024 sc1
    v_mfma_f32_16x16x32_bf16 a[112:115], a[16:19], v[72:75], a[112:115]
    v_mfma_f32_16x16x32_bf16 a[116:119], a[20:23], v[72:75], a[116:119]
    v_mfma_f32_16x16x32_bf16 a[120:123], a[24:27], v[72:75], a[120:123]
    buffer_load_dwordx4 v[124:127], v4, s[28:31], s83 offen offset:1024 sc1
    v_mfma_f32_16x16x32_bf16 a[124:127], a[28:31], v[72:75], a[124:127]
    s_waitcnt vmcnt(18)
    v_mfma_f32_16x16x32_bf16 v[144:147], a[12:15], v[76:79], v[144:147]
    v_mfma_f32_16x16x32_bf16 v[148:151], a[16:19], v[76:79], v[148:151]
    v_mfma_f32_16x16x32_bf16 v[152:155], a[20:23], v[76:79], v[152:155]
    v_mfma_f32_16x16x32_bf16 v[156:159], a[24:27], v[76:79], v[156:159]
    v_mfma_f32_16x16x32_bf16 v[160:163], a[28:31], v[76:79], v[160:163]
    s_waitcnt vmcnt(12)
    v_mfma_f32_16x16x32_bf16 a[88:91], a[32:35], v[80:83], a[88:91]
    v_mfma_f32_16x16x32_bf16 a[92:95], a[36:39], v[80:83], a[92:95]
    v_mfma_f32_16x16x32_bf16 a[96:99], a[40:43], v[80:83], a[96:99]
    v_mfma_f32_16x16x32_bf16 a[100:103], a[44:47], v[80:83], a[100:103]
    v_mfma_f32_16x16x32_bf16 a[104:107], a[48:51], v[80:83], a[104:107]
    s_waitcnt vmcnt(11)
    v_mfma_f32_16x16x32_bf16 a[108:111], a[32:35], v[84:87], a[108:111]
    v_mfma_f32_16x16x32_bf16 a[112:115], a[36:39], v[84:87], a[112:115]
    v_mfma_f32_16x16x32_bf16 a[116:119], a[40:43], v[84:87], a[116:119]
    v_mfma_f32_16x16x32_bf16 a[120:123], a[44:47], v[84:87], a[120:123]
    v_mfma_f32_16x16x32_bf16 a[124:127], a[48:51], v[84:87], a[124:127]
    s_waitcnt vmcnt(10)
    v_mfma_f32_16x16x32_bf16 v[144:147], a[32:35], v[88:91], v[144:147]
    v_mfma_f32_16x16x32_bf16 v[148:151], a[36:39], v[88:91], v[148:151]
    v_mfma_f32_16x16x32_bf16 v[152:155], a[40:43], v[88:91], v[152:155]
    v_mfma_f32_16x16x32_bf16 v[156:159], a[44:47], v[88:91], v[156:159]
    v_mfma_f32_16x16x32_bf16 v[160:163], a[48:51], v[88:91], v[160:163]
    s_waitcnt vmcnt(9)
    v_mfma_f32_16x16x32_bf16 a[88:91], a[52:55], v[92:95], a[88:91]
    v_mfma_f32_16x16x32_bf16 a[92:95], a[56:59], v[92:95], a[92:95]
    v_mfma_f32_16x16x32_bf16 a[96:99], a[60:63], v[92:95], a[96:99]
    s_waitcnt vmcnt(5)
    v_mfma_f32_16x16x32_bf16 a[100:103], a[64:67], v[92:95], a[100:103]
    v_cmp_ne_u32 vcc, s62, v234
    v_mfma_f32_16x16x32_bf16 a[104:107], a[68:71], v[92:95], a[104:107]
    s_cbranch_vccnz Lfix_43
Lok_44:
    v_mfma_f32_16x16x32_bf16 a[108:111], a[52:55], v[96:99], a[108:111]
    buffer_load_dwordx4 v[128:131], v4, s[28:31], s72 offen offset:3072 sc1
    v_lshlrev_b32 v222, 16, v222
    v_mfma_f32_16x16x32_bf16 a[112:115], a[56:59], v[96:99], a[112:115]
    v_lshlrev_b32 v202, 16, v192
    v_and_b32 v207, 0xffff0000, v192
    v_mfma_f32_16x16x32_bf16 a[116:119], a[60:63], v[96:99], a[116:119]
    v_lshlrev_b32 v212, 16, v193
    v_and_b32 v217, 0xffff0000, v193
    v_mfma_f32_16x16x32_bf16 a[120:123], a[64:67], v[96:99], a[120:123]
    buffer_load_dwordx4 v[132:135], v4, s[28:31], s74 offen offset:2048 sc1
    v_lshlrev_b32 v203, 16, v194
    v_mfma_f32_16x16x32_bf16 a[124:127], a[68:71], v[96:99], a[124:127]
    v_and_b32 v208, 0xffff0000, v194
    v_lshlrev_b32 v213, 16, v195
    v_mfma_f32_16x16x32_bf16 v[144:147], a[52:55], v[100:103], v[144:147]
    buffer_load_dwordx4 v[136:139], v4, s[28:31], s76 offen offset:3072 sc1
    v_and_b32 v218, 0xffff0000, v195
    v_mfma_f32_16x16x32_bf16 v[148:151], a[56:59], v[100:103], v[148:151]
    v_lshlrev_b32 v204, 16, v196
    v_and_b32 v209, 0xffff0000, v196
    v_mfma_f32_16x16x32_bf16 v[152:155], a[60:63], v[100:103], v[152:155]
    v_lshlrev_b32 v214, 16, v197
    v_and_b32 v219, 0xffff0000, v197
    v_mfma_f32_16x16x32_bf16 v[156:159], a[64:67], v[100:103], v[156:159]
    buffer_load_dwordx4 v[140:143], v4, s[28:31], s78 offen offset:2048 sc1
    v_lshlrev_b32 v205, 16, v198
    v_mfma_f32_16x16x32_bf16 v[160:163], a[68:71], v[100:103], v[160:163]
    v_and_b32 v210, 0xffff0000, v198
    v_lshlrev_b32 v215, 16, v199
    v_mfma_f32_16x16x32_bf16 a[88:91], a[72:75], v[104:107], a[88:91]
    buffer_load_dwordx4 v[64:67], v4, s[28:31], s80 offen offset:3072 sc1
    v_and_b32 v220, 0xffff0000, v199
    v_mfma_f32_16x16x32_bf16 a[92:95], a[76:79], v[104:107], a[92:95]
    v_lshlrev_b32 v206, 16, v200
    v_and_b32 v211, 0xffff0000, v200
    v_mfma_f32_16x16x32_bf16 a[96:99], a[80:83], v[104:107], a[96:99]
    v_lshlrev_b32 v216, 16, v201
    v_and_b32 v221, 0xffff0000, v201
    v_mfma_f32_16x16x32_bf16 a[100:103], a[84:87], v[104:107], a[100:103]
    buffer_load_dwordx4 v[68:71], v4, s[28:31], s82 offen offset:2048 sc1
    v_sub_f32 v202, v202, v222
    v_mfma_f32_16x16x32_bf16 a[104:107], v[8:11], v[104:107], a[104:107]
    s_waitcnt vmcnt(10)
    v_sub_f32 v203, v203, v222
    v_mfma_f32_16x16x32_bf16 a[108:111], a[72:75], v[108:111], a[108:111]
    buffer_load_dwordx4 v[72:75], v4, s[28:31], s64 offen offset:0 sc1
    v_sub_f32 v204, v204, v222
    v_mfma_f32_16x16x32_bf16 a[112:115], a[76:79], v[108:111], a[112:115]
    v_sub_f32 v205, v205, v222
    v_sub_f32 v206, v206, v222
    v_mfma_f32_16x16x32_bf16 a[116:119], a[80:83], v[108:111], a[116:119]
    v_sub_f32 v207, v207, v222
    v_sub_f32 v208, v208, v222
    v_mfma_f32_16x16x32_bf16 a[120:123], a[84:87], v[108:111], a[120:123]
    buffer_load_dwordx4 v[76:79], v4, s[28:31], s65 offen offset:0 sc1
    v_sub_f32 v209, v209, v222
    v_mfma_f32_16x16x32_bf16 a[124:127], v[8:11], v[108:111], a[124:127]
    s_waitcnt vmcnt(11)
    v_sub_f32 v210, v210, v222
    v_mfma_f32_16x16x32_bf16 v[144:147], a[72:75], v[112:115], v[144:147]
    buffer_load_dwordx4 v[80:83], v4, s[28:31], s65 offen offset:3072 sc1
    v_sub_f32 v211, v211, v222
    v_mfma_f32_16x16x32_bf16 v[148:151], a[76:79], v[112:115], v[148:151]
    v_sub_f32 v212, v212, v222
    v_sub_f32 v213, v213, v222
    v_mfma_f32_16x16x32_bf16 v[152:155], a[80:83], v[112:115], v[152:155]
    v_sub_f32 v214, v214, v222
    v_sub_f32 v215, v215, v222
    v_mfma_f32_16x16x32_bf16 v[156:159], a[84:87], v[112:115], v[156:159]
    buffer_load_dwordx4 v[84:87], v4, s[28:31], s66 offen offset:3072 sc1
    v_sub_f32 v216, v216, v222
    v_mfma_f32_16x16x32_bf16 v[160:163], v[8:11], v[112:115], v[160:163]
    s_waitcnt vmcnt(12)
    v_sub_f32 v217, v217, v222
    v_mfma_f32_16x16x32_bf16 a[88:91], v[12:15], v[116:119], a[88:91]
    buffer_load_dwordx4 v[88:91], v4, s[28:31], s64 offen offset:1024 sc1
    v_sub_f32 v218, v218, v222
    v_mfma_f32_16x16x32_bf16 a[92:95], v[36:39], v[116:119], a[92:95]
    v_sub_f32 v219, v219, v222
    v_sub_f32 v220, v220, v222
    v_mfma_f32_16x16x32_bf16 a[96:99], v[40:43], v[116:119], a[96:99]
    v_sub_f32 v221, v221, v222
    v_cvt_pk_bf16_f32 v192, v202, v203
    v_mfma_f32_16x16x32_bf16 a[100:103], v[16:19], v[116:119], a[100:103]
    buffer_load_dwordx4 v[92:95], v4, s[28:31], s65 offen offset:1024 sc1
    v_cvt_pk_bf16_f32 v193, v204, v205
    v_mfma_f32_16x16x32_bf16 a[104:107], v[20:23], v[116:119], a[104:107]
    s_waitcnt vmcnt(13)
    v_cvt_pk_bf16_f32 v194, v206, v207
    v_mfma_f32_16x16x32_bf16 a[108:111], v[12:15], v[120:123], a[108:111]
    buffer_load_dwordx4 v[96:99], v4, s[28:31], s66 offen offset:0 sc1
    v_cvt_pk_bf16_f32 v195, v208, v209
    v_mfma_f32_16x16x32_bf16 a[112:115], v[36:39], v[120:123], a[112:115]
    v_cvt_pk_bf16_f32 v196, v210, v211
    v_cvt_pk_bf16_f32 v197, v212, v213
    v_mfma_f32_16x16x32_bf16 a[116:119], v[40:43], v[120:123], a[116:119]
    v_cvt_pk_bf16_f32 v198, v214, v215
    v_cvt_pk_bf16_f32 v199, v216, v217
    v_mfma_f32_16x16x32_bf16 a[120:123], v[16:19], v[120:123], a[120:123]
    v_cvt_pk_bf16_f32 v200, v218, v219
    v_cvt_pk_bf16_f32 v201, v220, v221
    v_mfma_f32_16x16x32_bf16 a[124:127], v[20:23], v[120:123], a[124:127]
    s_waitcnt vmcnt(13)
    v_lshlrev_b32 v202, 16, v192
    v_mfma_f32_16x16x32_bf16 v[144:147], v[12:15], v[124:127], v[144:147]
    buffer_load_dwordx4 v[100:103], v4, s[28:31], s67 offen offset:0 sc1
    v_and_b32 v203, 0xffff0000, v192
    v_mfma_f32_16x16x32_bf16 v[148:151], v[36:39], v[124:127], v[148:151]
    v_lshlrev_b32 v204, 16, v193
    v_and_b32 v205, 0xffff0000, v193
    v_mfma_f32_16x16x32_bf16 v[152:155], v[40:43], v[124:127], v[152:155]
    v_lshlrev_b32 v206, 16, v194
    v_and_b32 v207, 0xffff0000, v194
    v_mfma_f32_16x16x32_bf16 v[156:159], v[16:19], v[124:127], v[156:159]
    v_lshlrev_b32 v208, 16, v195
    v_and_b32 v209, 0xffff0000, v195
    v_mfma_f32_16x16x32_bf16 v[160:163], v[20:23], v[124:127], v[160:163]
    s_waitcnt vmcnt(13)
    v_lshlrev_b32 v210, 16, v196
    v_mfma_f32_16x16x32_bf16 a[88:91], v[44:47], v[128:131], a[88:91]
    buffer_load_dwordx4 v[104:107], v4, s[28:31], s64 offen offset:2048 sc1
    v_and_b32 v211, 0xffff0000, v196
    v_mfma_f32_16x16x32_bf16 a[92:95], v[48:51], v[128:131], a[92:95]
    v_lshlrev_b32 v212, 16, v197
    v_and_b32 v213, 0xffff0000, v197
    v_mfma_f32_16x16x32_bf16 a[96:99], v[24:27], v[128:131], a[96:99]
    v_lshlrev_b32 v214, 16, v198
    v_and_b32 v215, 0xffff0000, v198
    v_mfma_f32_16x16x32_bf16 a[100:103], v[28:31], v[128:131], a[100:103]
    v_lshlrev_b32 v216, 16, v199
    v_and_b32 v217, 0xffff0000, v199
    v_mfma_f32_16x16x32_bf16 a[104:107], v[52:55], v[128:131], a[104:107]
    s_waitcnt vmcnt(13)
    v_lshlrev_b32 v218, 16, v200
    v_mfma_f32_16x16x32_bf16 a[88:91], v[56:59], v[132:135], a[88:91]
    buffer_load_dwordx4 v[108:111], v4, s[28:31], s65 offen offset:2048 sc1
    v_and_b32 v219, 0xffff0000, v200
    v_mfma_f32_16x16x32_bf16 a[92:95], v[184:187], v[132:135], a[92:95]
    v_lshlrev_b32 v220, 16, v201
    v_and_b32 v221, 0xffff0000, v201
    v_mfma_f32_16x16x32_bf16 a[96:99], v[188:191], v[132:135], a[96:99]
    v_mfma_f32_16x16x32_bf16 a[100:103], v[32:35], v[132:135], a[100:103]
    v_mfma_f32_16x16x32_bf16 a[104:107], v[60:63], v[132:135], a[104:107]
    s_waitcnt vmcnt(13)
    v_mfma_f32_16x16x32_bf16 a[108:111], v[44:47], v[136:139], a[108:111]
    buffer_load_dwordx4 v[112:115], v4, s[28:31], s66 offen offset:1024 sc1
    v_mfma_f32_16x16x32_bf16 a[112:115], v[48:51], v[136:139], a[112:115]
    v_mfma_f32_16x16x32_bf16 a[116:119], v[24:27], v[136:139], a[116:119]
    ds_write_b128 v230, a[88:91] offset:0
    v_mfma_f32_16x16x32_bf16 a[120:123], v[28:31], v[136:139], a[120:123]
    v_mfma_f32_16x16x32_bf16 a[124:127], v[52:55], v[136:139], a[124:127]
    s_waitcnt vmcnt(13)
    v_mfma_f32_16x16x32_bf16 a[108:111], v[56:59], v[140:143], a[108:111]
    buffer_load_dwordx4 v[116:119], v4, s[28:31], s67 offen offset:1024 sc1
    ds_write_b128 v230, a[92:95] offset:1024
    v_mfma_f32_16x16x32_bf16 a[112:115], v[184:187], v[140:143], a[112:115]
    v_mfma_f32_16x16x32_bf16 a[116:119], v[188:191], v[140:143], a[116:119]
    v_mfma_f32_16x16x32_bf16 a[120:123], v[32:35], v[140:143], a[120:123]
    ds_write_b128 v230, a[96:99] offset:2048
    v_mfma_f32_16x16x32_bf16 a[124:127], v[60:63], v[140:143], a[124:127]
    s_waitcnt vmcnt(13)
    v_mfma_f32_16x16x32_bf16 v[144:147], v[44:47], v[64:67], v[144:147]
    buffer_load_dwordx4 v[120:123], v4, s[28:31], s64 offen offset:3072 sc1
    v_mfma_f32_16x16x32_bf16 v[148:151], v[48:51], v[64:67], v[148:151]
    ds_write_b128 v230, a[100:103] offset:3072
    v_mfma_f32_16x16x32_bf16 v[152:155], v[24:27], v[64:67], v[152:155]
    v_mfma_f32_16x16x32_bf16 v[156:159], v[28:31], v[64:67], v[156:159]
    v_mfma_f32_16x16x32_bf16 v[160:163], v[52:55], v[64:67], v[160:163]
    ds_write_b128 v230, a[104:107] offset:4096
    s_waitcnt vmcnt(13)
    v_mfma_f32_16x16x32_bf16 v[144:147], v[56:59], v[68:71], v[144:147]
    buffer_load_dwordx4 v[124:127], v4, s[28:31], s66 offen offset:2048 sc1
    v_mfma_f32_16x16x32_bf16 v[148:151], v[184:187], v[68:71], v[148:151]
    v_mfma_f32_16x16x32_bf16 v[152:155], v[188:191], v[68:71], v[152:155]
    ds_write_b128 v231, a[108:111] offset:0
    v_mfma_f32_16x16x32_bf16 v[156:159], v[32:35], v[68:71], v[156:159]
    v_mfma_f32_16x16x32_bf16 v[160:163], v[60:63], v[68:71], v[160:163]
    s_waitcnt vmcnt(13)
    v_mfma_f32_16x16x32_bf16 v[164:167], a[128:131], v[72:75], v[202:205]
    ds_write_b128 v231, a[112:115] offset:1024
    v_mfma_f32_16x16x32_bf16 v[168:171], a[132:135], v[72:75], v[206:209]
    v_mfma_f32_16x16x32_bf16 v[172:175], a[136:139], v[72:75], v[210:213]
    v_mfma_f32_16x16x32_bf16 v[176:179], a[140:143], v[72:75], v[214:217]
    ds_write_b128 v231, a[116:119] offset:2048
    v_mfma_f32_16x16x32_bf16 v[180:183], a[144:147], v[72:75], v[218:221]
    s_waitcnt vmcnt(12)
    v_mfma_f32_16x16x32_bf16 v[164:167], a[148:151], v[76:79], v[164:167]
    v_mfma_f32_16x16x32_bf16 v[168:171], a[152:155], v[76:79], v[168:171]
    ds_write_b128 v231, a[120:123] offset:3072
    v_mfma_f32_16x16x32_bf16 v[172:175], a[156:159], v[76:79], v[172:175]
    v_mfma_f32_16x16x32_bf16 v[176:179], a[160:163], v[76:79], v[176:179]
    v_mfma_f32_16x16x32_bf16 v[180:183], a[164:167], v[76:79], v[180:183]
    ds_write_b128 v231, a[124:127] offset:4096
    s_waitcnt vmcnt(11)
    v_mfma_f32_16x16x32_bf16 v[164:167], a[168:171], v[80:83], v[164:167]
    v_mfma_f32_16x16x32_bf16 v[168:171], a[172:175], v[80:83], v[168:171]
    v_mfma_f32_16x16x32_bf16 v[172:175], a[176:179], v[80:83], v[172:175]
    ds_write_b128 v232, v[144:147] offset:0
    v_mfma_f32_16x16x32_bf16 v[176:179], a[180:183], v[80:83], v[176:179]
    v_mfma_f32_16x16x32_bf16 v[180:183], a[184:187], v[80:83], v[180:183]
    s_waitcnt vmcnt(10)
    v_mfma_f32_16x16x32_bf16 v[164:167], a[188:191], v[84:87], v[164:167]
    ds_write_b128 v232, v[148:151] offset:1024
    v_mfma_f32_16x16x32_bf16 v[168:171], a[192:195], v[84:87], v[168:171]
    v_mfma_f32_16x16x32_bf16 v[172:175], a[196:199], v[84:87], v[172:175]
    v_mfma_f32_16x16x32_bf16 v[176:179], a[200:203], v[84:87], v[176:179]
    ds_write_b128 v232, v[152:155] offset:2048
    v_mfma_f32_16x16x32_bf16 v[180:183], a[204:207], v[84:87], v[180:183]
    s_waitcnt vmcnt(9)
    v_mfma_f32_16x16x32_bf16 v[164:167], a[208:211], v[88:91], v[164:167]
    v_mfma_f32_16x16x32_bf16 v[168:171], a[212:215], v[88:91], v[168:171]
    ds_write_b128 v232, v[156:159] offset:3072
    v_mfma_f32_16x16x32_bf16 v[172:175], a[216:219], v[88:91], v[172:175]
    v_mfma_f32_16x16x32_bf16 v[176:179], a[220:223], v[88:91], v[176:179]
    v_mfma_f32_16x16x32_bf16 v[180:183], a[224:227], v[88:91], v[180:183]
    ds_write_b128 v232, v[160:163] offset:4096
    s_waitcnt vmcnt(8)
    v_mfma_f32_16x16x32_bf16 v[164:167], a[228:231], v[92:95], v[164:167]
    v_mfma_f32_16x16x32_bf16 v[168:171], a[232:235], v[92:95], v[168:171]
    v_mfma_f32_16x16x32_bf16 v[172:175], a[236:239], v[92:95], v[172:175]
    v_mfma_f32_16x16x32_bf16 v[176:179], a[240:243], v[92:95], v[176:179]
    v_mfma_f32_16x16x32_bf16 v[180:183], a[244:247], v[92:95], v[180:183]
    s_waitcnt vmcnt(7)
    s_waitcnt lgkmcnt(0)
    s_barrier
    v_mfma_f32_16x16x32_bf16 v[164:167], a[248:251], v[96:99], v[164:167]
    ds_read_b128 v[144:147], v229 offset:0
    ds_read_b128 v[64:67], v229 offset:5120
    v_mfma_f32_16x16x32_bf16 v[168:171], a[252:255], v[96:99], v[168:171]
    ds_read_b128 v[84:87], v229 offset:10240
    ds_read_b128 v[148:151], v229 offset:1024
    v_mfma_f32_16x16x32_bf16 v[172:175], a[0:3], v[96:99], v[172:175]
    ds_read_b128 v[68:71], v229 offset:6144
    ds_read_b128 v[88:91], v229 offset:11264
    v_mfma_f32_16x16x32_bf16 v[176:179], a[4:7], v[96:99], v[176:179]
    ds_read_b128 v[152:155], v229 offset:2048
    ds_read_b128 v[72:75], v229 offset:7168
    v_mfma_f32_16x16x32_bf16 v[180:183], a[8:11], v[96:99], v[180:183]
    s_waitcnt vmcnt(6)
    ds_read_b128 v[92:95], v229 offset:12288
    v_mfma_f32_16x16x32_bf16 v[164:167], a[12:15], v[100:103], v[164:167]
    ds_read_b128 v[156:159], v229 offset:3072
    ds_read_b128 v[76:79], v229 offset:8192
    v_mfma_f32_16x16x32_bf16 v[168:171], a[16:19], v[100:103], v[168:171]
    ds_read_b128 v[128:131], v229 offset:13312
    ds_read_b128 v[160:163], v229 offset:4096
    v_mfma_f32_16x16x32_bf16 v[172:175], a[20:23], v[100:103], v[172:175]
    ds_read_b128 v[80:83], v229 offset:9216
    ds_read_b128 v[132:135], v229 offset:14336
    v_mfma_f32_16x16x32_bf16 v[176:179], a[24:27], v[100:103], v[176:179]
    s_waitcnt lgkmcnt(12)
    v_add_f32 v64, v64, v84
    v_mfma_f32_16x16x32_bf16 v[180:183], a[28:31], v[100:103], v[180:183]
    s_waitcnt vmcnt(5)
    v_add_f32 v65, v65, v85
    v_mfma_f32_16x16x32_bf16 v[164:167], a[32:35], v[104:107], v[164:167]
    v_add_f32 v66, v66, v86
    v_add_f32 v67, v67, v87
    v_mfma_f32_16x16x32_bf16 v[168:171], a[36:39], v[104:107], v[168:171]
    v_add_f32 v144, v144, v64
    v_add_f32 v145, v145, v65
    v_mfma_f32_16x16x32_bf16 v[172:175], a[40:43], v[104:107], v[172:175]
    v_add_f32 v146, v146, v66
    v_add_f32 v147, v147, v67
    v_mfma_f32_16x16x32_bf16 v[176:179], a[44:47], v[104:107], v[176:179]
    s_waitcnt lgkmcnt(9)
    v_add_f32 v68, v68, v88
    v_mfma_f32_16x16x32_bf16 v[180:183], a[48:51], v[104:107], v[180:183]
    s_waitcnt vmcnt(4)
    v_add_f32 v69, v69, v89
    v_mfma_f32_16x16x32_bf16 v[164:167], a[52:55], v[108:111], v[164:167]
    v_add_f32 v70, v70, v90
    v_add_f32 v71, v71, v91
    v_mfma_f32_16x16x32_bf16 v[168:171], a[56:59], v[108:111], v[168:171]
    v_add_f32 v148, v148, v68
    v_add_f32 v149, v149, v69
    v_mfma_f32_16x16x32_bf16 v[172:175], a[60:63], v[108:111], v[172:175]
    v_add_f32 v150, v150, v70
    v_add_f32 v151, v151, v71
    v_mfma_f32_16x16x32_bf16 v[176:179], a[64:67], v[108:111], v[176:179]
    s_waitcnt lgkmcnt(6)
    v_add_f32 v72, v72, v92
    v_mfma_f32_16x16x32_bf16 v[180:183], a[68:71], v[108:111], v[180:183]
    s_waitcnt vmcnt(3)
    v_add_f32 v73, v73, v93
    v_mfma_f32_16x16x32_bf16 v[164:167], a[72:75], v[112:115], v[164:167]
    v_add_f32 v74, v74, v94
    v_add_f32 v75, v75, v95
    v_mfma_f32_16x16x32_bf16 v[168:171], a[76:79], v[112:115], v[168:171]
    v_add_f32 v152, v152, v72
    v_add_f32 v153, v153, v73
    v_mfma_f32_16x16x32_bf16 v[172:175], a[80:83], v[112:115], v[172:175]
    v_add_f32 v154, v154, v74
    v_add_f32 v155, v155, v75
    v_mfma_f32_16x16x32_bf16 v[176:179], a[84:87], v[112:115], v[176:179]
    s_waitcnt lgkmcnt(3)
    v_add_f32 v76, v76, v128
    v_mfma_f32_16x16x32_bf16 v[180:183], v[8:11], v[112:115], v[180:183]
    s_waitcnt vmcnt(2)
    v_add_f32 v77, v77, v129
    v_mfma_f32_16x16x32_bf16 v[164:167], v[12:15], v[116:119], v[164:167]
    v_add_f32 v78, v78, v130
    v_add_f32 v79, v79, v131
    v_mfma_f32_16x16x32_bf16 v[168:171], v[36:39], v[116:119], v[168:171]
    v_add_f32 v156, v156, v76
    v_add_f32 v157, v157, v77
    v_mfma_f32_16x16x32_bf16 v[172:175], v[40:43], v[116:119], v[172:175]
    v_add_f32 v158, v158, v78
    v_add_f32 v159, v159, v79
    v_mfma_f32_16x16x32_bf16 v[176:179], v[16:19], v[116:119], v[176:179]
    s_waitcnt lgkmcnt(0)
    v_add_f32 v80, v80, v132
    v_mfma_f32_16x16x32_bf16 v[180:183], v[20:23], v[116:119], v[180:183]
    s_waitcnt vmcnt(1)
    v_add_f32 v81, v81, v133
    v_mfma_f32_16x16x32_bf16 v[164:167], v[44:47], v[120:123], v[164:167]
    v_add_f32 v82, v82, v134
    v_add_f32 v83, v83, v135
    v_mfma_f32_16x16x32_bf16 v[168:171], v[48:51], v[120:123], v[168:171]
    v_add_f32 v160, v160, v80
    v_add_f32 v161, v161, v81
    v_mfma_f32_16x16x32_bf16 v[172:175], v[24:27], v[120:123], v[172:175]
    v_add_f32 v162, v162, v82
    v_add_f32 v163, v163, v83
    v_mfma_f32_16x16x32_bf16 v[176:179], v[28:31], v[120:123], v[176:179]
    v_mfma_f32_16x16x32_bf16 v[180:183], v[52:55], v[120:123], v[180:183]
    s_waitcnt vmcnt(0)
    v_mfma_f32_16x16x32_bf16 v[164:167], v[56:59], v[124:127], v[164:167]
    v_mfma_f32_16x16x32_bf16 v[168:171], v[184:187], v[124:127], v[168:171]
    v_mfma_f32_16x16x32_bf16 v[172:175], v[188:191], v[124:127], v[172:175]
    v_mfma_f32_16x16x32_bf16 v[176:179], v[32:35], v[124:127], v[176:179]
    v_mfma_f32_16x16x32_bf16 v[180:183], v[60:63], v[124:127], v[180:183]
    s_nop 3
    v_pk_add_f32 v[144:145], v[144:145], v[164:165]
    v_pk_add_f32 v[146:147], v[146:147], v[166:167]
    v_pk_add_f32 v[148:149], v[148:149], v[168:169]
    v_pk_add_f32 v[150:151], v[150:151], v[170:171]
    v_pk_add_f32 v[152:153], v[152:153], v[172:173]
    v_cvt_pk_bf16_f32 v192, v144, v145
    v_pk_add_f32 v[154:155], v[154:155], v[174:175]
    v_cvt_pk_bf16_f32 v193, v146, v147
    ds_write_b64 v225, v[192:193] offset:0
    v_pk_add_f32 v[156:157], v[156:157], v[176:177]
    v_cvt_pk_bf16_f32 v194, v148, v149
    v_pk_add_f32 v[158:159], v[158:159], v[178:179]
    v_cvt_pk_bf16_f32 v195, v150, v151
    ds_write_b64 v225, v[194:195] offset:8
    v_pk_add_f32 v[160:161], v[160:161], v[180:181]
    v_cvt_pk_bf16_f32 v196, v152, v153
    v_pk_add_f32 v[162:163], v[162:163], v[182:183]
    v_cvt_pk_bf16_f32 v197, v154, v155
    ds_write_b64 v225, v[196:197] offset:16
    v_cvt_pk_bf16_f32 v198, v156, v157
    v_cvt_pk_bf16_f32 v199, v158, v159
    ds_write_b64 v225, v[198:199] offset:24
    v_cvt_pk_bf16_f32 v200, v160, v161
    v_cvt_pk_bf16_f32 v201, v162, v163
    ds_write_b64 v225, v[200:201] offset:32
    ds_read_b128 v[64:67], v240
    ds_read_b128 v[68:71], v241
    ds_read_b128 v[72:75], v242
    s_waitcnt lgkmcnt(2)
    buffer_store_dwordx4 v[64:67], v236, s[24:27], s44 offen
    s_waitcnt lgkmcnt(1)
    buffer_store_dwordx4 v[68:71], v237, s[24:27], s44 offen
    s_waitcnt lgkmcnt(0)
    buffer_store_dwordx4 v[72:75], v238, s[24:27], s44 offen
L_end:
    s_endpgm
Lfix_19:
    s_add_i32 s49, s49, -1
    s_cmp_lt_i32 s49, 0
    s_cbranch_scc1 Lok_20
    buffer_load_dwordx4 v[80:83], v227, s[28:31], s68 offen offset:1024 sc1
    buffer_load_dwordx4 v[84:87], v228, s[28:31], s68 offen offset:1024 sc1
    buffer_load_dwordx4 v[88:91], v227, s[28:31], s68 offen offset:1536 sc1
    buffer_load_dwordx4 v[92:95], v228, s[28:31], s68 offen offset:1536 sc1
    buffer_load_dwordx4 v[96:99], v227, s[28:31], s68 offen offset:2048 sc1
    buffer_load_dwordx4 v[100:103], v228, s[28:31], s68 offen offset:2048 sc1
    buffer_load_dwordx4 v[104:107], v227, s[28:31], s68 offen offset:2560 sc1
    buffer_load_dwordx4 v[108:111], v228, s[28:31], s68 offen offset:2560 sc1
    buffer_load_dwordx4 v[112:115], v227, s[28:31], s68 offen offset:3072 sc1
    buffer_load_dwordx4 v[116:119], v228, s[28:31], s68 offen offset:3072 sc1
    buffer_load_dwordx4 v[120:123], v227, s[28:31], s68 offen offset:3584 sc1
    buffer_load_dwordx4 v[124:127], v228, s[28:31], s68 offen offset:3584 sc1
    s_waitcnt vmcnt(0)
    v_max3_u32 v234, v83, v87, v91
    v_max_u32 v234, v234, v95
    v_cmp_eq_u32 vcc, -1, v234
    s_nop 0
    s_cbranch_vccnz Lfix_19
    s_branch Lok_20
Lfix_21:
    s_add_i32 s49, s49, -1
    s_cmp_lt_i32 s49, 0
    s_cbranch_scc1 Lok_22
    buffer_load_dwordx4 v[96:99], v227, s[28:31], s68 offen offset:2048 sc1
    buffer_load_dwordx4 v[100:103], v228, s[28:31], s68 offen offset:2048 sc1
    buffer_load_dwordx4 v[104:107], v227, s[28:31], s68 offen offset:2560 sc1
    buffer_load_dwordx4 v[108:111], v228, s[28:31], s68 offen offset:2560 sc1
    buffer_load_dwordx4 v[112:115], v227, s[28:31], s68 offen offset:3072 sc1
    buffer_load_dwordx4 v[116:119], v228, s[28:31], s68 offen offset:3072 sc1
    buffer_load_dwordx4 v[120:123], v227, s[28:31], s68 offen offset:3584 sc1
    buffer_load_dwordx4 v[124:127], v228, s[28:31], s68 offen offset:3584 sc1
    buffer_load_dwordx4 v[128:131], v227, s[28:31], s69 offen offset:0 sc1
    buffer_load_dwordx4 v[132:135], v228, s[28:31], s69 offen offset:0 sc1
    buffer_load_dwordx4 v[136:139], v227, s[28:31], s69 offen offset:512 sc1
    buffer_load_dwordx4 v[140:143], v228, s[28:31], s69 offen offset:512 sc1
    s_waitcnt vmcnt(0)
    v_max3_u32 v234, v99, v103, v107
    v_max_u32 v234, v234, v111
    v_cmp_eq_u32 vcc, -1, v234
    s_nop 0
    s_cbranch_vccnz Lfix_21
    s_branch Lok_22
Lfix_23:
    s_add_i32 s49, s49, -1
    s_cmp_lt_i32 s49, 0
    s_cbranch_scc1 Lok_24
    buffer_load_dwordx4 v[112:115], v227, s[28:31], s68 offen offset:3072 sc1
    buffer_load_dwordx4 v[116:119], v228, s[28:31], s68 offen offset:3072 sc1
    buffer_load_dwordx4 v[120:123], v227, s[28:31], s68 offen offset:3584 sc1
    buffer_load_dwordx4 v[124:127], v228, s[28:31], s68 offen offset:3584 sc1
    buffer_load_dwordx4 v[128:131], v227, s[28:31], s69 offen offset:0 sc1
    buffer_load_dwordx4 v[132:135], v228, s[28:31], s69 offen offset:0 sc1
    buffer_load_dwordx4 v[136:139], v227, s[28:31], s69 offen offset:512 sc1
    buffer_load_dwordx4 v[140:143], v228, s[28:31], s69 offen offset:512 sc1
    buffer_load_dwordx4 v[144:147], v227, s[28:31], s69 offen offset:1024 sc1
    buffer_load_dwordx4 v[148:151], v228, s[28:31], s69 offen offset:1024 sc1
    buffer_load_dwordx4 v[152:155], v227, s[28:31], s69 offen offset:1536 sc1
    buffer_load_dwordx4 v[156:159], v228, s[28:31], s69 offen offset:1536 sc1
    s_waitcnt vmcnt(0)
    v_max3_u32 v234, v115, v119, v123
    v_max_u32 v234, v234, v127
    v_cmp_eq_u32 vcc, -1, v234
    s_nop 0
    s_cbranch_vccnz Lfix_23
    s_branch Lok_24
Lfix_25:
    s_add_i32 s49, s49, -1
    s_cmp_lt_i32 s49, 0
    s_cbranch_scc1 Lok_26
    buffer_load_dwordx4 v[128:131], v227, s[28:31], s69 offen offset:0 sc1
    buffer_load_dwordx4 v[132:135], v228, s[28:31], s69 offen offset:0 sc1
    buffer_load_dwordx4 v[136:139], v227, s[28:31], s69 offen offset:512 sc1
    buffer_load_dwordx4 v[140:143], v228, s[28:31], s69 offen offset:512 sc1
    buffer_load_dwordx4 v[144:147], v227, s[28:31], s69 offen offset:1024 sc1
    buffer_load_dwordx4 v[148:151], v228, s[28:31], s69 offen offset:1024 sc1
    buffer_load_dwordx4 v[152:155], v227, s[28:31], s69 offen offset:1536 sc1
    buffer_load_dwordx4 v[156:159], v228, s[28:31], s69 offen offset:1536 sc1
    buffer_load_dwordx4 v[160:163], v227, s[28:31], s69 offen offset:2048 sc1
    buffer_load_dwordx4 v[164:167], v228, s[28:31], s69 offen offset:2048 sc1
    buffer_load_dwordx4 v[168:171], v227, s[28:31], s69 offen offset:2560 sc1
    buffer_load_dwordx4 v[172:175], v228, s[28:31], s69 offen offset:2560 sc1
    s_waitcnt vmcnt(0)
    v_max3_u32 v234, v131, v135, v139
    v_max_u32 v234, v234, v143
    v_cmp_eq_u32 vcc, -1, v234
    s_nop 0
    s_cbranch_vccnz Lfix_25
    s_branch Lok_26
Lfix_27:
    s_add_i32 s49, s49, -1
    s_cmp_lt_i32 s49, 0
    s_cbranch_scc1 Lok_28
    buffer_load_dwordx4 v[144:147], v227, s[28:31], s69 offen offset:1024 sc1
    buffer_load_dwordx4 v[148:151], v228, s[28:31], s69 offen offset:1024 sc1
    buffer_load_dwordx4 v[152:155], v227, s[28:31], s69 offen offset:1536 sc1
    buffer_load_dwordx4 v[156:159], v228, s[28:31], s69 offen offset:1536 sc1
    buffer_load_dwordx4 v[160:163], v227, s[28:31], s69 offen offset:2048 sc1
    buffer_load_dwordx4 v[164:167], v228, s[28:31], s69 offen offset:2048 sc1
    buffer_load_dwordx4 v[168:171], v227, s[28:31], s69 offen offset:2560 sc1
    buffer_load_dwordx4 v[172:175], v228, s[28:31], s69 offen offset:2560 sc1
    buffer_load_dwordx4 v[176:179], v227, s[28:31], s69 offen offset:3072 sc1
    buffer_load_dwordx4 v[180:183], v228, s[28:31], s69 offen offset:3072 sc1
    buffer_load_dwordx4 v[184:187], v227, s[28:31], s69 offen offset:3584 sc1
    buffer_load_dwordx4 v[188:191], v228, s[28:31], s69 offen offset:3584 sc1
    s_waitcnt vmcnt(0)
    v_max3_u32 v234, v147, v151, v155
    v_max_u32 v234, v234, v159
    v_cmp_eq_u32 vcc, -1, v234
    s_nop 0
    s_cbranch_vccnz Lfix_27
    s_branch Lok_28
Lfix_29:
    s_add_i32 s49, s49, -1
    s_cmp_lt_i32 s49, 0
    s_cbranch_scc1 Lok_30
    buffer_load_dwordx4 v[160:163], v227, s[28:31], s69 offen offset:2048 sc1
    buffer_load_dwordx4 v[164:167], v228, s[28:31], s69 offen offset:2048 sc1
    buffer_load_dwordx4 v[168:171], v227, s[28:31], s69 offen offset:2560 sc1
    buffer_load_dwordx4 v[172:175], v228, s[28:31], s69 offen offset:2560 sc1
    buffer_load_dwordx4 v[176:179], v227, s[28:31], s69 offen offset:3072 sc1
    buffer_load_dwordx4 v[180:183], v228, s[28:31], s69 offen offset:3072 sc1
    buffer_load_dwordx4 v[184:187], v227, s[28:31], s69 offen offset:3584 sc1
    buffer_load_dwordx4 v[188:191], v228, s[28:31], s69 offen offset:3584 sc1
    buffer_load_dwordx4 v[192:195], v227, s[28:31], s70 offen offset:0 sc1
    buffer_load_dwordx4 v[196:199], v228, s[28:31], s70 offen offset:0 sc1
    buffer_load_dwordx4 v[200:203], v227, s[28:31], s70 offen offset:512 sc1
    buffer_load_dwordx4 v[204:207], v228, s[28:31], s70 offen offset:512 sc1
    s_waitcnt vmcnt(0)
    v_max3_u32 v234, v163, v167, v171
    v_max_u32 v234, v234, v175
    v_cmp_eq_u32 vcc, -1, v234
    s_nop 0
    s_cbranch_vccnz Lfix_29
    s_branch Lok_30
Lfix_31:
    s_add_i32 s49, s49, -1
    s_cmp_lt_i32 s49, 0
    s_cbranch_scc1 Lok_32
    buffer_load_dwordx4 v[176:179], v227, s[28:31], s69 offen offset:3072 sc1
    buffer_load_dwordx4 v[180:183], v228, s[28:31], s69 offen offset:3072 sc1
    buffer_load_dwordx4 v[184:187], v227, s[28:31], s69 offen offset:3584 sc1
    buffer_load_dwordx4 v[188:191], v228, s[28:31], s69 offen offset:3584 sc1
    buffer_load_dwordx4 v[192:195], v227, s[28:31], s70 offen offset:0 sc1
    buffer_load_dwordx4 v[196:199], v228, s[28:31], s70 offen offset:0 sc1
    buffer_load_dwordx4 v[200:203], v227, s[28:31], s70 offen offset:512 sc1
    buffer_load_dwordx4 v[204:207], v228, s[28:31], s70 offen offset:512 sc1
    buffer_load_dwordx4 v[208:211], v227, s[28:31], s70 offen offset:1024 sc1
    buffer_load_dwordx4 v[212:215], v228, s[28:31], s70 offen offset:1024 sc1
    buffer_load_dwordx4 v[216:219], v227, s[28:31], s70 offen offset:1536 sc1
    buffer_load_dwordx4 v[220:223], v228, s[28:31], s70 offen offset:1536 sc1
    s_waitcnt vmcnt(0)
    v_max3_u32 v234, v179, v183, v187
    v_max_u32 v234, v234, v191
    v_cmp_eq_u32 vcc, -1, v234
    s_nop 0
    s_cbranch_vccnz Lfix_31
    s_branch Lok_32
Lfix_33:
    s_add_i32 s49, s49, -1
    s_cmp_lt_i32 s49, 0
    s_cbranch_scc1 Lok_34
    buffer_load_dwordx4 v[192:195], v227, s[28:31], s70 offen offset:0 sc1
    buffer_load_dwordx4 v[196:199], v228, s[28:31], s70 offen offset:0 sc1
    buffer_load_dwordx4 v[200:203], v227, s[28:31], s70 offen offset:512 sc1
    buffer_load_dwordx4 v[204:207], v228, s[28:31], s70 offen offset:512 sc1
    buffer_load_dwordx4 v[208:211], v227, s[28:31], s70 offen offset:1024 sc1
    buffer_load_dwordx4 v[212:215], v228, s[28:31], s70 offen offset:1024 sc1
    buffer_load_dwordx4 v[216:219], v227, s[28:31], s70 offen offset:1536 sc1
    buffer_load_dwordx4 v[220:223], v228, s[28:31], s70 offen offset:1536 sc1
    s_waitcnt vmcnt(0)
    v_max3_u32 v234, v195, v199, v203
    v_max_u32 v234, v234, v207
    v_cmp_eq_u32 vcc, -1, v234
    s_nop 0
    s_cbranch_vccnz Lfix_33
    s_branch Lok_34
Lfix_35:
    s_add_i32 s49, s49, -1
    s_cmp_lt_i32 s49, 0
    s_cbranch_scc1 Lok_36
    buffer_load_dwordx4 v[208:211], v227, s[28:31], s70 offen offset:1024 sc1
    buffer_load_dwordx4 v[212:215], v228, s[28:31], s70 offen offset:1024 sc1
    buffer_load_dwordx4 v[216:219], v227, s[28:31], s70 offen offset:1536 sc1
    buffer_load_dwordx4 v[220:223], v228, s[28:31], s70 offen offset:1536 sc1
    s_waitcnt vmcnt(0)
    v_max3_u32 v234, v211, v215, v219
    v_max_u32 v234, v234, v223
    v_cmp_eq_u32 vcc, -1, v234
    s_nop 0
    s_cbranch_vccnz Lfix_35
    s_branch Lok_36
Lfix_17:
    s_add_i32 s49, s49, -1
    s_cmp_lt_i32 s49, 0
    s_cbranch_scc1 Lok_18
    buffer_load_dwordx2 v[230:231], v227, s[28:31], s70 offen offset:2048 sc1
    buffer_load_dwordx2 v[232:233], v228, s[28:31], s70 offen offset:2048 sc1
    s_waitcnt vmcnt(0)
    v_cmp_ne_u32 vcc, s62, v231
    v_cmp_ne_u32 s[58:59], s62, v233
    s_nop 0
    s_or_b64 vcc, vcc, s[58:59]
    s_cbranch_scc1 Lfix_17
    s_branch Lok_18
Lfix_37:
    s_add_i32 s49, s49, -1
    s_cmp_lt_i32 s49, 0
    s_cbranch_scc1 Lok_38
    buffer_load_dword v234, v0, s[28:31], s46 offen offset:0 sc1
    s_waitcnt vmcnt(0)
    v_cmp_ne_u32 vcc, s62, v234
    s_nop 0
    s_cbranch_vccnz Lfix_37
    s_branch Lok_38
Lfix_39:
    s_add_i32 s49, s49, -1
    s_cmp_lt_i32 s49, 0
    s_cbranch_scc1 Lok_40
    buffer_load_dword v234, v0, s[28:31], s46 offen offset:128 sc1
    s_waitcnt vmcnt(0)
    v_cmp_ne_u32 vcc, s62, v234
    s_nop 0
    s_cbranch_vccnz Lfix_39
    s_branch Lok_40
Lfix_41:
    s_add_i32 s49, s49, -1
    s_cmp_lt_i32 s49, 0
    s_cbranch_scc1 Lok_42
    buffer_load_dword v234, v0, s[28:31], s46 offen offset:256 sc1
    s_waitcnt vmcnt(0)
    v_cmp_ne_u32 vcc, s62, v234
    s_nop 0
    s_cbranch_vccnz Lfix_41
    s_branch Lok_42
Lfix_43:
    s_add_i32 s49, s49, -1
    s_cmp_lt_i32 s49, 0
    s_cbranch_scc1 Lok_44
    buffer_load_dword v234, v0, s[28:31], s46 offen offset:384 sc1
    s_waitcnt vmcnt(0)
    v_cmp_ne_u32 vcc, s62, v234
    s_nop 0
    s_cbranch_vccnz Lfix_43
    s_branch Lok_44
.p2align 8
.type L_tab,@object
L_tab:
.quad 0x3f803f803f803f80,0x3f803f803f803f80,0x3f7d3f7f3f803f80,0x3f713f753f783f7b,0x3f753f7b3f7f3f80,0x3f463f553f623f6d,0x3f673f753f7d3f80,0x3f043f223f3e3f55
.quad 0x3f553f6d3f7b3f80,0x3e483ec43f0e3f35,0x3f3e3f623f783f80,0xbe163dc93eac3f0e,0x3f223f553f753f80,0xbef1be483dc93ec4,0x3f043f463f713f80,0xbf3ebef1be163e48
.quad 0x3ec43f353f6d3f80,0xbf6dbf35bec40000,0x3e793f223f673f80,0xbf80bf62bf18be48,0x3dc93f0e3f623f80,0xbf75bf7bbf46bec4,0xbd493ef13f5c3f80,0xbf4ebf7fbf67bf0e
.quad 0xbe483ec43f553f80,0xbf0ebf6dbf7bbf35,0xbeac3e953f4e3f80,0xbe79bf46bf80bf55,0xbef13e483f463f80,0x3dc9bf0ebf75bf6d,0xbf183dc93f3e3f80,0x3edbbe95bf5cbf7b
.quad 0x3f803f803f803f80,0x3f803f803f803f80,0x3f5c3f623f673f6d,0x3f3e3f463f4e3f55,0x3ef13f0e3f223f35,0x3dc93e483e953ec4,0xbd493dc93e793ec4,0xbf18bef1beacbe48
.quad 0xbf0ebec4be480000,0xbf7bbf6dbf55bf35,0xbf67bf46bf18bec4,0xbf5cbf75bf80bf7b,0xbf7fbf7bbf62bf35,0xbe95bf0ebf46bf6d,0xbf4ebf75bf80bf6d,0x3edb3dc9be79bf0e
.quad 0xbec4bf35bf6dbf80,0x3f6d3f353ec40000,0x3e16be95bf2cbf6d,0x3f713f7f3f5c3f0e,0x3f223e48be95bf35,0x3ef13f553f7f3f6d,0x3f713f223e16bec4,0xbe793e953f3e3f7b
.quad 0x3f7b3f6d3f0e0000,0xbf55bec43e483f35,0x3f3e3f7f3f5c3ec4,0xbf7dbf62bedb3e48,0x3e953f553f7f3f35,0xbf22bf7bbf62bec4,0xbe793ef13f713f6d,0x3d49bf22bf7dbf55
.quad 0x3f803f803f803f80,0x3f803f803f803f80,0x3f183f223f2c3f35,0x3edb3ef13f043f0e,0xbe95be48bdc90000,0xbf22bf0ebef1bec4,0xbf71bf62bf4ebf35,0xbf78bf7fbf80bf7b
.quad 0xbf55bf6dbf7bbf80,0xbe48bec4bf0ebf35,0xbd49be95bf04bf35,0x3f4e3f223edb3e48,0x3f463f0e3e950000,0x3f623f7b3f7f3f6d,0x3f783f7f3f673f35,0xbd493e953f183f55
.quad 0x3ec43f353f6d3f80,0xbf6dbf35bec40000,0xbf04bdc93eac3f35,0xbf3ebf75bf7dbf55,0xbf7fbf55bef10000,0x3e95be48bf22bf6d,0xbf2cbf75bf78bf35,0x3f7d3f463eacbe48
.quad 0x3e48bec4bf55bf80,0x3f0e3f6d3f7b3f35,0x3f673ef1be16bf35,0xbf043dc93f2c3f7b,0x3f623f7b3f220000,0xbf7fbf55be953ec4,0x3e163f463f803f35,0xbeacbf62bf78bf0e
.quad 0x3f803f803f803f80,0x3f803f803f803f80,0x3e793e953eac3ec4,0x3d493dc93e163e48,0xbf62bf55bf46bf35,0xbf7fbf7bbf75bf6d,0xbf2cbf46bf5cbf6d,0xbe16be95bedbbf0e
.quad 0x3f0e3ec43e480000,0x3f7b3f6d3f553f35,0x3f713f7f3f7d3f6d,0x3e793ef13f2c3f55,0xbdc93e483ef13f35,0xbf75bf55bf22bec4,0xbf7dbf62bf2cbec4,0xbeacbf22bf5cbf7b
.quad 0xbec4bf35bf6dbf80,0x3f6d3f353ec40000,0x3f4e3ef13d49bec4,0x3edb3f463f783f7b,0x3f463f7b3f753f35,0xbf62bf0ebdc93ec4,0xbedb3dc93f183f6d,0xbf04bf62bf80bf55
.quad 0xbf7bbf6dbf0e0000,0x3f553ec4be48bf35,0xbd49bf22bf78bf6d,0x3f183f753f713f0e,0x3f753f0ebdc9bf35,0xbf46be483ef13f6d,0x3f043f753f673ec4,0xbf2cbf7fbf4ebe48
.quad 0x3f803f803f803f80,0x3f803f803f803f80,0xbe16bdc9bd490000,0xbeacbe95be79be48,0xbf75bf7bbf7fbf80,0xbf46bf55bf62bf6d,0x3edb3e953e160000,0x3f5c3f463f2c3f0e
.quad 0x3f553f6d3f7b3f80,0x3e483ec43f0e3f35,0xbf2cbef1be790000,0xbf7dbf7fbf71bf55,0xbf22bf55bf75bf80,0x3ef13e48bdc9bec4,0x3f5c3f223eac0000,0x3f2c3f623f7d3f7b
.quad 0x3ec43f353f6d3f80,0xbf6dbf35bec40000,0xbf78bf46bedb0000,0xbd49bef1bf4ebf7b,0xbdc9bf0ebf62bf80,0x3f753f7b3f463ec4,0x3f803f623f040000,0xbf18bdc93edb3f55
.quad 0xbe483ec43f553f80,0xbf0ebf6dbf7bbf35,0xbf71bf75bf180000,0x3f783f223d49bf0e,0x3ef1be48bf46bf80,0xbdc93f0e3f753f6d,0x3f4e3f7f3f2c0000,0xbf67bf75bf043e48
.quad 0x3f803f803f803f80,0x3f803f803f803f80,0xbf04bef1bedbbec4,0xbf2cbf22bf18bf0e,0xbef1bf0ebf22bf35,0xbdc9be48be95bec4,0x3f803f7f3f783f6d,0x3f4e3f623f713f7b
.quad 0xbf0ebec4be480000,0xbf7bbf6dbf55bf35,0xbedbbf22bf4ebf6d,0x3f043e953d49be48,0x3f7f3f7b3f623f35,0x3e953f0e3f463f6d,0xbf18be953d493ec4,0xbf67bf7fbf78bf55
.quad 0xbec4bf35bf6dbf80,0x3f6d3f353ec40000,0x3f7d3f753f3e3ec4,0xbeac3dc93f043f55,0xbf22be483e953f35,0xbef1bf55bf7fbf6d,0xbeacbf46bf7dbf6d,0x3f783f753f2c3e48
.quad 0x3f7b3f6d3f0e0000,0xbf55bec43e483f35,0xbf2cbdc93f043f6d,0x3e16bef1bf67bf7b,0xbe95bf55bf7fbf35,0x3f223f7b3f623ec4,0x3f783f623eacbec4,0xbf80bf46be163f0e
.quad 0x3f803f803f803f80,0x3f803f803f803f80,0xbf4ebf46bf3ebf35,0xbf67bf62bf5cbf55,0x3e953e483dc90000,0x3f223f0e3ef13ec4,0x3eac3ef13f183f35,0xbe79bdc93d493e48
.quad 0xbf55bf6dbf7bbf80,0xbe48bec4bf0ebf35,0x3f803f753f5c3f35,0x3f183f463f673f7b,0xbf46bf0ebe950000,0xbf62bf7bbf7fbf6d,0x3e79bdc9bedbbf35,0x3f803f753f4e3f0e
.quad 0x3ec43f353f6d3f80,0xbf6dbf35bec40000,0xbf5cbf7fbf71bf35,0x3f2c3e95be16bf0e,0x3f7f3f553ef10000,0xbe953e483f223f6d,0xbf3ebe953e793f35,0xbe16bf22bf71bf7b
.quad 0x3e48bec4bf55bf80,0x3f0e3f6d3f7b3f35,0x3edb3f623f7d3f35,0xbf5cbf7fbf3ebe48,0xbf62bf7bbf220000,0x3f7f3f553e95bec4,0x3f7d3f22bd49bf35,0xbf71bef13e793f55
.quad 0x3f803f803f803f80,0x3f803f803f803f80,0xbf78bf75bf71bf6d,0xbf80bf7fbf7dbf7b,0x3f623f553f463f35,0x3f7f3f7b3f753f6d,0xbf3ebf22bf04bec4,0xbf7dbf75bf67bf55
.quad 0x3f0e3ec43e480000,0x3f7b3f6d3f553f35,0xbeacbdc93e163ec4,0xbf78bf62bf3ebf0e,0x3dc9be48bef1bf35,0x3f753f553f223ec4,0x3e163ef13f3e3f6d,0xbf71bf46bf04be48
.quad 0xbec4bf35bf6dbf80,0x3f6d3f353ec40000,0x3f183f623f803f6d,0xbf67bf22be793e48,0xbf46bf7bbf75bf35,0x3f623f0e3dc9bec4,0x3f673f7f3f4e3ec4,0xbf5cbef13d493f0e
.quad 0xbf7bbf6dbf0e0000,0x3f553ec4be48bf35,0x3f803f463e79bec4,0xbf4ebe953eac3f55,0xbf75bf0e3dc93f35,0x3f463e48bef1bf6d,0x3f5c3e95bedbbf6d,0xbf3ebdc93f183f7b
.quad 0x3f803f803f803f80,0x3f803f803f803f80,0xbf7dbf7fbf80bf80,0xbf71bf75bf78bf7b,0x3f753f7b3f7f3f80,0x3f463f553f623f6d,0xbf67bf75bf7dbf80,0xbf04bf22bf3ebf55
.quad 0x3f553f6d3f7b3f80,0x3e483ec43f0e3f35,0xbf3ebf62bf78bf80,0x3e16bdc9beacbf0e,0x3f223f553f753f80,0xbef1be483dc93ec4,0xbf04bf46bf71bf80,0x3f3e3ef13e16be48
.quad 0x3ec43f353f6d3f80,0xbf6dbf35bec40000,0xbe79bf22bf67bf80,0x3f803f623f183e48,0x3dc93f0e3f623f80,0xbf75bf7bbf46bec4,0x3d49bef1bf5cbf80,0x3f4e3f7f3f673f0e
.quad 0xbe483ec43f553f80,0xbf0ebf6dbf7bbf35,0x3eacbe95bf4ebf80,0x3e793f463f803f55,0xbef13e483f463f80,0x3dc9bf0ebf75bf6d,0x3f18bdc9bf3ebf80,0xbedb3e953f5c3f7b
.quad 0x3f803f803f803f80,0x3f803f803f803f80,0xbf5cbf62bf67bf6d,0xbf3ebf46bf4ebf55,0x3ef13f0e3f223f35,0x3dc93e483e953ec4,0x3d49bdc9be79bec4,0x3f183ef13eac3e48
.quad 0xbf0ebec4be480000,0xbf7bbf6dbf55bf35,0x3f673f463f183ec4,0x3f5c3f753f803f7b,0xbf7fbf7bbf62bf35,0xbe95bf0ebf46bf6d,0x3f4e3f753f803f6d,0xbedbbdc93e793f0e
.quad 0xbec4bf35bf6dbf80,0x3f6d3f353ec40000,0xbe163e953f2c3f6d,0xbf71bf7fbf5cbf0e,0x3f223e48be95bf35,0x3ef13f553f7f3f6d,0xbf71bf22be163ec4,0x3e79be95bf3ebf7b
.quad 0x3f7b3f6d3f0e0000,0xbf55bec43e483f35,0xbf3ebf7fbf5cbec4,0x3f7d3f623edbbe48,0x3e953f553f7f3f35,0xbf22bf7bbf62bec4,0x3e79bef1bf71bf6d,0xbd493f223f7d3f55
.quad 0x3f803f803f803f80,0x3f803f803f803f80,0xbf18bf22bf2cbf35,0xbedbbef1bf04bf0e,0xbe95be48bdc90000,0xbf22bf0ebef1bec4,0x3f713f623f4e3f35,0x3f783f7f3f803f7b
.quad 0xbf55bf6dbf7bbf80,0xbe48bec4bf0ebf35,0x3d493e953f043f35,0xbf4ebf22bedbbe48,0x3f463f0e3e950000,0x3f623f7b3f7f3f6d,0xbf78bf7fbf67bf35,0x3d49be95bf18bf55
.quad 0x3ec43f353f6d3f80,0xbf6dbf35bec40000,0x3f043dc9beacbf35,0x3f3e3f753f7d3f55,0xbf7fbf55bef10000,0x3e95be48bf22bf6d,0x3f2c3f753f783f35,0xbf7dbf46beac3e48
.quad 0x3e48bec4bf55bf80,0x3f0e3f6d3f7b3f35,0xbf67bef13e163f35,0x3f04bdc9bf2cbf7b,0x3f623f7b3f220000,0xbf7fbf55be953ec4,0xbe16bf46bf80bf35,0x3eac3f623f783f0e
.quad 0x3f803f803f803f80,0x3f803f803f803f80,0xbe79be95beacbec4,0xbd49bdc9be16be48,0xbf62bf55bf46bf35,0xbf7fbf7bbf75bf6d,0x3f2c3f463f5c3f6d,0x3e163e953edb3f0e
.quad 0x3f0e3ec43e480000,0x3f7b3f6d3f553f35,0xbf71bf7fbf7dbf6d,0xbe79bef1bf2cbf55,0xbdc93e483ef13f35,0xbf75bf55bf22bec4,0x3f7d3f623f2c3ec4,0x3eac3f223f5c3f7b
.quad 0xbec4bf35bf6dbf80,0x3f6d3f353ec40000,0xbf4ebef1bd493ec4,0xbedbbf46bf78bf7b,0x3f463f7b3f753f35,0xbf62bf0ebdc93ec4,0x3edbbdc9bf18bf6d,0x3f043f623f803f55
.quad 0xbf7bbf6dbf0e0000,0x3f553ec4be48bf35,0x3d493f223f783f6d,0xbf18bf75bf71bf0e,0x3f753f0ebdc9bf35,0xbf46be483ef13f6d,0xbf04bf75bf67bec4,0x3f2c3f7f3f4e3e48
.quad 0x3f803f803f803f80,0x3f803f803f803f80,0x3e163dc93d490000,0x3eac3e953e793e48,0xbf75bf7bbf7fbf80,0xbf46bf55bf62bf6d,0xbedbbe95be160000,0xbf5cbf46bf2cbf0e
.quad 0x3f553f6d3f7b3f80,0x3e483ec43f0e3f35,0x3f2c3ef13e790000,0x3f7d3f7f3f713f55,0xbf22bf55bf75bf80,0x3ef13e48bdc9bec4,0xbf5cbf22beac0000,0xbf2cbf62bf7dbf7b
.quad 0x3ec43f353f6d3f80,0xbf6dbf35bec40000,0x3f783f463edb0000,0x3d493ef13f4e3f7b,0xbdc9bf0ebf62bf80,0x3f753f7b3f463ec4,0xbf80bf62bf040000,0x3f183dc9bedbbf55
.quad 0xbe483ec43f553f80,0xbf0ebf6dbf7bbf35,0x3f713f753f180000,0xbf78bf22bd493f0e,0x3ef1be48bf46bf80,0xbdc93f0e3f753f6d,0xbf4ebf7fbf2c0000,0x3f673f753f04be48
.quad 0x3f803f803f803f80,0x3f803f803f803f80,0x3f043ef13edb3ec4,0x3f2c3f223f183f0e,0xbef1bf0ebf22bf35,0xbdc9be48be95bec4,0xbf80bf7fbf78bf6d,0xbf4ebf62bf71bf7b
.quad 0xbf0ebec4be480000,0xbf7bbf6dbf55bf35,0x3edb3f223f4e3f6d,0xbf04be95bd493e48,0x3f7f3f7b3f623f35,0x3e953f0e3f463f6d,0x3f183e95bd49bec4,0x3f673f7f3f783f55
.quad 0xbec4bf35bf6dbf80,0x3f6d3f353ec40000,0xbf7dbf75bf3ebec4,0x3eacbdc9bf04bf55,0xbf22be483e953f35,0xbef1bf55bf7fbf6d,0x3eac3f463f7d3f6d,0xbf78bf75bf2cbe48
.quad 0x3f7b3f6d3f0e0000,0xbf55bec43e483f35,0x3f2c3dc9bf04bf6d,0xbe163ef13f673f7b,0xbe95bf55bf7fbf35,0x3f223f7b3f623ec4,0xbf78bf62beac3ec4,0x3f803f463e16bf0e
.quad 0x3f803f803f803f80,0x3f803f803f803f80,0x3f4e3f463f3e3f35,0x3f673f623f5c3f55,0x3e953e483dc90000,0x3f223f0e3ef13ec4,0xbeacbef1bf18bf35,0x3e793dc9bd49be48
.quad 0xbf55bf6dbf7bbf80,0xbe48bec4bf0ebf35,0xbf80bf75bf5cbf35,0xbf18bf46bf67bf7b,0xbf46bf0ebe950000,0xbf62bf7bbf7fbf6d,0xbe793dc93edb3f35,0xbf80bf75bf4ebf0e
.quad 0x3ec43f353f6d3f80,0xbf6dbf35bec40000,0x3f5c3f7f3f713f35,0xbf2cbe953e163f0e,0x3f7f3f553ef10000,0xbe953e483f223f6d,0x3f3e3e95be79bf35,0x3e163f223f713f7b
.quad 0x3e48bec4bf55bf80,0x3f0e3f6d3f7b3f35,0xbedbbf62bf7dbf35,0x3f5c3f7f3f3e3e48,0xbf62bf7bbf220000,0x3f7f3f553e95bec4,0xbf7dbf223d493f35,0x3f713ef1be79bf55
.quad 0x3f803f803f803f80,0x3f803f803f803f80,0x3f783f753f713f6d,0x3f803f7f3f7d3f7b,0x3f623f553f463f35,0x3f7f3f7b3f753f6d,0x3f3e3f223f043ec4,0x3f7d3f753f673f55
.quad 0x3f0e3ec43e480000,0x3f7b3f6d3f553f35,0x3eac3dc9be16bec4,0x3f783f623f3e3f0e,0x3dc9be48bef1bf35,0x3f753f553f223ec4,0xbe16bef1bf3ebf6d,0x3f713f463f043e48
.quad 0xbec4bf35bf6dbf80,0x3f6d3f353ec40000,0xbf18bf62bf80bf6d,0x3f673f223e79be48,0xbf46bf7bbf75bf35,0x3f623f0e3dc9bec4,0xbf67bf7fbf4ebec4,0x3f5c3ef1bd49bf0e
.quad 0xbf7bbf6dbf0e0000,0x3f553ec4be48bf35,0xbf80bf46be793ec4,0x3f4e3e95beacbf55,0xbf75bf0e3dc93f35,0x3f463e48bef1bf6d,0xbf5cbe953edb3f6d,0x3f3e3dc9bf18bf7b
.quad 0xbf803f80bf803f80,0xbf803f80bf803f80,0xbe16bdc9bd490000,0xbeacbe95be79be48,0xbe95be48bdc90000,0xbf22bf0ebef1bec4,0xbedbbe95be160000,0xbf5cbf46bf2cbf0e
.quad 0xbf0ebec4be480000,0xbf7bbf6dbf55bf35,0xbf2cbef1be790000,0xbf7dbf7fbf71bf55,0xbf46bf0ebe950000,0xbf62bf7bbf7fbf6d,0xbf5cbf22beac0000,0xbf2cbf62bf7dbf7b
.quad 0xbf6dbf35bec40000,0xbec4bf35bf6dbf80,0xbf78bf46bedb0000,0xbd49bef1bf4ebf7b,0xbf7fbf55bef10000,0x3e95be48bf22bf6d,0xbf80bf62bf040000,0x3f183dc9bedbbf55
.quad 0xbf7bbf6dbf0e0000,0x3f553ec4be48bf35,0xbf71bf75bf180000,0x3f783f223d49bf0e,0xbf62bf7bbf220000,0x3f7f3f553e95bec4,0xbf4ebf7fbf2c0000,0x3f673f753f04be48
.quad 0xbf803f80bf803f80,0xbf803f80bf803f80,0xbf04bef1bedbbec4,0xbf2cbf22bf18bf0e,0xbf62bf55bf46bf35,0xbf7fbf7bbf75bf6d,0xbf80bf7fbf78bf6d,0xbf4ebf62bf71bf7b
.quad 0xbf55bf6dbf7bbf80,0xbe48bec4bf0ebf35,0xbedbbf22bf4ebf6d,0x3f043e953d49be48,0x3dc9be48bef1bf35,0x3f753f553f223ec4,0x3f183e95bd49bec4,0x3f673f7f3f783f55
.quad 0x3f6d3f353ec40000,0x3ec43f353f6d3f80,0x3f7d3f753f3e3ec4,0xbeac3dc93f043f55,0x3f463f7b3f753f35,0xbf62bf0ebdc93ec4,0x3eac3f463f7d3f6d,0xbf78bf75bf2cbe48
.quad 0xbe483ec43f553f80,0xbf0ebf6dbf7bbf35,0xbf2cbdc93f043f6d,0x3e16bef1bf67bf7b,0xbf75bf0e3dc93f35,0x3f463e48bef1bf6d,0xbf78bf62beac3ec4,0x3f803f463e16bf0e
.quad 0xbf803f80bf803f80,0xbf803f80bf803f80,0xbf4ebf46bf3ebf35,0xbf67bf62bf5cbf55,0xbf75bf7bbf7fbf80,0xbf46bf55bf62bf6d,0xbeacbef1bf18bf35,0x3e793dc9bd49be48
.quad 0x3f0e3ec43e480000,0x3f7b3f6d3f553f35,0x3f803f753f5c3f35,0x3f183f463f673f7b,0x3f223f553f753f80,0xbef1be483dc93ec4,0xbe793dc93edb3f35,0xbf80bf75bf4ebf0e
.quad 0xbf6dbf35bec40000,0xbec4bf35bf6dbf80,0xbf5cbf7fbf71bf35,0x3f2c3e95be16bf0e,0xbdc9bf0ebf62bf80,0x3f753f7b3f463ec4,0x3f3e3e95be79bf35,0x3e163f223f713f7b
.quad 0x3f7b3f6d3f0e0000,0xbf55bec43e483f35,0x3edb3f623f7d3f35,0xbf5cbf7fbf3ebe48,0xbef13e483f463f80,0x3dc9bf0ebf75bf6d,0xbf7dbf223d493f35,0x3f713ef1be79bf55
.quad 0xbf803f80bf803f80,0xbf803f80bf803f80,0xbf78bf75bf71bf6d,0xbf80bf7fbf7dbf7b,0xbef1bf0ebf22bf35,0xbdc9be48be95bec4,0x3f3e3f223f043ec4,0x3f7d3f753f673f55
.quad 0x3f553f6d3f7b3f80,0x3e483ec43f0e3f35,0xbeacbdc93e163ec4,0xbf78bf62bf3ebf0e,0xbf7fbf7bbf62bf35,0xbe95bf0ebf46bf6d,0xbe16bef1bf3ebf6d,0x3f713f463f043e48
.quad 0x3f6d3f353ec40000,0x3ec43f353f6d3f80,0x3f183f623f803f6d,0xbf67bf22be793e48,0xbf22be483e953f35,0xbef1bf55bf7fbf6d,0xbf67bf7fbf4ebec4,0x3f5c3ef1bd49bf0e
.quad 0x3e48bec4bf55bf80,0x3f0e3f6d3f7b3f35,0x3f803f463e79bec4,0xbf4ebe953eac3f55,0x3e953f553f7f3f35,0xbf22bf7bbf62bec4,0xbf5cbe953edb3f6d,0x3f3e3dc9bf18bf7b
.quad 0xbf803f80bf803f80,0xbf803f80bf803f80,0xbf7dbf7fbf80bf80,0xbf71bf75bf78bf7b,0x3e953e483dc90000,0x3f223f0e3ef13ec4,0x3f673f753f7d3f80,0x3f043f223f3e3f55
.quad 0xbf0ebec4be480000,0xbf7bbf6dbf55bf35,0xbf3ebf62bf78bf80,0x3e16bdc9beacbf0e,0x3f463f0e3e950000,0x3f623f7b3f7f3f6d,0x3f043f463f713f80,0xbf3ebef1be163e48
.quad 0xbf6dbf35bec40000,0xbec4bf35bf6dbf80,0xbe79bf22bf67bf80,0x3f803f623f183e48,0x3f7f3f553ef10000,0xbe953e483f223f6d,0xbd493ef13f5c3f80,0xbf4ebf7fbf67bf0e
.quad 0xbf7bbf6dbf0e0000,0x3f553ec4be48bf35,0x3eacbe95bf4ebf80,0x3e793f463f803f55,0x3f623f7b3f220000,0xbf7fbf55be953ec4,0xbf183dc93f3e3f80,0x3edbbe95bf5cbf7b
.quad 0xbf803f80bf803f80,0xbf803f80bf803f80,0xbf5cbf62bf67bf6d,0xbf3ebf46bf4ebf55,0x3f623f553f463f35,0x3f7f3f7b3f753f6d,0xbd493dc93e793ec4,0xbf18bef1beacbe48
.quad 0xbf55bf6dbf7bbf80,0xbe48bec4bf0ebf35,0x3f673f463f183ec4,0x3f5c3f753f803f7b,0xbdc93e483ef13f35,0xbf75bf55bf22bec4,0xbf4ebf75bf80bf6d,0x3edb3dc9be79bf0e
.quad 0x3f6d3f353ec40000,0x3ec43f353f6d3f80,0xbe163e953f2c3f6d,0xbf71bf7fbf5cbf0e,0xbf46bf7bbf75bf35,0x3f623f0e3dc9bec4,0x3f713f223e16bec4,0xbe793e953f3e3f7b
.quad 0xbe483ec43f553f80,0xbf0ebf6dbf7bbf35,0xbf3ebf7fbf5cbec4,0x3f7d3f623edbbe48,0x3f753f0ebdc9bf35,0xbf46be483ef13f6d,0xbe793ef13f713f6d,0x3d49bf22bf7dbf55
.quad 0xbf803f80bf803f80,0xbf803f80bf803f80,0xbf18bf22bf2cbf35,0xbedbbef1bf04bf0e,0x3f753f7b3f7f3f80,0x3f463f553f623f6d,0xbf71bf62bf4ebf35,0xbf78bf7fbf80bf7b
.quad 0x3f0e3ec43e480000,0x3f7b3f6d3f553f35,0x3d493e953f043f35,0xbf4ebf22bedbbe48,0xbf22bf55bf75bf80,0x3ef13e48bdc9bec4,0x3f783f7f3f673f35,0xbd493e953f183f55
.quad 0xbf6dbf35bec40000,0xbec4bf35bf6dbf80,0x3f043dc9beacbf35,0x3f3e3f753f7d3f55,0x3dc93f0e3f623f80,0xbf75bf7bbf46bec4,0xbf2cbf75bf78bf35,0x3f7d3f463eacbe48
.quad 0x3f7b3f6d3f0e0000,0xbf55bec43e483f35,0xbf67bef13e163f35,0x3f04bdc9bf2cbf7b,0x3ef1be48bf46bf80,0xbdc93f0e3f753f6d,0x3e163f463f803f35,0xbeacbf62bf78bf0e
.quad 0xbf803f80bf803f80,0xbf803f80bf803f80,0xbe79be95beacbec4,0xbd49bdc9be16be48,0x3ef13f0e3f223f35,0x3dc93e483e953ec4,0xbf2cbf46bf5cbf6d,0xbe16be95bedbbf0e
.quad 0x3f553f6d3f7b3f80,0x3e483ec43f0e3f35,0xbf71bf7fbf7dbf6d,0xbe79bef1bf2cbf55,0x3f7f3f7b3f623f35,0x3e953f0e3f463f6d,0xbf7dbf62bf2cbec4,0xbeacbf22bf5cbf7b
.quad 0x3f6d3f353ec40000,0x3ec43f353f6d3f80,0xbf4ebef1bd493ec4,0xbedbbf46bf78bf7b,0x3f223e48be95bf35,0x3ef13f553f7f3f6d,0xbedb3dc93f183f6d,0xbf04bf62bf80bf55
.quad 0x3e48bec4bf55bf80,0x3f0e3f6d3f7b3f35,0x3d493f223f783f6d,0xbf18bf75bf71bf0e,0xbe95bf55bf7fbf35,0x3f223f7b3f623ec4,0x3f043f753f673ec4,0xbf2cbf7fbf4ebe48
.quad 0xbf803f80bf803f80,0xbf803f80bf803f80,0x3e163dc93d490000,0x3eac3e953e793e48,0xbe95be48bdc90000,0xbf22bf0ebef1bec4,0x3edb3e953e160000,0x3f5c3f463f2c3f0e
.quad 0xbf0ebec4be480000,0xbf7bbf6dbf55bf35,0x3f2c3ef13e790000,0x3f7d3f7f3f713f55,0xbf46bf0ebe950000,0xbf62bf7bbf7fbf6d,0x3f5c3f223eac0000,0x3f2c3f623f7d3f7b
.quad 0xbf6dbf35bec40000,0xbec4bf35bf6dbf80,0x3f783f463edb0000,0x3d493ef13f4e3f7b,0xbf7fbf55bef10000,0x3e95be48bf22bf6d,0x3f803f623f040000,0xbf18bdc93edb3f55
.quad 0xbf7bbf6dbf0e0000,0x3f553ec4be48bf35,0x3f713f753f180000,0xbf78bf22bd493f0e,0xbf62bf7bbf220000,0x3f7f3f553e95bec4,0x3f4e3f7f3f2c0000,0xbf67bf75bf043e48
.quad 0xbf803f80bf803f80,0xbf803f80bf803f80,0x3f043ef13edb3ec4,0x3f2c3f223f183f0e,0xbf62bf55bf46bf35,0xbf7fbf7bbf75bf6d,0x3f803f7f3f783f6d,0x3f4e3f623f713f7b
.quad 0xbf55bf6dbf7bbf80,0xbe48bec4bf0ebf35,0x3edb3f223f4e3f6d,0xbf04be95bd493e48,0x3dc9be48bef1bf35,0x3f753f553f223ec4,0xbf18be953d493ec4,0xbf67bf7fbf78bf55
.quad 0x3f6d3f353ec40000,0x3ec43f353f6d3f80,0xbf7dbf75bf3ebec4,0x3eacbdc9bf04bf55,0x3f463f7b3f753f35,0xbf62bf0ebdc93ec4,0xbeacbf46bf7dbf6d,0x3f783f753f2c3e48
.quad 0xbe483ec43f553f80,0xbf0ebf6dbf7bbf35,0x3f2c3dc9bf04bf6d,0xbe163ef13f673f7b,0xbf75bf0e3dc93f35,0x3f463e48bef1bf6d,0x3f783f623eacbec4,0xbf80bf46be163f0e
.quad 0xbf803f80bf803f80,0xbf803f80bf803f80,0x3f4e3f463f3e3f35,0x3f673f623f5c3f55,0xbf75bf7bbf7fbf80,0xbf46bf55bf62bf6d,0x3eac3ef13f183f35,0xbe79bdc93d493e48
.quad 0x3f0e3ec43e480000,0x3f7b3f6d3f553f35,0xbf80bf75bf5cbf35,0xbf18bf46bf67bf7b,0x3f223f553f753f80,0xbef1be483dc93ec4,0x3e79bdc9bedbbf35,0x3f803f753f4e3f0e
.quad 0xbf6dbf35bec40000,0xbec4bf35bf6dbf80,0x3f5c3f7f3f713f35,0xbf2cbe953e163f0e,0xbdc9bf0ebf62bf80,0x3f753f7b3f463ec4,0xbf3ebe953e793f35,0xbe16bf22bf71bf7b
.quad 0x3f7b3f6d3f0e0000,0xbf55bec43e483f35,0xbedbbf62bf7dbf35,0x3f5c3f7f3f3e3e48,0xbef13e483f463f80,0x3dc9bf0ebf75bf6d,0x3f7d3f22bd49bf35,0xbf71bef13e793f55
.quad 0xbf803f80bf803f80,0xbf803f80bf803f80,0x3f783f753f713f6d,0x3f803f7f3f7d3f7b,0xbef1bf0ebf22bf35,0xbdc9be48be95bec4,0xbf3ebf22bf04bec4,0xbf7dbf75bf67bf55
.quad 0x3f553f6d3f7b3f80,0x3e483ec43f0e3f35,0x3eac3dc9be16bec4,0x3f783f623f3e3f0e,0xbf7fbf7bbf62bf35,0xbe95bf0ebf46bf6d,0x3e163ef13f3e3f6d,0xbf71bf46bf04be48
.quad 0x3f6d3f353ec40000,0x3ec43f353f6d3f80,0xbf18bf62bf80bf6d,0x3f673f223e79be48,0xbf22be483e953f35,0xbef1bf55bf7fbf6d,0x3f673f7f3f4e3ec4,0xbf5cbef13d493f0e
.quad 0x3e48bec4bf55bf80,0x3f0e3f6d3f7b3f35,0xbf80bf46be793ec4,0x3f4e3e95beacbf55,0x3e953f553f7f3f35,0xbf22bf7bbf62bec4,0x3f5c3e95bedbbf6d,0xbf3ebdc93f183f7b
.quad 0xbf803f80bf803f80,0xbf803f80bf803f80,0x3f7d3f7f3f803f80,0x3f713f753f783f7b,0x3e953e483dc90000,0x3f223f0e3ef13ec4,0xbf67bf75bf7dbf80,0xbf04bf22bf3ebf55
.quad 0xbf0ebec4be480000,0xbf7bbf6dbf55bf35,0x3f3e3f623f783f80,0xbe163dc93eac3f0e,0x3f463f0e3e950000,0x3f623f7b3f7f3f6d,0xbf04bf46bf71bf80,0x3f3e3ef13e16be48
.quad 0xbf6dbf35bec40000,0xbec4bf35bf6dbf80,0x3e793f223f673f80,0xbf80bf62bf18be48,0x3f7f3f553ef10000,0xbe953e483f223f6d,0x3d49bef1bf5cbf80,0x3f4e3f7f3f673f0e
.quad 0xbf7bbf6dbf0e0000,0x3f553ec4be48bf35,0xbeac3e953f4e3f80,0xbe79bf46bf80bf55,0x3f623f7b3f220000,0xbf7fbf55be953ec4,0x3f18bdc9bf3ebf80,0xbedb3e953f5c3f7b
.quad 0xbf803f80bf803f80,0xbf803f80bf803f80,0x3f5c3f623f673f6d,0x3f3e3f463f4e3f55,0x3f623f553f463f35,0x3f7f3f7b3f753f6d,0x3d49bdc9be79bec4,0x3f183ef13eac3e48
.quad 0xbf55bf6dbf7bbf80,0xbe48bec4bf0ebf35,0xbf67bf46bf18bec4,0xbf5cbf75bf80bf7b,0xbdc93e483ef13f35,0xbf75bf55bf22bec4,0x3f4e3f753f803f6d,0xbedbbdc93e793f0e
.quad 0x3f6d3f353ec40000,0x3ec43f353f6d3f80,0x3e16be95bf2cbf6d,0x3f713f7f3f5c3f0e,0xbf46bf7bbf75bf35,0x3f623f0e3dc9bec4,0xbf71bf22be163ec4,0x3e79be95bf3ebf7b
.quad 0xbe483ec43f553f80,0xbf0ebf6dbf7bbf35,0x3f3e3f7f3f5c3ec4,0xbf7dbf62bedb3e48,0x3f753f0ebdc9bf35,0xbf46be483ef13f6d,0x3e79bef1bf71bf6d,0xbd493f223f7d3f55
.quad 0xbf803f80bf803f80,0xbf803f80bf803f80,0x3f183f223f2c3f35,0x3edb3ef13f043f0e,0x3f753f7b3f7f3f80,0x3f463f553f623f6d,0x3f713f623f4e3f35,0x3f783f7f3f803f7b
.quad 0x3f0e3ec43e480000,0x3f7b3f6d3f553f35,0xbd49be95bf04bf35,0x3f4e3f223edb3e48,0xbf22bf55bf75bf80,0x3ef13e48bdc9bec4,0xbf78bf7fbf67bf35,0x3d49be95bf18bf55
.quad 0xbf6dbf35bec40000,0xbec4bf35bf6dbf80,0xbf04bdc93eac3f35,0xbf3ebf75bf7dbf55,0x3dc93f0e3f623f80,0xbf75bf7bbf46bec4,0x3f2c3f753f783f35,0xbf7dbf46beac3e48
.quad 0x3f7b3f6d3f0e0000,0xbf55bec43e483f35,0x3f673ef1be16bf35,0xbf043dc93f2c3f7b,0x3ef1be48bf46bf80,0xbdc93f0e3f753f6d,0xbe16bf46bf80bf35,0x3eac3f623f783f0e
.quad 0xbf803f80bf803f80,0xbf803f80bf803f80,0x3e793e953eac3ec4,0x3d493dc93e163e48,0x3ef13f0e3f223f35,0x3dc93e483e953ec4,0x3f2c3f463f5c3f6d,0x3e163e953edb3f0e
.quad 0x3f553f6d3f7b3f80,0x3e483ec43f0e3f35,0x3f713f7f3f7d3f6d,0x3e793ef13f2c3f55,0x3f7f3f7b3f623f35,0x3e953f0e3f463f6d,0x3f7d3f623f2c3ec4,0x3eac3f223f5c3f7b
.quad 0x3f6d3f353ec40000,0x3ec43f353f6d3f80,0x3f4e3ef13d49bec4,0x3edb3f463f783f7b,0x3f223e48be95bf35,0x3ef13f553f7f3f6d,0x3edbbdc9bf18bf6d,0x3f043f623f803f55
.quad 0x3e48bec4bf55bf80,0x3f0e3f6d3f7b3f35,0xbd49bf22bf78bf6d,0x3f183f753f713f0e,0xbe95bf55bf7fbf35,0x3f223f7b3f623ec4,0xbf04bf75bf67bec4,0x3f2c3f7f3f4e3e48
.quad 0xbf3500003f353f80,0x3f350000bf35bf80,0xbf4ebdc93f2c3f80,0x3f673e95bf04bf7b,0xbf62be483f223f80,0x3f7f3f0ebe95bf6d,0xbf71be953f183f80,0x3f783f46bd49bf55
.quad 0xbf7bbec43f0e3f80,0x3f553f6d3e48bf35,0xbf80bef13f043f80,0x3f183f7f3edbbf0e,0xbf7fbf0e3ef13f80,0x3e953f7b3f22bec4,0xbf78bf223edb3f80,0xbd493f623f4ebe48
.quad 0xbf6dbf353ec43f80,0xbec43f353f6d0000,0xbf5cbf463eac3f80,0xbf2c3ef13f7d3e48,0xbf46bf553e953f80,0xbf623e483f7f3ec4,0xbf2cbf623e793f80,0xbf7dbdc93f713f0e
.quad 0xbf0ebf6d3e483f80,0xbf7bbec43f553f35,0xbedbbf753e163f80,0xbf5cbf223f2c3f55,0xbe95bf7b3dc93f80,0xbf22bf553ef13f6d,0xbe16bf7f3d493f80,0xbeacbf753e793f7b
.quad 0xbf3500003f353f80,0x3f350000bf35bf80,0xbf78bef13eac3f6d,0x3f803f22be16bf55,0xbf75bf55bdc93f35,0x3f463f7b3ef1bec4,0xbf2cbf7fbf043ec4,0x3e163f623f673e48
.quad 0xbe48bf6dbf550000,0xbf0e3ec43f7b3f35,0x3eacbf22bf7dbec4,0xbf78be953f2c3f7b,0x3f46be48bf75bf35,0xbf62bf553dc93f6d,0x3f7d3e95bf3ebf6d,0xbeacbf7fbf043f0e
.quad 0x3f6d3f35bec4bf80,0x3ec4bf35bf6d0000,0x3f183f753d49bf6d,0x3f67bdc9bf78bf0e,0x3dc93f7b3ef1bf35,0x3f753f0ebf22bf6d,0xbedb3f463f4ebec4,0x3f043f75bd49bf7b
.quad 0xbf553ec43f7b0000,0xbe483f6d3f0ebf35,0xbf80bdc93f783ec4,0xbf4e3ef13f71be48,0xbf62bf0e3f463f35,0xbf7fbe483f753ec4,0xbf04bf623edb3f6d,0xbf2cbf463f183f55
.quad 0xbf3500003f353f80,0x3f350000bf35bf80,0xbf7dbf46bd493f35,0x3f713f623e79bf0e,0xbef1bf7bbf460000,0x3dc93f553f753ec4,0x3edbbef1bf7dbf35,0xbf5cbdc93f3e3f7b
.quad 0x3f7b3ec4bf0ebf80,0xbf55bf6dbe483f35,0x3f3e3f753e79bf35,0x3e16bf46bf71be48,0xbdc93f553f620000,0x3f753e48bf46bf6d,0xbf5c3dc93f713f35,0x3f2c3f753e16bf55
.quad 0xbf6dbf353ec43f80,0xbec43f353f6d0000,0xbe79bf7fbedb3f35,0xbf80be953f4e3f55,0x3f22bf0ebf750000,0xbef1bf7bbdc93f6d,0x3f803e95bf5cbf35,0x3f18bf22bf673e48
.quad 0x3f0e3f6dbe48bf80,0x3f7b3ec4bf55bf35,0xbeac3f623f18bf35,0x3e793f7f3d49bf7b,0xbf753e483f7f0000,0xbf463f0e3f62bec4,0xbf4ebf223f3e3f35,0xbf67bef13f5c3f0e
.quad 0xbf3500003f353f80,0x3f350000bf35bf80,0xbf5cbf75bedb3ec4,0x3f3e3f7f3f18be48,0x3e95bf0ebf7fbf35,0xbf223e483f623f6d,0x3f803f22be79bf6d,0xbf4ebf75beac3f0e
.quad 0x3e483f6d3f550000,0x3f0ebec4bf7bbf35,0xbf67bdc93f4e3f6d,0x3f5c3f623d49bf55,0xbf22bf7bbe953f35,0xbef13f0e3f7f3ec4,0x3f18bef1bf80bec4,0xbf67bf463e793f7b
.quad 0x3f6d3f35bec4bf80,0x3ec4bf35bf6d0000,0xbe163f623f3ebec4,0x3f713f22bf04bf7b,0xbf7fbe483f623f35,0xbe953f553f46bec4,0xbeacbf7fbe163f6d,0xbf78bef13f3e3f55
.quad 0x3f55bec4bf7b0000,0x3e48bf6dbf0e3f35,0x3f3e3f46bf04bf6d,0x3f7d3e95bf67bf0e,0xbef13f553f22bf35,0xbdc93f7b3e95bf6d,0xbf78be953f713ec4,0xbf80bdc93f7d3e48
.quad 0xbf3500003f353f80,0x3f350000bf35bf80,0xbf18bf7fbf3e0000,0x3edb3f753f5c3e48,0x3f623e48bf22bf80,0xbf7fbf0e3e953f6d,0x3eac3f753f4e0000,0x3e79bf22bf80bf0e
.quad 0xbf7bbec43f0e3f80,0x3f553f6d3e48bf35,0xbd49bf62bf5c0000,0xbf4e3dc93f673f55,0x3f7f3f0ebef1bf80,0xbe95bf7bbf223ec4,0xbe793f463f670000,0x3f803ef1bf18bf7b
.quad 0xbf6dbf353ec43f80,0xbec43f353f6d0000,0x3f04bf22bf710000,0xbf3ebf623e163f7b,0x3f463f55be95bf80,0x3f62be48bf7fbec4,0xbf3e3ef13f780000,0x3e163f7f3eacbf55
.quad 0xbf0ebf6d3e483f80,0xbf7bbec43f553f35,0x3f67be95bf7d0000,0x3f04bf46bf3e3f0e,0x3e953f7bbdc9bf80,0x3f223f55bef1bf6d,0xbf7d3dc93f800000,0xbf713e953f78be48
.quad 0xbf3500003f353f80,0x3f350000bf35bf80,0xbe79bf62bf71bec4,0x3d493f463f7d3f0e,0x3f753f553dc9bf35,0xbf46bf7bbef13ec4,0xbf3e3dc93f5c3f6d,0x3f7d3ef1bedbbf7b
.quad 0xbe48bf6dbf550000,0xbf0e3ec43f7b3f35,0x3f713f46be16bf6d,0xbe79bf75bf3e3e48,0xbf463e483f753f35,0x3f623f55bdc9bf6d,0xbe16bf75bf2c3ec4,0xbf71bdc93f5c3f55
.quad 0x3f6d3f35bec4bf80,0x3ec4bf35bf6d0000,0xbf4e3e953f803ec4,0x3edb3f7f3e79bf55,0xbdc9bf7bbef13f35,0xbf75bf0e3f223f6d,0x3f673f22bf18bf6d,0x3f5cbe95bf80be48
.quad 0xbf553ec43f7b0000,0xbe483f6d3f0ebf35,0xbd49bf7fbe793f6d,0xbf18bf623eac3f7b,0x3f623f0ebf46bf35,0x3f7f3e48bf75bec4,0xbf5c3ef13f67bec4,0xbf3e3f223f4ebf0e
.quad 0xbf3500003f353f80,0x3f350000bf35bf80,0x3e16bf22bf80bf35,0xbeac3ef13f783f55,0x3ef13f7b3f460000,0xbdc9bf55bf75bec4,0xbf67bf62be163f35,0x3f043f7f3f2cbe48
.quad 0x3f7b3ec4bf0ebf80,0xbf55bf6dbe483f35,0xbf2c3e953f783f35,0x3f7d3f22beacbf7b,0x3dc9bf55bf620000,0xbf75be483f463f6d,0x3f043f7f3eacbf35,0x3f3ebe95bf7dbf0e
.quad 0xbf6dbf353ec43f80,0xbec43f353f6d0000,0x3f783dc9bf67bf35,0xbd49bf75bf183f0e,0xbf223f0e3f750000,0x3ef13f7b3dc9bf6d,0x3d49bf75bf043f35,0xbf4ebf463edb3f7b
.quad 0x3f0e3f6dbe48bf80,0x3f7b3ec4bf55bf35,0xbf71bef13f4e3f35,0xbf783dc93f803e48,0x3f75be48bf7f0000,0x3f46bf0ebf623ec4,0xbf183f463f2cbf35,0xbedb3f623f04bf55
.quad 0xbf3500003f353f80,0x3f350000bf35bf80,0x3f04be95bf67bf6d,0xbf2c3dc93f4e3f7b,0xbe953f0e3f7f3f35,0x3f22be48bf62bf6d,0x3d49bf46bf78bec4,0xbf183e953f713f55
.quad 0x3e483f6d3f550000,0x3f0ebec4bf7bbf35,0xbedbbf7fbf183ec4,0xbf043ef13f803f0e,0x3f223f7b3e95bf35,0x3ef1bf0ebf7fbec4,0xbf4ebf623d493f6d,0xbedb3f223f783e48
.quad 0x3f6d3f35bec4bf80,0x3ec4bf35bf6d0000,0xbf7dbef13f2c3f6d,0xbeac3f463f5cbe48,0x3f7f3e48bf62bf35,0x3e95bf55bf463ec4,0xbf713dc93f7d3ec4,0xbe793f623f2cbf0e
.quad 0x3f55bec4bf7b0000,0x3e48bf6dbf0e3f35,0xbf2c3f223f5cbec4,0xbe163f753edbbf55,0x3ef1bf55bf223f35,0x3dc9bf7bbe953f6d,0xbe793f753eacbf6d,0xbd493f7f3e16bf7b
.quad 0xbf3500003f353f80,0x3f350000bf35bf80,0x3f4e3dc9bf2cbf80,0xbf67be953f043f7b,0xbf62be483f223f80,0x3f7f3f0ebe95bf6d,0x3f713e95bf18bf80,0xbf78bf463d493f55
.quad 0xbf7bbec43f0e3f80,0x3f553f6d3e48bf35,0x3f803ef1bf04bf80,0xbf18bf7fbedb3f0e,0xbf7fbf0e3ef13f80,0x3e953f7b3f22bec4,0x3f783f22bedbbf80,0x3d49bf62bf4e3e48
.quad 0xbf6dbf353ec43f80,0xbec43f353f6d0000,0x3f5c3f46beacbf80,0x3f2cbef1bf7dbe48,0xbf46bf553e953f80,0xbf623e483f7f3ec4,0x3f2c3f62be79bf80,0x3f7d3dc9bf71bf0e
.quad 0xbf0ebf6d3e483f80,0xbf7bbec43f553f35,0x3edb3f75be16bf80,0x3f5c3f22bf2cbf55,0xbe95bf7b3dc93f80,0xbf22bf553ef13f6d,0x3e163f7fbd49bf80,0x3eac3f75be79bf7b
.quad 0xbf3500003f353f80,0x3f350000bf35bf80,0x3f783ef1beacbf6d,0xbf80bf223e163f55,0xbf75bf55bdc93f35,0x3f463f7b3ef1bec4,0x3f2c3f7f3f04bec4,0xbe16bf62bf67be48
.quad 0xbe48bf6dbf550000,0xbf0e3ec43f7b3f35,0xbeac3f223f7d3ec4,0x3f783e95bf2cbf7b,0x3f46be48bf75bf35,0xbf62bf553dc93f6d,0xbf7dbe953f3e3f6d,0x3eac3f7f3f04bf0e
.quad 0x3f6d3f35bec4bf80,0x3ec4bf35bf6d0000,0xbf18bf75bd493f6d,0xbf673dc93f783f0e,0x3dc93f7b3ef1bf35,0x3f753f0ebf22bf6d,0x3edbbf46bf4e3ec4,0xbf04bf753d493f7b
.quad 0xbf553ec43f7b0000,0xbe483f6d3f0ebf35,0x3f803dc9bf78bec4,0x3f4ebef1bf713e48,0xbf62bf0e3f463f35,0xbf7fbe483f753ec4,0x3f043f62bedbbf6d,0x3f2c3f46bf18bf55
.quad 0xbf3500003f353f80,0x3f350000bf35bf80,0x3f7d3f463d49bf35,0xbf71bf62be793f0e,0xbef1bf7bbf460000,0x3dc93f553f753ec4,0xbedb3ef13f7d3f35,0x3f5c3dc9bf3ebf7b
.quad 0x3f7b3ec4bf0ebf80,0xbf55bf6dbe483f35,0xbf3ebf75be793f35,0xbe163f463f713e48,0xbdc93f553f620000,0x3f753e48bf46bf6d,0x3f5cbdc9bf71bf35,0xbf2cbf75be163f55
.quad 0xbf6dbf353ec43f80,0xbec43f353f6d0000,0x3e793f7f3edbbf35,0x3f803e95bf4ebf55,0x3f22bf0ebf750000,0xbef1bf7bbdc93f6d,0xbf80be953f5c3f35,0xbf183f223f67be48
.quad 0x3f0e3f6dbe48bf80,0x3f7b3ec4bf55bf35,0x3eacbf62bf183f35,0xbe79bf7fbd493f7b,0xbf753e483f7f0000,0xbf463f0e3f62bec4,0x3f4e3f22bf3ebf35,0x3f673ef1bf5cbf0e
.quad 0xbf3500003f353f80,0x3f350000bf35bf80,0x3f5c3f753edbbec4,0xbf3ebf7fbf183e48,0x3e95bf0ebf7fbf35,0xbf223e483f623f6d,0xbf80bf223e793f6d,0x3f4e3f753eacbf0e
.quad 0x3e483f6d3f550000,0x3f0ebec4bf7bbf35,0x3f673dc9bf4ebf6d,0xbf5cbf62bd493f55,0xbf22bf7bbe953f35,0xbef13f0e3f7f3ec4,0xbf183ef13f803ec4,0x3f673f46be79bf7b
.quad 0x3f6d3f35bec4bf80,0x3ec4bf35bf6d0000,0x3e16bf62bf3e3ec4,0xbf71bf223f043f7b,0xbf7fbe483f623f35,0xbe953f553f46bec4,0x3eac3f7f3e16bf6d,0x3f783ef1bf3ebf55
.quad 0x3f55bec4bf7b0000,0x3e48bf6dbf0e3f35,0xbf3ebf463f043f6d,0xbf7dbe953f673f0e,0xbef13f553f22bf35,0xbdc93f7b3e95bf6d,0x3f783e95bf71bec4,0x3f803dc9bf7dbe48
.quad 0xbf3500003f353f80,0x3f350000bf35bf80,0x3f183f7f3f3e0000,0xbedbbf75bf5cbe48,0x3f623e48bf22bf80,0xbf7fbf0e3e953f6d,0xbeacbf75bf4e0000,0xbe793f223f803f0e
.quad 0xbf7bbec43f0e3f80,0x3f553f6d3e48bf35,0x3d493f623f5c0000,0x3f4ebdc9bf67bf55,0x3f7f3f0ebef1bf80,0xbe95bf7bbf223ec4,0x3e79bf46bf670000,0xbf80bef13f183f7b
.quad 0xbf6dbf353ec43f80,0xbec43f353f6d0000,0xbf043f223f710000,0x3f3e3f62be16bf7b,0x3f463f55be95bf80,0x3f62be48bf7fbec4,0x3f3ebef1bf780000,0xbe16bf7fbeac3f55
.quad 0xbf0ebf6d3e483f80,0xbf7bbec43f553f35,0xbf673e953f7d0000,0xbf043f463f3ebf0e,0x3e953f7bbdc9bf80,0x3f223f55bef1bf6d,0x3f7dbdc9bf800000,0x3f71be95bf783e48
.quad 0xbf3500003f353f80,0x3f350000bf35bf80,0x3e793f623f713ec4,0xbd49bf46bf7dbf0e,0x3f753f553dc9bf35,0xbf46bf7bbef13ec4,0x3f3ebdc9bf5cbf6d,0xbf7dbef13edb3f7b
.quad 0xbe48bf6dbf550000,0xbf0e3ec43f7b3f35,0xbf71bf463e163f6d,0x3e793f753f3ebe48,0xbf463e483f753f35,0x3f623f55bdc9bf6d,0x3e163f753f2cbec4,0x3f713dc9bf5cbf55
.quad 0x3f6d3f35bec4bf80,0x3ec4bf35bf6d0000,0x3f4ebe95bf80bec4,0xbedbbf7fbe793f55,0xbdc9bf7bbef13f35,0xbf75bf0e3f223f6d,0xbf67bf223f183f6d,0xbf5c3e953f803e48
.quad 0xbf553ec43f7b0000,0xbe483f6d3f0ebf35,0x3d493f7f3e79bf6d,0x3f183f62beacbf7b,0x3f623f0ebf46bf35,0x3f7f3e48bf75bec4,0x3f5cbef1bf673ec4,0x3f3ebf22bf4e3f0e
.quad 0xbf3500003f353f80,0x3f350000bf35bf80,0xbe163f223f803f35,0x3eacbef1bf78bf55,0x3ef13f7b3f460000,0xbdc9bf55bf75bec4,0x3f673f623e16bf35,0xbf04bf7fbf2c3e48
.quad 0x3f7b3ec4bf0ebf80,0xbf55bf6dbe483f35,0x3f2cbe95bf78bf35,0xbf7dbf223eac3f7b,0x3dc9bf55bf620000,0xbf75be483f463f6d,0xbf04bf7fbeac3f35,0xbf3e3e953f7d3f0e
.quad 0xbf6dbf353ec43f80,0xbec43f353f6d0000,0xbf78bdc93f673f35,0x3d493f753f18bf0e,0xbf223f0e3f750000,0x3ef13f7b3dc9bf6d,0xbd493f753f04bf35,0x3f4e3f46bedbbf7b
.quad 0x3f0e3f6dbe48bf80,0x3f7b3ec4bf55bf35,0x3f713ef1bf4ebf35,0x3f78bdc9bf80be48,0x3f75be48bf7f0000,0x3f46bf0ebf623ec4,0x3f18bf46bf2c3f35,0x3edbbf62bf043f55
.quad 0xbf3500003f353f80,0x3f350000bf35bf80,0xbf043e953f673f6d,0x3f2cbdc9bf4ebf7b,0xbe953f0e3f7f3f35,0x3f22be48bf62bf6d,0xbd493f463f783ec4,0x3f18be95bf71bf55
.quad 0x3e483f6d3f550000,0x3f0ebec4bf7bbf35,0x3edb3f7f3f18bec4,0x3f04bef1bf80bf0e,0x3f223f7b3e95bf35,0x3ef1bf0ebf7fbec4,0x3f4e3f62bd49bf6d,0x3edbbf22bf78be48
.quad 0x3f6d3f35bec4bf80,0x3ec4bf35bf6d0000,0x3f7d3ef1bf2cbf6d,0x3eacbf46bf5c3e48,0x3f7f3e48bf62bf35,0x3e95bf55bf463ec4,0x3f71bdc9bf7dbec4,0x3e79bf62bf2c3f0e
.quad 0x3f55bec4bf7b0000,0x3e48bf6dbf0e3f35,0x3f2cbf22bf5c3ec4,0x3e16bf75bedb3f55,0x3ef1bf55bf223f35,0x3dc9bf7bbe953f6d,0x3e79bf75beac3f6d,0x3d49bf7fbe163f7b
.quad 0xbf35bf80bf350000,0x3f353f803f350000,0xbf18bf7fbf3e0000,0x3edb3f753f5c3e48,0xbef1bf7bbf460000,0x3dc93f553f753ec4,0xbeacbf75bf4e0000,0xbe793f223f803f0e
.quad 0xbe48bf6dbf550000,0xbf0e3ec43f7b3f35,0xbd49bf62bf5c0000,0xbf4e3dc93f673f55,0x3dc9bf55bf620000,0xbf75be483f463f6d,0x3e79bf46bf670000,0xbf80bef13f183f7b
.quad 0x3ec4bf35bf6d0000,0xbf6dbf353ec43f80,0x3f04bf22bf710000,0xbf3ebf623e163f7b,0x3f22bf0ebf750000,0xbef1bf7bbdc93f6d,0x3f3ebef1bf780000,0xbe16bf7fbeac3f55
.quad 0x3f55bec4bf7b0000,0x3e48bf6dbf0e3f35,0x3f67be95bf7d0000,0x3f04bf46bf3e3f0e,0x3f75be48bf7f0000,0x3f46bf0ebf623ec4,0x3f7dbdc9bf800000,0x3f71be95bf783e48
.quad 0xbf35bf80bf350000,0x3f353f803f350000,0xbe79bf62bf71bec4,0x3d493f463f7d3f0e,0x3e95bf0ebf7fbf35,0xbf223e483f623f6d,0x3f3ebdc9bf5cbf6d,0xbf7dbef13edb3f7b
.quad 0x3f7b3ec4bf0ebf80,0xbf55bf6dbe483f35,0x3f713f46be16bf6d,0xbe79bf75bf3e3e48,0x3f223f7b3e95bf35,0x3ef1bf0ebf7fbec4,0x3e163f753f2cbec4,0x3f713dc9bf5cbf55
.quad 0xbec43f353f6d0000,0x3f6d3f35bec4bf80,0xbf4e3e953f803ec4,0x3edb3f7f3e79bf55,0xbf7fbe483f623f35,0xbe953f553f46bec4,0xbf67bf223f183f6d,0xbf5c3e953f803e48
.quad 0xbf0ebf6d3e483f80,0xbf7bbec43f553f35,0xbd49bf7fbe793f6d,0xbf18bf623eac3f7b,0x3ef1bf55bf223f35,0x3dc9bf7bbe953f6d,0x3f5cbef1bf673ec4,0x3f3ebf22bf4e3f0e
.quad 0xbf35bf80bf350000,0x3f353f803f350000,0x3e16bf22bf80bf35,0xbeac3ef13f783f55,0x3f623e48bf22bf80,0xbf7fbf0e3e953f6d,0x3f673f623e16bf35,0xbf04bf7fbf2c3e48
.quad 0x3e483f6d3f550000,0x3f0ebec4bf7bbf35,0xbf2c3e953f783f35,0x3f7d3f22beacbf7b,0xbf7fbf0e3ef13f80,0x3e953f7b3f22bec4,0xbf04bf7fbeac3f35,0xbf3e3e953f7d3f0e
.quad 0x3ec4bf35bf6d0000,0xbf6dbf353ec43f80,0x3f783dc9bf67bf35,0xbd49bf75bf183f0e,0x3f463f55be95bf80,0x3f62be48bf7fbec4,0xbd493f753f04bf35,0x3f4e3f46bedbbf7b
.quad 0xbf553ec43f7b0000,0xbe483f6d3f0ebf35,0xbf71bef13f4e3f35,0xbf783dc93f803e48,0xbe95bf7b3dc93f80,0xbf22bf553ef13f6d,0x3f18bf46bf2c3f35,0x3edbbf62bf043f55
.quad 0xbf35bf80bf350000,0x3f353f803f350000,0x3f04be95bf67bf6d,0xbf2c3dc93f4e3f7b,0x3f753f553dc9bf35,0xbf46bf7bbef13ec4,0xbd493f463f783ec4,0x3f18be95bf71bf55
.quad 0xbf7bbec43f0e3f80,0x3f553f6d3e48bf35,0xbedbbf7fbf183ec4,0xbf043ef13f803f0e,0x3f46be48bf75bf35,0xbf62bf553dc93f6d,0x3f4e3f62bd49bf6d,0x3edbbf22bf78be48
.quad 0xbec43f353f6d0000,0x3f6d3f35bec4bf80,0xbf7dbef13f2c3f6d,0xbeac3f463f5cbe48,0xbdc9bf7bbef13f35,0xbf75bf0e3f223f6d,0x3f71bdc9bf7dbec4,0x3e79bf62bf2c3f0e
.quad 0x3f0e3f6dbe48bf80,0x3f7b3ec4bf55bf35,0xbf2c3f223f5cbec4,0xbe163f753edbbf55,0xbf62bf0e3f463f35,0xbf7fbe483f753ec4,0x3e79bf75beac3f6d,0x3d49bf7fbe163f7b
.quad 0xbf35bf80bf350000,0x3f353f803f350000,0x3f4e3dc9bf2cbf80,0xbf67be953f043f7b,0x3ef13f7b3f460000,0xbdc9bf55bf75bec4,0xbf71be953f183f80,0x3f783f46bd49bf55
.quad 0xbe48bf6dbf550000,0xbf0e3ec43f7b3f35,0x3f803ef1bf04bf80,0xbf18bf7fbedb3f0e,0xbdc93f553f620000,0x3f753e48bf46bf6d,0xbf78bf223edb3f80,0xbd493f623f4ebe48
.quad 0x3ec4bf35bf6d0000,0xbf6dbf353ec43f80,0x3f5c3f46beacbf80,0x3f2cbef1bf7dbe48,0xbf223f0e3f750000,0x3ef13f7b3dc9bf6d,0xbf2cbf623e793f80,0xbf7dbdc93f713f0e
.quad 0x3f55bec4bf7b0000,0x3e48bf6dbf0e3f35,0x3edb3f75be16bf80,0x3f5c3f22bf2cbf55,0xbf753e483f7f0000,0xbf463f0e3f62bec4,0xbe16bf7f3d493f80,0xbeacbf753e793f7b
.quad 0xbf35bf80bf350000,0x3f353f803f350000,0x3f783ef1beacbf6d,0xbf80bf223e163f55,0xbe953f0e3f7f3f35,0x3f22be48bf62bf6d,0xbf2cbf7fbf043ec4,0x3e163f623f673e48
.quad 0x3f7b3ec4bf0ebf80,0xbf55bf6dbe483f35,0xbeac3f223f7d3ec4,0x3f783e95bf2cbf7b,0xbf22bf7bbe953f35,0xbef13f0e3f7f3ec4,0x3f7d3e95bf3ebf6d,0xbeacbf7fbf043f0e
.quad 0xbec43f353f6d0000,0x3f6d3f35bec4bf80,0xbf18bf75bd493f6d,0xbf673dc93f783f0e,0x3f7f3e48bf62bf35,0x3e95bf55bf463ec4,0xbedb3f463f4ebec4,0x3f043f75bd49bf7b
.quad 0xbf0ebf6d3e483f80,0xbf7bbec43f553f35,0x3f803dc9bf78bec4,0x3f4ebef1bf713e48,0xbef13f553f22bf35,0xbdc93f7b3e95bf6d,0xbf04bf623edb3f6d,0xbf2cbf463f183f55
.quad 0xbf35bf80bf350000,0x3f353f803f350000,0x3f7d3f463d49bf35,0xbf71bf62be793f0e,0xbf62be483f223f80,0x3f7f3f0ebe95bf6d,0x3edbbef1bf7dbf35,0xbf5cbdc93f3e3f7b
.quad 0x3e483f6d3f550000,0x3f0ebec4bf7bbf35,0xbf3ebf75be793f35,0xbe163f463f713e48,0x3f7f3f0ebef1bf80,0xbe95bf7bbf223ec4,0xbf5c3dc93f713f35,0x3f2c3f753e16bf55
.quad 0x3ec4bf35bf6d0000,0xbf6dbf353ec43f80,0x3e793f7f3edbbf35,0x3f803e95bf4ebf55,0xbf46bf553e953f80,0xbf623e483f7f3ec4,0x3f803e95bf5cbf35,0x3f18bf22bf673e48
.quad 0xbf553ec43f7b0000,0xbe483f6d3f0ebf35,0x3eacbf62bf183f35,0xbe79bf7fbd493f7b,0x3e953f7bbdc9bf80,0x3f223f55bef1bf6d,0xbf4ebf223f3e3f35,0xbf67bef13f5c3f0e
.quad 0xbf35bf80bf350000,0x3f353f803f350000,0x3f5c3f753edbbec4,0xbf3ebf7fbf183e48,0xbf75bf55bdc93f35,0x3f463f7b3ef1bec4,0x3f803f22be79bf6d,0xbf4ebf75beac3f0e
.quad 0xbf7bbec43f0e3f80,0x3f553f6d3e48bf35,0x3f673dc9bf4ebf6d,0xbf5cbf62bd493f55,0xbf463e483f753f35,0x3f623f55bdc9bf6d,0x3f18bef1bf80bec4,0xbf67bf463e793f7b
.quad 0xbec43f353f6d0000,0x3f6d3f35bec4bf80,0x3e16bf62bf3e3ec4,0xbf71bf223f043f7b,0x3dc93f7b3ef1bf35,0x3f753f0ebf22bf6d,0xbeacbf7fbe163f6d,0xbf78bef13f3e3f55
.quad 0x3f0e3f6dbe48bf80,0x3f7b3ec4bf55bf35,0xbf3ebf463f043f6d,0xbf7dbe953f673f0e,0x3f623f0ebf46bf35,0x3f7f3e48bf75bec4,0xbf78be953f713ec4,0xbf80bdc93f7d3e48
.quad 0xbf35bf80bf350000,0x3f353f803f350000,0x3f183f7f3f3e0000,0xbedbbf75bf5cbe48,0xbef1bf7bbf460000,0x3dc93f553f753ec4,0x3eac3f753f4e0000,0x3e79bf22bf80bf0e
.quad 0xbe48bf6dbf550000,0xbf0e3ec43f7b3f35,0x3d493f623f5c0000,0x3f4ebdc9bf67bf55,0x3dc9bf55bf620000,0xbf75be483f463f6d,0xbe793f463f670000,0x3f803ef1bf18bf7b
.quad 0x3ec4bf35bf6d0000,0xbf6dbf353ec43f80,0xbf043f223f710000,0x3f3e3f62be16bf7b,0x3f22bf0ebf750000,0xbef1bf7bbdc93f6d,0xbf3e3ef13f780000,0x3e163f7f3eacbf55
.quad 0x3f55bec4bf7b0000,0x3e48bf6dbf0e3f35,0xbf673e953f7d0000,0xbf043f463f3ebf0e,0x3f75be48bf7f0000,0x3f46bf0ebf623ec4,0xbf7d3dc93f800000,0xbf713e953f78be48
.quad 0xbf35bf80bf350000,0x3f353f803f350000,0x3e793f623f713ec4,0xbd49bf46bf7dbf0e,0x3e95bf0ebf7fbf35,0xbf223e483f623f6d,0xbf3e3dc93f5c3f6d,0x3f7d3ef1bedbbf7b
.quad 0x3f7b3ec4bf0ebf80,0xbf55bf6dbe483f35,0xbf71bf463e163f6d,0x3e793f753f3ebe48,0x3f223f7b3e95bf35,0x3ef1bf0ebf7fbec4,0xbe16bf75bf2c3ec4,0xbf71bdc93f5c3f55
.quad 0xbec43f353f6d0000,0x3f6d3f35bec4bf80,0x3f4ebe95bf80bec4,0xbedbbf7fbe793f55,0xbf7fbe483f623f35,0xbe953f553f46bec4,0x3f673f22bf18bf6d,0x3f5cbe95bf80be48
.quad 0xbf0ebf6d3e483f80,0xbf7bbec43f553f35,0x3d493f7f3e79bf6d,0x3f183f62beacbf7b,0x3ef1bf55bf223f35,0x3dc9bf7bbe953f6d,0xbf5c3ef13f67bec4,0xbf3e3f223f4ebf0e
.quad 0xbf35bf80bf350000,0x3f353f803f350000,0xbe163f223f803f35,0x3eacbef1bf78bf55,0x3f623e48bf22bf80,0xbf7fbf0e3e953f6d,0xbf67bf62be163f35,0x3f043f7f3f2cbe48
.quad 0x3e483f6d3f550000,0x3f0ebec4bf7bbf35,0x3f2cbe95bf78bf35,0xbf7dbf223eac3f7b,0xbf7fbf0e3ef13f80,0x3e953f7b3f22bec4,0x3f043f7f3eacbf35,0x3f3ebe95bf7dbf0e
.quad 0x3ec4bf35bf6d0000,0xbf6dbf353ec43f80,0xbf78bdc93f673f35,0x3d493f753f18bf0e,0x3f463f55be95bf80,0x3f62be48bf7fbec4,0x3d49bf75bf043f35,0xbf4ebf463edb3f7b
.quad 0xbf553ec43f7b0000,0xbe483f6d3f0ebf35,0x3f713ef1bf4ebf35,0x3f78bdc9bf80be48,0xbe95bf7b3dc93f80,0xbf22bf553ef13f6d,0xbf183f463f2cbf35,0xbedb3f623f04bf55
.quad 0xbf35bf80bf350000,0x3f353f803f350000,0xbf043e953f673f6d,0x3f2cbdc9bf4ebf7b,0x3f753f553dc9bf35,0xbf46bf7bbef13ec4,0x3d49bf46bf78bec4,0xbf183e953f713f55
.quad 0xbf7bbec43f0e3f80,0x3f553f6d3e48bf35,0x3edb3f7f3f18bec4,0x3f04bef1bf80bf0e,0x3f46be48bf75bf35,0xbf62bf553dc93f6d,0xbf4ebf623d493f6d,0xbedb3f223f783e48
.quad 0xbec43f353f6d0000,0x3f6d3f35bec4bf80,0x3f7d3ef1bf2cbf6d,0x3eacbf46bf5c3e48,0xbdc9bf7bbef13f35,0xbf75bf0e3f223f6d,0xbf713dc93f7d3ec4,0xbe793f623f2cbf0e
.quad 0x3f0e3f6dbe48bf80,0x3f7b3ec4bf55bf35,0x3f2cbf22bf5c3ec4,0x3e16bf75bedb3f55,0xbf62bf0e3f463f35,0xbf7fbe483f753ec4,0xbe793f753eacbf6d,0xbd493f7f3e16bf7b
.quad 0xbf35bf80bf350000,0x3f353f803f350000,0xbf4ebdc93f2c3f80,0x3f673e95bf04bf7b,0x3ef13f7b3f460000,0xbdc9bf55bf75bec4,0x3f713e95bf18bf80,0xbf78bf463d493f55
.quad 0xbe48bf6dbf550000,0xbf0e3ec43f7b3f35,0xbf80bef13f043f80,0x3f183f7f3edbbf0e,0xbdc93f553f620000,0x3f753e48bf46bf6d,0x3f783f22bedbbf80,0x3d49bf62bf4e3e48
.quad 0x3ec4bf35bf6d0000,0xbf6dbf353ec43f80,0xbf5cbf463eac3f80,0xbf2c3ef13f7d3e48,0xbf223f0e3f750000,0x3ef13f7b3dc9bf6d,0x3f2c3f62be79bf80,0x3f7d3dc9bf71bf0e
.quad 0x3f55bec4bf7b0000,0x3e48bf6dbf0e3f35,0xbedbbf753e163f80,0xbf5cbf223f2c3f55,0xbf753e483f7f0000,0xbf463f0e3f62bec4,0x3e163f7fbd49bf80,0x3eac3f75be79bf7b
.quad 0xbf35bf80bf350000,0x3f353f803f350000,0xbf78bef13eac3f6d,0x3f803f22be16bf55,0xbe953f0e3f7f3f35,0x3f22be48bf62bf6d,0x3f2c3f7f3f04bec4,0xbe16bf62bf67be48
.quad 0x3f7b3ec4bf0ebf80,0xbf55bf6dbe483f35,0x3eacbf22bf7dbec4,0xbf78be953f2c3f7b,0xbf22bf7bbe953f35,0xbef13f0e3f7f3ec4,0xbf7dbe953f3e3f6d,0x3eac3f7f3f04bf0e
.quad 0xbec43f353f6d0000,0x3f6d3f35bec4bf80,0x3f183f753d49bf6d,0x3f67bdc9bf78bf0e,0x3f7f3e48bf62bf35,0x3e95bf55bf463ec4,0x3edbbf46bf4e3ec4,0xbf04bf753d493f7b
.quad 0xbf0ebf6d3e483f80,0xbf7bbec43f553f35,0xbf80bdc93f783ec4,0xbf4e3ef13f71be48,0xbef13f553f22bf35,0xbdc93f7b3e95bf6d,0x3f043f62bedbbf6d,0x3f2c3f46bf18bf55
.quad 0xbf35bf80bf350000,0x3f353f803f350000,0xbf7dbf46bd493f35,0x3f713f623e79bf0e,0xbf62be483f223f80,0x3f7f3f0ebe95bf6d,0xbedb3ef13f7d3f35,0x3f5c3dc9bf3ebf7b
.quad 0x3e483f6d3f550000,0x3f0ebec4bf7bbf35,0x3f3e3f753e79bf35,0x3e16bf46bf71be48,0x3f7f3f0ebef1bf80,0xbe95bf7bbf223ec4,0x3f5cbdc9bf71bf35,0xbf2cbf75be163f55
.quad 0x3ec4bf35bf6d0000,0xbf6dbf353ec43f80,0xbe79bf7fbedb3f35,0xbf80be953f4e3f55,0xbf46bf553e953f80,0xbf623e483f7f3ec4,0xbf80be953f5c3f35,0xbf183f223f67be48
.quad 0xbf553ec43f7b0000,0xbe483f6d3f0ebf35,0xbeac3f623f18bf35,0x3e793f7f3d49bf7b,0x3e953f7bbdc9bf80,0x3f223f55bef1bf6d,0x3f4e3f22bf3ebf35,0x3f673ef1bf5cbf0e
.quad 0xbf35bf80bf350000,0x3f353f803f350000,0xbf5cbf75bedb3ec4,0x3f3e3f7f3f18be48,0xbf75bf55bdc93f35,0x3f463f7b3ef1bec4,0xbf80bf223e793f6d,0x3f4e3f753eacbf0e
.quad 0xbf7bbec43f0e3f80,0x3f553f6d3e48bf35,0xbf67bdc93f4e3f6d,0x3f5c3f623d49bf55,0xbf463e483f753f35,0x3f623f55bdc9bf6d,0xbf183ef13f803ec4,0x3f673f46be79bf7b
.quad 0xbec43f353f6d0000,0x3f6d3f35bec4bf80,0xbe163f623f3ebec4,0x3f713f22bf04bf7b,0x3dc93f7b3ef1bf35,0x3f753f0ebf22bf6d,0x3eac3f7f3e16bf6d,0x3f783ef1bf3ebf55
.quad 0x3f0e3f6dbe48bf80,0x3f7b3ec4bf55bf35,0x3f3e3f46bf04bf6d,0x3f7d3e95bf67bf0e,0x3f623f0ebf46bf35,0x3f7f3e48bf75bec4,0x3f783e95bf71bec4,0x3f803dc9bf7dbe48
.quad 0xbf8000003f80,0xbf8000003f80,0x3e16bf7fbd493f80,0x3eacbf75be793f7b,0x3e95bf7bbdc93f80,0x3f22bf55bef13f6d,0x3edbbf75be163f80,0x3f5cbf22bf2c3f55
.quad 0x3f0ebf6dbe483f80,0x3f7bbec4bf553f35,0x3f2cbf62be793f80,0x3f7dbdc9bf713f0e,0x3f46bf55be953f80,0x3f623e48bf7f3ec4,0x3f5cbf46beac3f80,0x3f2c3ef1bf7d3e48
.quad 0x3f6dbf35bec43f80,0x3ec43f35bf6d0000,0x3f78bf22bedb3f80,0x3d493f62bf4ebe48,0x3f7fbf0ebef13f80,0xbe953f7bbf22bec4,0x3f80bef1bf043f80,0xbf183f7fbedbbf0e
.quad 0x3f7bbec4bf0e3f80,0xbf553f6dbe48bf35,0x3f71be95bf183f80,0xbf783f463d49bf55,0x3f62be48bf223f80,0xbf7f3f0e3e95bf6d,0x3f4ebdc9bf2c3f80,0xbf673e953f04bf7b
.quad 0xbf8000003f80,0xbf8000003f80,0x3f04bf62bedb3f6d,0x3f2cbf46bf183f55,0x3f62bf0ebf463f35,0x3f7fbe48bf753ec4,0x3f80bdc9bf783ec4,0x3f4e3ef1bf71be48
.quad 0x3f553ec4bf7b0000,0x3e483f6dbf0ebf35,0x3edb3f46bf4ebec4,0xbf043f753d49bf7b,0xbdc93f7bbef1bf35,0xbf753f0e3f22bf6d,0xbf183f75bd49bf6d,0xbf67bdc93f78bf0e
.quad 0xbf6d3f353ec4bf80,0xbec4bf353f6d0000,0xbf7d3e953f3ebf6d,0x3eacbf7f3f043f0e,0xbf46be483f75bf35,0x3f62bf55bdc93f6d,0xbeacbf223f7dbec4,0x3f78be95bf2c3f7b
.quad 0x3e48bf6d3f550000,0x3f0e3ec4bf7b3f35,0x3f2cbf7f3f043ec4,0xbe163f62bf673e48,0x3f75bf553dc93f35,0xbf463f7bbef1bec4,0x3f78bef1beac3f6d,0xbf803f223e16bf55
.quad 0xbf8000003f80,0xbf8000003f80,0x3f4ebf22bf3e3f35,0x3f67bef1bf5c3f0e,0x3f753e48bf7f0000,0x3f463f0ebf62bec4,0x3eac3f62bf18bf35,0xbe793f7fbd49bf7b
.quad 0xbf0e3f6d3e48bf80,0xbf7b3ec43f55bf35,0xbf803e953f5cbf35,0xbf18bf223f673e48,0xbf22bf0e3f750000,0x3ef1bf7b3dc93f6d,0x3e79bf7f3edb3f35,0x3f80be95bf4e3f55
.quad 0x3f6dbf35bec43f80,0x3ec43f35bf6d0000,0x3f5c3dc9bf713f35,0xbf2c3f75be16bf55,0x3dc93f55bf620000,0xbf753e483f46bf6d,0xbf3e3f75be79bf35,0xbe16bf463f71be48
.quad 0xbf7b3ec43f0ebf80,0x3f55bf6d3e483f35,0xbedbbef13f7dbf35,0x3f5cbdc9bf3e3f7b,0x3ef1bf7b3f460000,0xbdc93f55bf753ec4,0x3f7dbf463d493f35,0xbf713f62be79bf0e
.quad 0xbf8000003f80,0xbf8000003f80,0x3f78be95bf713ec4,0x3f80bdc9bf7d3e48,0x3ef13f55bf22bf35,0x3dc93f7bbe95bf6d,0xbf3e3f463f04bf6d,0xbf7d3e953f67bf0e
.quad 0xbf55bec43f7b0000,0xbe48bf6d3f0e3f35,0x3eacbf7f3e163f6d,0x3f78bef1bf3e3f55,0x3f7fbe48bf623f35,0x3e953f55bf46bec4,0x3e163f62bf3ebec4,0xbf713f223f04bf7b
.quad 0xbf6d3f353ec4bf80,0xbec4bf353f6d0000,0xbf18bef13f80bec4,0x3f67bf46be793f7b,0x3f22bf7b3e953f35,0x3ef13f0ebf7f3ec4,0x3f67bdc9bf4e3f6d,0xbf5c3f62bd49bf55
.quad 0xbe483f6dbf550000,0xbf0ebec43f7bbf35,0xbf803f223e79bf6d,0x3f4ebf753eac3f0e,0xbe95bf0e3f7fbf35,0x3f223e48bf623f6d,0x3f5cbf753edb3ec4,0xbf3e3f7fbf18be48
.quad 0xbf8000003f80,0xbf8000003f80,0x3f7d3dc9bf800000,0x3f713e95bf78be48,0xbe953f7b3dc9bf80,0xbf223f553ef1bf6d,0xbf67be953f7d0000,0xbf04bf463f3e3f0e
.quad 0x3f0ebf6dbe483f80,0x3f7bbec4bf553f35,0x3f3e3ef1bf780000,0xbe163f7fbeacbf55,0xbf463f553e95bf80,0xbf62be483f7fbec4,0xbf04bf223f710000,0x3f3ebf62be163f7b
.quad 0x3f6dbf35bec43f80,0x3ec43f35bf6d0000,0x3e793f46bf670000,0xbf803ef13f18bf7b,0xbf7f3f0e3ef1bf80,0x3e95bf7b3f223ec4,0x3d49bf623f5c0000,0x3f4e3dc9bf673f55
.quad 0x3f7bbec4bf0e3f80,0xbf553f6dbe48bf35,0xbeac3f75bf4e0000,0xbe79bf223f80bf0e,0xbf623e483f22bf80,0x3f7fbf0ebe953f6d,0x3f18bf7f3f3e0000,0xbedb3f75bf5c3e48
.quad 0xbf8000003f80,0xbf8000003f80,0x3f5c3ef1bf67bec4,0x3f3e3f22bf4ebf0e,0xbf623f0e3f46bf35,0xbf7f3e483f75bec4,0x3d49bf7f3e793f6d,0x3f18bf62beac3f7b
.quad 0x3f553ec4bf7b0000,0x3e483f6dbf0ebf35,0xbf673f223f18bf6d,0xbf5cbe953f80be48,0x3dc9bf7b3ef13f35,0x3f75bf0ebf223f6d,0x3f4e3e95bf803ec4,0xbedb3f7fbe79bf55
.quad 0xbf6d3f353ec4bf80,0xbec4bf353f6d0000,0x3e16bf753f2c3ec4,0x3f71bdc9bf5c3f55,0x3f463e48bf753f35,0xbf623f553dc9bf6d,0xbf713f463e16bf6d,0x3e79bf753f3e3e48
.quad 0x3e48bf6d3f550000,0x3f0e3ec4bf7b3f35,0x3f3e3dc9bf5c3f6d,0xbf7d3ef13edbbf7b,0xbf753f55bdc9bf35,0x3f46bf7b3ef13ec4,0x3e79bf623f71bec4,0xbd493f46bf7d3f0e
.quad 0xbf8000003f80,0xbf8000003f80,0x3f183f46bf2cbf35,0x3edb3f62bf04bf55,0xbf75be483f7f0000,0xbf46bf0e3f623ec4,0x3f71bef1bf4e3f35,0x3f783dc9bf803e48
.quad 0xbf0e3f6d3e48bf80,0xbf7b3ec43f55bf35,0xbd49bf753f043f35,0x3f4ebf46bedb3f7b,0x3f223f0ebf750000,0xbef13f7bbdc9bf6d,0xbf783dc93f67bf35,0x3d49bf753f183f0e
.quad 0x3f6dbf35bec43f80,0x3ec43f35bf6d0000,0xbf043f7fbeacbf35,0xbf3ebe953f7dbf0e,0xbdc9bf553f620000,0x3f75be48bf463f6d,0x3f2c3e95bf783f35,0xbf7d3f223eacbf7b
.quad 0xbf7b3ec43f0ebf80,0x3f55bf6d3e483f35,0x3f67bf623e163f35,0xbf043f7fbf2cbe48,0xbef13f7bbf460000,0x3dc9bf553f75bec4,0xbe16bf223f80bf35,0x3eac3ef1bf783f55
.quad 0xbf8000003f80,0xbf8000003f80,0x3e793f75beacbf6d,0x3d493f7fbe16bf7b,0xbef1bf553f223f35,0xbdc9bf7b3e953f6d,0x3f2c3f22bf5cbec4,0x3e163f75bedbbf55
.quad 0xbf55bec43f7b0000,0xbe48bf6d3f0e3f35,0x3f713dc9bf7d3ec4,0x3e793f62bf2cbf0e,0xbf7f3e483f62bf35,0xbe95bf553f463ec4,0x3f7dbef1bf2c3f6d,0x3eac3f46bf5cbe48
.quad 0xbf6d3f353ec4bf80,0xbec4bf353f6d0000,0x3f4ebf62bd493f6d,0x3edb3f22bf783e48,0xbf223f7bbe95bf35,0xbef1bf0e3f7fbec4,0x3edbbf7f3f183ec4,0x3f043ef1bf803f0e
.quad 0xbe483f6dbf550000,0xbf0ebec43f7bbf35,0xbd49bf463f78bec4,0x3f183e95bf713f55,0x3e953f0ebf7f3f35,0xbf22be483f62bf6d,0xbf04be953f67bf6d,0x3f2c3dc9bf4e3f7b
.quad 0xbf8000003f80,0xbf8000003f80,0xbe163f7f3d49bf80,0xbeac3f753e79bf7b,0x3e95bf7bbdc93f80,0x3f22bf55bef13f6d,0xbedb3f753e16bf80,0xbf5c3f223f2cbf55
.quad 0x3f0ebf6dbe483f80,0x3f7bbec4bf553f35,0xbf2c3f623e79bf80,0xbf7d3dc93f71bf0e,0x3f46bf55be953f80,0x3f623e48bf7f3ec4,0xbf5c3f463eacbf80,0xbf2cbef13f7dbe48
.quad 0x3f6dbf35bec43f80,0x3ec43f35bf6d0000,0xbf783f223edbbf80,0xbd49bf623f4e3e48,0x3f7fbf0ebef13f80,0xbe953f7bbf22bec4,0xbf803ef13f04bf80,0x3f18bf7f3edb3f0e
.quad 0x3f7bbec4bf0e3f80,0xbf553f6dbe48bf35,0xbf713e953f18bf80,0x3f78bf46bd493f55,0x3f62be48bf223f80,0xbf7f3f0e3e95bf6d,0xbf4e3dc93f2cbf80,0x3f67be95bf043f7b
.quad 0xbf8000003f80,0xbf8000003f80,0xbf043f623edbbf6d,0xbf2c3f463f18bf55,0x3f62bf0ebf463f35,0x3f7fbe48bf753ec4,0xbf803dc93f78bec4,0xbf4ebef13f713e48
.quad 0x3f553ec4bf7b0000,0x3e483f6dbf0ebf35,0xbedbbf463f4e3ec4,0x3f04bf75bd493f7b,0xbdc93f7bbef1bf35,0xbf753f0e3f22bf6d,0x3f18bf753d493f6d,0x3f673dc9bf783f0e
.quad 0xbf6d3f353ec4bf80,0xbec4bf353f6d0000,0x3f7dbe95bf3e3f6d,0xbeac3f7fbf04bf0e,0xbf46be483f75bf35,0x3f62bf55bdc93f6d,0x3eac3f22bf7d3ec4,0xbf783e953f2cbf7b
.quad 0x3e48bf6d3f550000,0x3f0e3ec4bf7b3f35,0xbf2c3f7fbf04bec4,0x3e16bf623f67be48,0x3f75bf553dc93f35,0xbf463f7bbef1bec4,0xbf783ef13eacbf6d,0x3f80bf22be163f55
.quad 0xbf8000003f80,0xbf8000003f80,0xbf4e3f223f3ebf35,0xbf673ef13f5cbf0e,0x3f753e48bf7f0000,0x3f463f0ebf62bec4,0xbeacbf623f183f35,0x3e79bf7f3d493f7b
.quad 0xbf0e3f6d3e48bf80,0xbf7b3ec43f55bf35,0x3f80be95bf5c3f35,0x3f183f22bf67be48,0xbf22bf0e3f750000,0x3ef1bf7b3dc93f6d,0xbe793f7fbedbbf35,0xbf803e953f4ebf55
.quad 0x3f6dbf35bec43f80,0x3ec43f35bf6d0000,0xbf5cbdc93f71bf35,0x3f2cbf753e163f55,0x3dc93f55bf620000,0xbf753e483f46bf6d,0x3f3ebf753e793f35,0x3e163f46bf713e48
.quad 0xbf7b3ec43f0ebf80,0x3f55bf6d3e483f35,0x3edb3ef1bf7d3f35,0xbf5c3dc93f3ebf7b,0x3ef1bf7b3f460000,0xbdc93f55bf753ec4,0xbf7d3f46bd49bf35,0x3f71bf623e793f0e
.quad 0xbf8000003f80,0xbf8000003f80,0xbf783e953f71bec4,0xbf803dc93f7dbe48,0x3ef13f55bf22bf35,0x3dc93f7bbe95bf6d,0x3f3ebf46bf043f6d,0x3f7dbe95bf673f0e
.quad 0xbf55bec43f7b0000,0xbe48bf6d3f0e3f35,0xbeac3f7fbe16bf6d,0xbf783ef13f3ebf55,0x3f7fbe48bf623f35,0x3e953f55bf46bec4,0xbe16bf623f3e3ec4,0x3f71bf22bf043f7b
.quad 0xbf6d3f353ec4bf80,0xbec4bf353f6d0000,0x3f183ef1bf803ec4,0xbf673f463e79bf7b,0x3f22bf7b3e953f35,0x3ef13f0ebf7f3ec4,0xbf673dc93f4ebf6d,0x3f5cbf623d493f55
.quad 0xbe483f6dbf550000,0xbf0ebec43f7bbf35,0x3f80bf22be793f6d,0xbf4e3f75beacbf0e,0xbe95bf0e3f7fbf35,0x3f223e48bf623f6d,0xbf5c3f75bedbbec4,0x3f3ebf7f3f183e48
.quad 0xbf8000003f80,0xbf8000003f80,0xbf7dbdc93f800000,0xbf71be953f783e48,0xbe953f7b3dc9bf80,0xbf223f553ef1bf6d,0x3f673e95bf7d0000,0x3f043f46bf3ebf0e
.quad 0x3f0ebf6dbe483f80,0x3f7bbec4bf553f35,0xbf3ebef13f780000,0x3e16bf7f3eac3f55,0xbf463f553e95bf80,0xbf62be483f7fbec4,0x3f043f22bf710000,0xbf3e3f623e16bf7b
.quad 0x3f6dbf35bec43f80,0x3ec43f35bf6d0000,0xbe79bf463f670000,0x3f80bef1bf183f7b,0xbf7f3f0e3ef1bf80,0x3e95bf7b3f223ec4,0xbd493f62bf5c0000,0xbf4ebdc93f67bf55
.quad 0x3f7bbec4bf0e3f80,0xbf553f6dbe48bf35,0x3eacbf753f4e0000,0x3e793f22bf803f0e,0xbf623e483f22bf80,0x3f7fbf0ebe953f6d,0xbf183f7fbf3e0000,0x3edbbf753f5cbe48
.quad 0xbf8000003f80,0xbf8000003f80,0xbf5cbef13f673ec4,0xbf3ebf223f4e3f0e,0xbf623f0e3f46bf35,0xbf7f3e483f75bec4,0xbd493f7fbe79bf6d,0xbf183f623eacbf7b
.quad 0x3f553ec4bf7b0000,0x3e483f6dbf0ebf35,0x3f67bf22bf183f6d,0x3f5c3e95bf803e48,0x3dc9bf7b3ef13f35,0x3f75bf0ebf223f6d,0xbf4ebe953f80bec4,0x3edbbf7f3e793f55
.quad 0xbf6d3f353ec4bf80,0xbec4bf353f6d0000,0xbe163f75bf2cbec4,0xbf713dc93f5cbf55,0x3f463e48bf753f35,0xbf623f553dc9bf6d,0x3f71bf46be163f6d,0xbe793f75bf3ebe48
.quad 0x3e48bf6d3f550000,0x3f0e3ec4bf7b3f35,0xbf3ebdc93f5cbf6d,0x3f7dbef1bedb3f7b,0xbf753f55bdc9bf35,0x3f46bf7b3ef13ec4,0xbe793f62bf713ec4,0x3d49bf463f7dbf0e
.quad 0xbf8000003f80,0xbf8000003f80,0xbf18bf463f2c3f35,0xbedbbf623f043f55,0xbf75be483f7f0000,0xbf46bf0e3f623ec4,0xbf713ef13f4ebf35,0xbf78bdc93f80be48
.quad 0xbf0e3f6d3e48bf80,0xbf7b3ec43f55bf35,0x3d493f75bf04bf35,0xbf4e3f463edbbf7b,0x3f223f0ebf750000,0xbef13f7bbdc9bf6d,0x3f78bdc9bf673f35,0xbd493f75bf18bf0e
.quad 0x3f6dbf35bec43f80,0x3ec43f35bf6d0000,0x3f04bf7f3eac3f35,0x3f3e3e95bf7d3f0e,0xbdc9bf553f620000,0x3f75be48bf463f6d,0xbf2cbe953f78bf35,0x3f7dbf22beac3f7b
.quad 0xbf7b3ec43f0ebf80,0x3f55bf6d3e483f35,0xbf673f62be16bf35,0x3f04bf7f3f2c3e48,0xbef13f7bbf460000,0x3dc9bf553f75bec4,0x3e163f22bf803f35,0xbeacbef13f78bf55
.quad 0xbf8000003f80,0xbf8000003f80,0xbe79bf753eac3f6d,0xbd49bf7f3e163f7b,0xbef1bf553f223f35,0xbdc9bf7b3e953f6d,0xbf2cbf223f5c3ec4,0xbe16bf753edb3f55
.quad 0xbf55bec43f7b0000,0xbe48bf6d3f0e3f35,0xbf71bdc93f7dbec4,0xbe79bf623f2c3f0e,0xbf7f3e483f62bf35,0xbe95bf553f463ec4,0xbf7d3ef13f2cbf6d,0xbeacbf463f5c3e48
.quad 0xbf6d3f353ec4bf80,0xbec4bf353f6d0000,0xbf4e3f623d49bf6d,0xbedbbf223f78be48,0xbf223f7bbe95bf35,0xbef1bf0e3f7fbec4,0xbedb3f7fbf18bec4,0xbf04bef13f80bf0e
.quad 0xbe483f6dbf550000,0xbf0ebec43f7bbf35,0x3d493f46bf783ec4,0xbf18be953f71bf55,0x3e953f0ebf7f3f35,0xbf22be483f62bf6d,0x3f043e95bf673f6d,0xbf2cbdc93f4ebf7b
.quad 0x3f800000bf800000,0x3f800000bf800000,0x3f7d3dc9bf800000,0x3f713e95bf78be48,0x3f753e48bf7f0000,0x3f463f0ebf62bec4,0x3f673e95bf7d0000,0x3f043f46bf3ebf0e
.quad 0x3f553ec4bf7b0000,0x3e483f6dbf0ebf35,0x3f3e3ef1bf780000,0xbe163f7fbeacbf55,0x3f223f0ebf750000,0xbef13f7bbdc9bf6d,0x3f043f22bf710000,0xbf3e3f623e16bf7b
.quad 0x3ec43f35bf6d0000,0xbf6d3f353ec4bf80,0x3e793f46bf670000,0xbf803ef13f18bf7b,0x3dc93f55bf620000,0xbf753e483f46bf6d,0xbd493f62bf5c0000,0xbf4ebdc93f67bf55
.quad 0xbe483f6dbf550000,0xbf0ebec43f7bbf35,0xbeac3f75bf4e0000,0xbe79bf223f80bf0e,0xbef13f7bbf460000,0x3dc9bf553f75bec4,0xbf183f7fbf3e0000,0x3edbbf753f5cbe48
.quad 0x3f800000bf800000,0x3f800000bf800000,0x3f5c3ef1bf67bec4,0x3f3e3f22bf4ebf0e,0x3ef13f55bf22bf35,0x3dc93f7bbe95bf6d,0xbd493f7fbe79bf6d,0xbf183f623eacbf7b
.quad 0xbf0e3f6d3e48bf80,0xbf7b3ec43f55bf35,0xbf673f223f18bf6d,0xbf5cbe953f80be48,0xbf7f3e483f62bf35,0xbe95bf553f463ec4,0xbf4ebe953f80bec4,0x3edbbf7f3e793f55
.quad 0xbec4bf353f6d0000,0x3f6dbf35bec43f80,0x3e16bf753f2c3ec4,0x3f71bdc9bf5c3f55,0x3f22bf7b3e953f35,0x3ef13f0ebf7f3ec4,0x3f71bf46be163f6d,0xbe793f75bf3ebe48
.quad 0x3f7bbec4bf0e3f80,0xbf553f6dbe48bf35,0x3f3e3dc9bf5c3f6d,0xbf7d3ef13edbbf7b,0x3e953f0ebf7f3f35,0xbf22be483f62bf6d,0xbe793f62bf713ec4,0x3d49bf463f7dbf0e
.quad 0x3f800000bf800000,0x3f800000bf800000,0x3f183f46bf2cbf35,0x3edb3f62bf04bf55,0xbe953f7b3dc9bf80,0xbf223f553ef1bf6d,0xbf713ef13f4ebf35,0xbf78bdc93f80be48
.quad 0xbf55bec43f7b0000,0xbe48bf6d3f0e3f35,0xbd49bf753f043f35,0x3f4ebf46bedb3f7b,0x3f46bf55be953f80,0x3f623e48bf7f3ec4,0x3f78bdc9bf673f35,0xbd493f75bf18bf0e
.quad 0x3ec43f35bf6d0000,0xbf6d3f353ec4bf80,0xbf043f7fbeacbf35,0xbf3ebe953f7dbf0e,0xbf7f3f0e3ef1bf80,0x3e95bf7b3f223ec4,0xbf2cbe953f78bf35,0x3f7dbf22beac3f7b
.quad 0x3e48bf6d3f550000,0x3f0e3ec4bf7b3f35,0x3f67bf623e163f35,0xbf043f7fbf2cbe48,0x3f62be48bf223f80,0xbf7f3f0e3e95bf6d,0x3e163f22bf803f35,0xbeacbef13f78bf55
.quad 0x3f800000bf800000,0x3f800000bf800000,0x3e793f75beacbf6d,0x3d493f7fbe16bf7b,0xbf623f0e3f46bf35,0xbf7f3e483f75bec4,0xbf2cbf223f5c3ec4,0xbe16bf753edb3f55
.quad 0x3f0ebf6dbe483f80,0x3f7bbec4bf553f35,0x3f713dc9bf7d3ec4,0x3e793f62bf2cbf0e,0xbdc93f7bbef1bf35,0xbf753f0e3f22bf6d,0xbf7d3ef13f2cbf6d,0xbeacbf463f5c3e48
.quad 0xbec4bf353f6d0000,0x3f6dbf35bec43f80,0x3f4ebf62bd493f6d,0x3edb3f22bf783e48,0x3f463e48bf753f35,0xbf623f553dc9bf6d,0xbedb3f7fbf18bec4,0xbf04bef13f80bf0e
.quad 0xbf7b3ec43f0ebf80,0x3f55bf6d3e483f35,0xbd49bf463f78bec4,0x3f183e95bf713f55,0x3f75bf553dc93f35,0xbf463f7bbef1bec4,0x3f043e95bf673f6d,0xbf2cbdc93f4ebf7b
.quad 0x3f800000bf800000,0x3f800000bf800000,0xbe163f7f3d49bf80,0xbeac3f753e79bf7b,0xbf75be483f7f0000,0xbf46bf0e3f623ec4,0x3edbbf75be163f80,0x3f5cbf22bf2c3f55
.quad 0x3f553ec4bf7b0000,0x3e483f6dbf0ebf35,0xbf2c3f623e79bf80,0xbf7d3dc93f71bf0e,0xbf22bf0e3f750000,0x3ef1bf7b3dc93f6d,0x3f5cbf46beac3f80,0x3f2c3ef1bf7d3e48
.quad 0x3ec43f35bf6d0000,0xbf6d3f353ec4bf80,0xbf783f223edbbf80,0xbd49bf623f4e3e48,0xbdc9bf553f620000,0x3f75be48bf463f6d,0x3f80bef1bf043f80,0xbf183f7fbedbbf0e
.quad 0xbe483f6dbf550000,0xbf0ebec43f7bbf35,0xbf713e953f18bf80,0x3f78bf46bd493f55,0x3ef1bf7b3f460000,0xbdc93f55bf753ec4,0x3f4ebdc9bf2c3f80,0xbf673e953f04bf7b
.quad 0x3f800000bf800000,0x3f800000bf800000,0xbf043f623edbbf6d,0xbf2c3f463f18bf55,0xbef1bf553f223f35,0xbdc9bf7b3e953f6d,0x3f80bdc9bf783ec4,0x3f4e3ef1bf71be48
.quad 0xbf0e3f6d3e48bf80,0xbf7b3ec43f55bf35,0xbedbbf463f4e3ec4,0x3f04bf75bd493f7b,0x3f7fbe48bf623f35,0x3e953f55bf46bec4,0xbf183f75bd49bf6d,0xbf67bdc93f78bf0e
.quad 0xbec4bf353f6d0000,0x3f6dbf35bec43f80,0x3f7dbe95bf3e3f6d,0xbeac3f7fbf04bf0e,0xbf223f7bbe95bf35,0xbef1bf0e3f7fbec4,0xbeacbf223f7dbec4,0x3f78be95bf2c3f7b
.quad 0x3f7bbec4bf0e3f80,0xbf553f6dbe48bf35,0xbf2c3f7fbf04bec4,0x3e16bf623f67be48,0xbe95bf0e3f7fbf35,0x3f223e48bf623f6d,0x3f78bef1beac3f6d,0xbf803f223e16bf55
.quad 0x3f800000bf800000,0x3f800000bf800000,0xbf4e3f223f3ebf35,0xbf673ef13f5cbf0e,0x3e95bf7bbdc93f80,0x3f22bf55bef13f6d,0x3eac3f62bf18bf35,0xbe793f7fbd49bf7b
.quad 0xbf55bec43f7b0000,0xbe48bf6d3f0e3f35,0x3f80be95bf5c3f35,0x3f183f22bf67be48,0xbf463f553e95bf80,0xbf62be483f7fbec4,0x3e79bf7f3edb3f35,0x3f80be95bf4e3f55
.quad 0x3ec43f35bf6d0000,0xbf6d3f353ec4bf80,0xbf5cbdc93f71bf35,0x3f2cbf753e163f55,0x3f7fbf0ebef13f80,0xbe953f7bbf22bec4,0xbf3e3f75be79bf35,0xbe16bf463f71be48
.quad 0x3e48bf6d3f550000,0x3f0e3ec4bf7b3f35,0x3edb3ef1bf7d3f35,0xbf5c3dc93f3ebf7b,0xbf623e483f22bf80,0x3f7fbf0ebe953f6d,0x3f7dbf463d493f35,0xbf713f62be79bf0e
.quad 0x3f800000bf800000,0x3f800000bf800000,0xbf783e953f71bec4,0xbf803dc93f7dbe48,0x3f62bf0ebf463f35,0x3f7fbe48bf753ec4,0xbf3e3f463f04bf6d,0xbf7d3e953f67bf0e
.quad 0x3f0ebf6dbe483f80,0x3f7bbec4bf553f35,0xbeac3f7fbe16bf6d,0xbf783ef13f3ebf55,0x3dc9bf7b3ef13f35,0x3f75bf0ebf223f6d,0x3e163f62bf3ebec4,0xbf713f223f04bf7b
.quad 0xbec4bf353f6d0000,0x3f6dbf35bec43f80,0x3f183ef1bf803ec4,0xbf673f463e79bf7b,0xbf46be483f75bf35,0x3f62bf55bdc93f6d,0x3f67bdc9bf4e3f6d,0xbf5c3f62bd49bf55
.quad 0xbf7b3ec43f0ebf80,0x3f55bf6d3e483f35,0x3f80bf22be793f6d,0xbf4e3f75beacbf0e,0xbf753f55bdc9bf35,0x3f46bf7b3ef13ec4,0x3f5cbf753edb3ec4,0xbf3e3f7fbf18be48
.quad 0x3f800000bf800000,0x3f800000bf800000,0xbf7dbdc93f800000,0xbf71be953f783e48,0x3f753e48bf7f0000,0x3f463f0ebf62bec4,0xbf67be953f7d0000,0xbf04bf463f3e3f0e
.quad 0x3f553ec4bf7b0000,0x3e483f6dbf0ebf35,0xbf3ebef13f780000,0x3e16bf7f3eac3f55,0x3f223f0ebf750000,0xbef13f7bbdc9bf6d,0xbf04bf223f710000,0x3f3ebf62be163f7b
.quad 0x3ec43f35bf6d0000,0xbf6d3f353ec4bf80,0xbe79bf463f670000,0x3f80bef1bf183f7b,0x3dc93f55bf620000,0xbf753e483f46bf6d,0x3d49bf623f5c0000,0x3f4e3dc9bf673f55
.quad 0xbe483f6dbf550000,0xbf0ebec43f7bbf35,0x3eacbf753f4e0000,0x3e793f22bf803f0e,0xbef13f7bbf460000,0x3dc9bf553f75bec4,0x3f18bf7f3f3e0000,0xbedb3f75bf5c3e48
.quad 0x3f800000bf800000,0x3f800000bf800000,0xbf5cbef13f673ec4,0xbf3ebf223f4e3f0e,0x3ef13f55bf22bf35,0x3dc93f7bbe95bf6d,0x3d49bf7f3e793f6d,0x3f18bf62beac3f7b
.quad 0xbf0e3f6d3e48bf80,0xbf7b3ec43f55bf35,0x3f67bf22bf183f6d,0x3f5c3e95bf803e48,0xbf7f3e483f62bf35,0xbe95bf553f463ec4,0x3f4e3e95bf803ec4,0xbedb3f7fbe79bf55
.quad 0xbec4bf353f6d0000,0x3f6dbf35bec43f80,0xbe163f75bf2cbec4,0xbf713dc93f5cbf55,0x3f22bf7b3e953f35,0x3ef13f0ebf7f3ec4,0xbf713f463e16bf6d,0x3e79bf753f3e3e48
.quad 0x3f7bbec4bf0e3f80,0xbf553f6dbe48bf35,0xbf3ebdc93f5cbf6d,0x3f7dbef1bedb3f7b,0x3e953f0ebf7f3f35,0xbf22be483f62bf6d,0x3e79bf623f71bec4,0xbd493f46bf7d3f0e
.quad 0x3f800000bf800000,0x3f800000bf800000,0xbf18bf463f2c3f35,0xbedbbf623f043f55,0xbe953f7b3dc9bf80,0xbf223f553ef1bf6d,0x3f71bef1bf4e3f35,0x3f783dc9bf803e48
.quad 0xbf55bec43f7b0000,0xbe48bf6d3f0e3f35,0x3d493f75bf04bf35,0xbf4e3f463edbbf7b,0x3f46bf55be953f80,0x3f623e48bf7f3ec4,0xbf783dc93f67bf35,0x3d49bf753f183f0e
.quad 0x3ec43f35bf6d0000,0xbf6d3f353ec4bf80,0x3f04bf7f3eac3f35,0x3f3e3e95bf7d3f0e,0xbf7f3f0e3ef1bf80,0x3e95bf7b3f223ec4,0x3f2c3e95bf783f35,0xbf7d3f223eacbf7b
.quad 0x3e48bf6d3f550000,0x3f0e3ec4bf7b3f35,0xbf673f62be16bf35,0x3f04bf7f3f2c3e48,0x3f62be48bf223f80,0xbf7f3f0e3e95bf6d,0xbe16bf223f80bf35,0x3eac3ef1bf783f55
.quad 0x3f800000bf800000,0x3f800000bf800000,0xbe79bf753eac3f6d,0xbd49bf7f3e163f7b,0xbf623f0e3f46bf35,0xbf7f3e483f75bec4,0x3f2c3f22bf5cbec4,0x3e163f75bedbbf55
.quad 0x3f0ebf6dbe483f80,0x3f7bbec4bf553f35,0xbf71bdc93f7dbec4,0xbe79bf623f2c3f0e,0xbdc93f7bbef1bf35,0xbf753f0e3f22bf6d,0x3f7dbef1bf2c3f6d,0x3eac3f46bf5cbe48
.quad 0xbec4bf353f6d0000,0x3f6dbf35bec43f80,0xbf4e3f623d49bf6d,0xbedbbf223f78be48,0x3f463e48bf753f35,0xbf623f553dc9bf6d,0x3edbbf7f3f183ec4,0x3f043ef1bf803f0e
.quad 0xbf7b3ec43f0ebf80,0x3f55bf6d3e483f35,0x3d493f46bf783ec4,0xbf18be953f71bf55,0x3f75bf553dc93f35,0xbf463f7bbef1bec4,0xbf04be953f67bf6d,0x3f2c3dc9bf4e3f7b
.quad 0x3f800000bf800000,0x3f800000bf800000,0x3e16bf7fbd493f80,0x3eacbf75be793f7b,0xbf75be483f7f0000,0xbf46bf0e3f623ec4,0xbedb3f753e16bf80,0xbf5c3f223f2cbf55
.quad 0x3f553ec4bf7b0000,0x3e483f6dbf0ebf35,0x3f2cbf62be793f80,0x3f7dbdc9bf713f0e,0xbf22bf0e3f750000,0x3ef1bf7b3dc93f6d,0xbf5c3f463eacbf80,0xbf2cbef13f7dbe48
.quad 0x3ec43f35bf6d0000,0xbf6d3f353ec4bf80,0x3f78bf22bedb3f80,0x3d493f62bf4ebe48,0xbdc9bf553f620000,0x3f75be48bf463f6d,0xbf803ef13f04bf80,0x3f18bf7f3edb3f0e
.quad 0xbe483f6dbf550000,0xbf0ebec43f7bbf35,0x3f71be95bf183f80,0xbf783f463d49bf55,0x3ef1bf7b3f460000,0xbdc93f55bf753ec4,0xbf4e3dc93f2cbf80,0x3f67be95bf043f7b
.quad 0x3f800000bf800000,0x3f800000bf800000,0x3f04bf62bedb3f6d,0x3f2cbf46bf183f55,0xbef1bf553f223f35,0xbdc9bf7b3e953f6d,0xbf803dc93f78bec4,0xbf4ebef13f713e48
.quad 0xbf0e3f6d3e48bf80,0xbf7b3ec43f55bf35,0x3edb3f46bf4ebec4,0xbf043f753d49bf7b,0x3f7fbe48bf623f35,0x3e953f55bf46bec4,0x3f18bf753d493f6d,0x3f673dc9bf783f0e
.quad 0xbec4bf353f6d0000,0x3f6dbf35bec43f80,0xbf7d3e953f3ebf6d,0x3eacbf7f3f043f0e,0xbf223f7bbe95bf35,0xbef1bf0e3f7fbec4,0x3eac3f22bf7d3ec4,0xbf783e953f2cbf7b
.quad 0x3f7bbec4bf0e3f80,0xbf553f6dbe48bf35,0x3f2cbf7f3f043ec4,0xbe163f62bf673e48,0xbe95bf0e3f7fbf35,0x3f223e48bf623f6d,0xbf783ef13eacbf6d,0x3f80bf22be163f55
.quad 0x3f800000bf800000,0x3f800000bf800000,0x3f4ebf22bf3e3f35,0x3f67bef1bf5c3f0e,0x3e95bf7bbdc93f80,0x3f22bf55bef13f6d,0xbeacbf623f183f35,0x3e79bf7f3d493f7b
.quad 0xbf55bec43f7b0000,0xbe48bf6d3f0e3f35,0xbf803e953f5cbf35,0xbf18bf223f673e48,0xbf463f553e95bf80,0xbf62be483f7fbec4,0xbe793f7fbedbbf35,0xbf803e953f4ebf55
.quad 0x3ec43f35bf6d0000,0xbf6d3f353ec4bf80,0x3f5c3dc9bf713f35,0xbf2c3f75be16bf55,0x3f7fbf0ebef13f80,0xbe953f7bbf22bec4,0x3f3ebf753e793f35,0x3e163f46bf713e48
.quad 0x3e48bf6d3f550000,0x3f0e3ec4bf7b3f35,0xbedbbef13f7dbf35,0x3f5cbdc9bf3e3f7b,0xbf623e483f22bf80,0x3f7fbf0ebe953f6d,0xbf7d3f46bd49bf35,0x3f71bf623e793f0e
.quad 0x3f800000bf800000,0x3f800000bf800000,0x3f78be95bf713ec4,0x3f80bdc9bf7d3e48,0x3f62bf0ebf463f35,0x3f7fbe48bf753ec4,0x3f3ebf46bf043f6d,0x3f7dbe95bf673f0e
.quad 0x3f0ebf6dbe483f80,0x3f7bbec4bf553f35,0x3eacbf7f3e163f6d,0x3f78bef1bf3e3f55,0x3dc9bf7b3ef13f35,0x3f75bf0ebf223f6d,0xbe16bf623f3e3ec4,0x3f71bf22bf043f7b
.quad 0xbec4bf353f6d0000,0x3f6dbf35bec43f80,0xbf18bef13f80bec4,0x3f67bf46be793f7b,0xbf46be483f75bf35,0x3f62bf55bdc93f6d,0xbf673dc93f4ebf6d,0x3f5cbf623d493f55
.quad 0xbf7b3ec43f0ebf80,0x3f55bf6d3e483f35,0xbf803f223e79bf6d,0x3f4ebf753eac3f0e,0xbf753f55bdc9bf35,0x3f46bf7b3ef13ec4,0xbf5c3f75bedbbec4,0x3f3ebf7f3f183e48
.quad 0x3f350000bf353f80,0xbf3500003f35bf80,0x3f183dc9bf3e3f80,0xbedbbe953f5cbf7b,0x3ef13e48bf463f80,0xbdc9bf0e3f75bf6d,0x3eac3e95bf4e3f80,0x3e79bf463f80bf55
.quad 0x3e483ec4bf553f80,0x3f0ebf6d3f7bbf35,0x3d493ef1bf5c3f80,0x3f4ebf7f3f67bf0e,0xbdc93f0ebf623f80,0x3f75bf7b3f46bec4,0xbe793f22bf673f80,0x3f80bf623f18be48
.quad 0xbec43f35bf6d3f80,0x3f6dbf353ec40000,0xbf043f46bf713f80,0x3f3ebef13e163e48,0xbf223f55bf753f80,0x3ef1be48bdc93ec4,0xbf3e3f62bf783f80,0x3e163dc9beac3f0e
.quad 0xbf553f6dbf7b3f80,0xbe483ec4bf0e3f35,0xbf673f75bf7d3f80,0xbf043f22bf3e3f55,0xbf753f7bbf7f3f80,0xbf463f55bf623f6d,0xbf7d3f7fbf803f80,0xbf713f75bf783f7b
.quad 0x3f350000bf353f80,0xbf3500003f35bf80,0x3e793ef1bf713f6d,0xbd49bf223f7dbf55,0xbe953f55bf7f3f35,0x3f22bf7b3f62bec4,0xbf3e3f7fbf5c3ec4,0x3f7dbf623edb3e48
.quad 0xbf7b3f6dbf0e0000,0x3f55bec4be483f35,0xbf713f22be16bec4,0x3e793e95bf3e3f7b,0xbf223e483e95bf35,0xbef13f55bf7f3f6d,0xbe16be953f2cbf6d,0xbf713f7fbf5c3f0e
.quad 0x3ec4bf353f6dbf80,0xbf6d3f35bec40000,0x3f4ebf753f80bf6d,0xbedb3dc93e79bf0e,0x3f7fbf7b3f62bf35,0x3e95bf0e3f46bf6d,0x3f67bf463f18bec4,0x3f5cbf753f80bf7b
.quad 0x3f0ebec43e480000,0x3f7bbf6d3f55bf35,0x3d493dc9be793ec4,0x3f18bef13eacbe48,0xbef13f0ebf223f35,0xbdc93e48be953ec4,0xbf5c3f62bf673f6d,0xbf3e3f46bf4e3f55
.quad 0x3f350000bf353f80,0xbf3500003f35bf80,0xbe163f46bf803f35,0x3eacbf623f78bf0e,0xbf623f7bbf220000,0x3f7fbf553e953ec4,0xbf673ef13e16bf35,0x3f043dc9bf2c3f7b
.quad 0xbe48bec43f55bf80,0xbf0e3f6dbf7b3f35,0x3f2cbf753f78bf35,0xbf7d3f46beacbe48,0x3f7fbf553ef10000,0xbe95be483f22bf6d,0x3f04bdc9beac3f35,0x3f3ebf753f7dbf55
.quad 0xbec43f35bf6d3f80,0x3f6dbf353ec40000,0xbf783f7fbf673f35,0x3d493e95bf183f55,0xbf463f0ebe950000,0xbf623f7bbf7f3f6d,0x3d49be953f04bf35,0xbf4e3f22bedb3e48
.quad 0x3f55bf6d3f7bbf80,0x3e48bec43f0ebf35,0x3f71bf623f4ebf35,0x3f78bf7f3f80bf7b,0x3e95be483dc90000,0x3f22bf0e3ef1bec4,0xbf183f22bf2c3f35,0xbedb3ef1bf043f0e
.quad 0x3f350000bf353f80,0xbf3500003f35bf80,0xbf043f75bf673ec4,0x3f2cbf7f3f4ebe48,0xbf753f0e3dc9bf35,0x3f46be48bef13f6d,0x3d49bf223f78bf6d,0xbf183f75bf713f0e
.quad 0x3f7bbf6d3f0e0000,0xbf553ec43e48bf35,0x3edb3dc9bf183f6d,0x3f04bf623f80bf55,0xbf463f7bbf753f35,0x3f62bf0e3dc93ec4,0xbf4e3ef1bd49bec4,0xbedb3f46bf783f7b
.quad 0x3ec4bf353f6dbf80,0xbf6d3f35bec40000,0x3f7dbf623f2cbec4,0x3eacbf223f5cbf7b,0x3dc93e48bef13f35,0x3f75bf553f22bec4,0xbf713f7fbf7d3f6d,0xbe793ef1bf2c3f55
.quad 0xbf0e3ec4be480000,0xbf7b3f6dbf553f35,0x3f2cbf463f5cbf6d,0x3e16be953edbbf0e,0x3f62bf553f46bf35,0x3f7fbf7b3f75bf6d,0xbe793e95beac3ec4,0xbd493dc9be163e48
.quad 0x3f350000bf353f80,0xbf3500003f35bf80,0xbf4e3f7fbf2c0000,0x3f67bf753f043e48,0xbef1be483f46bf80,0x3dc93f0ebf753f6d,0x3f71bf753f180000,0xbf783f22bd49bf0e
.quad 0x3e483ec4bf553f80,0x3f0ebf6d3f7bbf35,0xbf803f62bf040000,0x3f18bdc9bedb3f55,0x3dc9bf0e3f62bf80,0xbf753f7bbf463ec4,0x3f78bf463edb0000,0x3d49bef13f4ebf7b
.quad 0xbec43f35bf6d3f80,0x3f6dbf353ec40000,0xbf5c3f22beac0000,0xbf2c3f62bf7d3f7b,0x3f22bf553f75bf80,0xbef13e483dc9bec4,0x3f2cbef13e790000,0x3f7dbf7f3f71bf55
.quad 0xbf553f6dbf7b3f80,0xbe483ec4bf0e3f35,0xbedb3e95be160000,0xbf5c3f46bf2c3f0e,0x3f75bf7b3f7fbf80,0x3f46bf553f62bf6d,0x3e16bdc93d490000,0x3eacbe953e79be48
.quad 0x3f350000bf353f80,0xbf3500003f35bf80,0xbf783f62beacbec4,0x3f80bf463e163f0e,0x3e95bf553f7fbf35,0xbf223f7bbf623ec4,0x3f2cbdc9bf043f6d,0xbe16bef13f67bf7b
.quad 0xbf7b3f6dbf0e0000,0x3f55bec4be483f35,0x3eacbf463f7dbf6d,0xbf783f75bf2c3e48,0x3f22be48be953f35,0x3ef1bf553f7fbf6d,0xbf7d3f75bf3e3ec4,0x3eac3dc9bf043f55
.quad 0x3ec4bf353f6dbf80,0xbf6d3f35bec40000,0x3f18be95bd493ec4,0x3f67bf7f3f78bf55,0xbf7f3f7bbf623f35,0xbe953f0ebf463f6d,0x3edbbf223f4ebf6d,0xbf043e95bd49be48
.quad 0x3f0ebec43e480000,0x3f7bbf6d3f55bf35,0xbf803f7fbf783f6d,0xbf4e3f62bf713f7b,0x3ef1bf0e3f22bf35,0x3dc9be483e95bec4,0x3f04bef13edbbec4,0x3f2cbf223f18bf0e
.quad 0x3f350000bf353f80,0xbf3500003f35bf80,0xbf7d3f223d49bf35,0x3f71bef1be793f55,0x3f62bf7b3f220000,0xbf7f3f55be95bec4,0xbedb3f62bf7d3f35,0x3f5cbf7f3f3ebe48
.quad 0xbe48bec43f55bf80,0xbf0e3f6dbf7b3f35,0x3f3ebe95be793f35,0x3e16bf223f71bf7b,0xbf7f3f55bef10000,0x3e953e48bf223f6d,0x3f5cbf7f3f71bf35,0xbf2c3e953e16bf0e
.quad 0xbec43f35bf6d3f80,0x3f6dbf353ec40000,0xbe79bdc93edbbf35,0xbf803f75bf4e3f0e,0x3f46bf0e3e950000,0x3f62bf7b3f7fbf6d,0xbf803f75bf5c3f35,0xbf183f46bf673f7b
.quad 0x3f55bf6d3f7bbf80,0x3e48bec43f0ebf35,0xbeac3ef1bf183f35,0x3e79bdc9bd493e48,0xbe953e48bdc90000,0xbf223f0ebef13ec4,0x3f4ebf463f3ebf35,0x3f67bf623f5cbf55
.quad 0x3f350000bf353f80,0xbf3500003f35bf80,0xbf5c3e953edbbf6d,0x3f3ebdc9bf183f7b,0x3f75bf0ebdc93f35,0xbf463e483ef1bf6d,0xbf803f46be79bec4,0x3f4ebe95beac3f55
.quad 0x3f7bbf6d3f0e0000,0xbf553ec43e48bf35,0xbf673f7fbf4e3ec4,0x3f5cbef1bd493f0e,0x3f46bf7b3f75bf35,0xbf623f0ebdc9bec4,0xbf183f62bf803f6d,0x3f67bf223e793e48
.quad 0x3ec4bf353f6dbf80,0xbf6d3f35bec40000,0xbe163ef1bf3e3f6d,0x3f71bf463f04be48,0xbdc9be483ef1bf35,0xbf753f55bf223ec4,0x3eacbdc9be163ec4,0x3f78bf623f3ebf0e
.quad 0xbf0e3ec4be480000,0xbf7b3f6dbf553f35,0x3f3ebf223f04bec4,0x3f7dbf753f67bf55,0xbf623f55bf463f35,0xbf7f3f7bbf753f6d,0x3f78bf753f71bf6d,0x3f80bf7f3f7dbf7b
.quad 0x3f350000bf353f80,0xbf3500003f35bf80,0xbf18bdc93f3ebf80,0x3edb3e95bf5c3f7b,0x3ef13e48bf463f80,0xbdc9bf0e3f75bf6d,0xbeacbe953f4ebf80,0xbe793f46bf803f55
.quad 0x3e483ec4bf553f80,0x3f0ebf6d3f7bbf35,0xbd49bef13f5cbf80,0xbf4e3f7fbf673f0e,0xbdc93f0ebf623f80,0x3f75bf7b3f46bec4,0x3e79bf223f67bf80,0xbf803f62bf183e48
.quad 0xbec43f35bf6d3f80,0x3f6dbf353ec40000,0x3f04bf463f71bf80,0xbf3e3ef1be16be48,0xbf223f55bf753f80,0x3ef1be48bdc93ec4,0x3f3ebf623f78bf80,0xbe16bdc93eacbf0e
.quad 0xbf553f6dbf7b3f80,0xbe483ec4bf0e3f35,0x3f67bf753f7dbf80,0x3f04bf223f3ebf55,0xbf753f7bbf7f3f80,0xbf463f55bf623f6d,0x3f7dbf7f3f80bf80,0x3f71bf753f78bf7b
.quad 0x3f350000bf353f80,0xbf3500003f35bf80,0xbe79bef13f71bf6d,0x3d493f22bf7d3f55,0xbe953f55bf7f3f35,0x3f22bf7b3f62bec4,0x3f3ebf7f3f5cbec4,0xbf7d3f62bedbbe48
.quad 0xbf7b3f6dbf0e0000,0x3f55bec4be483f35,0x3f71bf223e163ec4,0xbe79be953f3ebf7b,0xbf223e483e95bf35,0xbef13f55bf7f3f6d,0x3e163e95bf2c3f6d,0x3f71bf7f3f5cbf0e
.quad 0x3ec4bf353f6dbf80,0xbf6d3f35bec40000,0xbf4e3f75bf803f6d,0x3edbbdc9be793f0e,0x3f7fbf7b3f62bf35,0x3e95bf0e3f46bf6d,0xbf673f46bf183ec4,0xbf5c3f75bf803f7b
.quad 0x3f0ebec43e480000,0x3f7bbf6d3f55bf35,0xbd49bdc93e79bec4,0xbf183ef1beac3e48,0xbef13f0ebf223f35,0xbdc93e48be953ec4,0x3f5cbf623f67bf6d,0x3f3ebf463f4ebf55
.quad 0x3f350000bf353f80,0xbf3500003f35bf80,0x3e16bf463f80bf35,0xbeac3f62bf783f0e,0xbf623f7bbf220000,0x3f7fbf553e953ec4,0x3f67bef1be163f35,0xbf04bdc93f2cbf7b
.quad 0xbe48bec43f55bf80,0xbf0e3f6dbf7b3f35,0xbf2c3f75bf783f35,0x3f7dbf463eac3e48,0x3f7fbf553ef10000,0xbe95be483f22bf6d,0xbf043dc93eacbf35,0xbf3e3f75bf7d3f55
.quad 0xbec43f35bf6d3f80,0x3f6dbf353ec40000,0x3f78bf7f3f67bf35,0xbd49be953f18bf55,0xbf463f0ebe950000,0xbf623f7bbf7f3f6d,0xbd493e95bf043f35,0x3f4ebf223edbbe48
.quad 0x3f55bf6d3f7bbf80,0x3e48bec43f0ebf35,0xbf713f62bf4e3f35,0xbf783f7fbf803f7b,0x3e95be483dc90000,0x3f22bf0e3ef1bec4,0x3f18bf223f2cbf35,0x3edbbef13f04bf0e
.quad 0x3f350000bf353f80,0xbf3500003f35bf80,0x3f04bf753f67bec4,0xbf2c3f7fbf4e3e48,0xbf753f0e3dc9bf35,0x3f46be48bef13f6d,0xbd493f22bf783f6d,0x3f18bf753f71bf0e
.quad 0x3f7bbf6d3f0e0000,0xbf553ec43e48bf35,0xbedbbdc93f18bf6d,0xbf043f62bf803f55,0xbf463f7bbf753f35,0x3f62bf0e3dc93ec4,0x3f4ebef13d493ec4,0x3edbbf463f78bf7b
.quad 0x3ec4bf353f6dbf80,0xbf6d3f35bec40000,0xbf7d3f62bf2c3ec4,0xbeac3f22bf5c3f7b,0x3dc93e48bef13f35,0x3f75bf553f22bec4,0x3f71bf7f3f7dbf6d,0x3e79bef13f2cbf55
.quad 0xbf0e3ec4be480000,0xbf7b3f6dbf553f35,0xbf2c3f46bf5c3f6d,0xbe163e95bedb3f0e,0x3f62bf553f46bf35,0x3f7fbf7b3f75bf6d,0x3e79be953eacbec4,0x3d49bdc93e16be48
.quad 0x3f350000bf353f80,0xbf3500003f35bf80,0x3f4ebf7f3f2c0000,0xbf673f75bf04be48,0xbef1be483f46bf80,0x3dc93f0ebf753f6d,0xbf713f75bf180000,0x3f78bf223d493f0e
.quad 0x3e483ec4bf553f80,0x3f0ebf6d3f7bbf35,0x3f80bf623f040000,0xbf183dc93edbbf55,0x3dc9bf0e3f62bf80,0xbf753f7bbf463ec4,0xbf783f46bedb0000,0xbd493ef1bf4e3f7b
.quad 0xbec43f35bf6d3f80,0x3f6dbf353ec40000,0x3f5cbf223eac0000,0x3f2cbf623f7dbf7b,0x3f22bf553f75bf80,0xbef13e483dc9bec4,0xbf2c3ef1be790000,0xbf7d3f7fbf713f55
.quad 0xbf553f6dbf7b3f80,0xbe483ec4bf0e3f35,0x3edbbe953e160000,0x3f5cbf463f2cbf0e,0x3f75bf7b3f7fbf80,0x3f46bf553f62bf6d,0xbe163dc9bd490000,0xbeac3e95be793e48
.quad 0x3f350000bf353f80,0xbf3500003f35bf80,0x3f78bf623eac3ec4,0xbf803f46be16bf0e,0x3e95bf553f7fbf35,0xbf223f7bbf623ec4,0xbf2c3dc93f04bf6d,0x3e163ef1bf673f7b
.quad 0xbf7b3f6dbf0e0000,0x3f55bec4be483f35,0xbeac3f46bf7d3f6d,0x3f78bf753f2cbe48,0x3f22be48be953f35,0x3ef1bf553f7fbf6d,0x3f7dbf753f3ebec4,0xbeacbdc93f04bf55
.quad 0x3ec4bf353f6dbf80,0xbf6d3f35bec40000,0xbf183e953d49bec4,0xbf673f7fbf783f55,0xbf7f3f7bbf623f35,0xbe953f0ebf463f6d,0xbedb3f22bf4e3f6d,0x3f04be953d493e48
.quad 0x3f0ebec43e480000,0x3f7bbf6d3f55bf35,0x3f80bf7f3f78bf6d,0x3f4ebf623f71bf7b,0x3ef1bf0e3f22bf35,0x3dc9be483e95bec4,0xbf043ef1bedb3ec4,0xbf2c3f22bf183f0e
.quad 0x3f350000bf353f80,0xbf3500003f35bf80,0x3f7dbf22bd493f35,0xbf713ef13e79bf55,0x3f62bf7b3f220000,0xbf7f3f55be95bec4,0x3edbbf623f7dbf35,0xbf5c3f7fbf3e3e48
.quad 0xbe48bec43f55bf80,0xbf0e3f6dbf7b3f35,0xbf3e3e953e79bf35,0xbe163f22bf713f7b,0xbf7f3f55bef10000,0x3e953e48bf223f6d,0xbf5c3f7fbf713f35,0x3f2cbe95be163f0e
.quad 0xbec43f35bf6d3f80,0x3f6dbf353ec40000,0x3e793dc9bedb3f35,0x3f80bf753f4ebf0e,0x3f46bf0e3e950000,0x3f62bf7b3f7fbf6d,0x3f80bf753f5cbf35,0x3f18bf463f67bf7b
.quad 0x3f55bf6d3f7bbf80,0x3e48bec43f0ebf35,0x3eacbef13f18bf35,0xbe793dc93d49be48,0xbe953e48bdc90000,0xbf223f0ebef13ec4,0xbf4e3f46bf3e3f35,0xbf673f62bf5c3f55
.quad 0x3f350000bf353f80,0xbf3500003f35bf80,0x3f5cbe95bedb3f6d,0xbf3e3dc93f18bf7b,0x3f75bf0ebdc93f35,0xbf463e483ef1bf6d,0x3f80bf463e793ec4,0xbf4e3e953eacbf55
.quad 0x3f7bbf6d3f0e0000,0xbf553ec43e48bf35,0x3f67bf7f3f4ebec4,0xbf5c3ef13d49bf0e,0x3f46bf7b3f75bf35,0xbf623f0ebdc9bec4,0x3f18bf623f80bf6d,0xbf673f22be79be48
.quad 0x3ec4bf353f6dbf80,0xbf6d3f35bec40000,0x3e16bef13f3ebf6d,0xbf713f46bf043e48,0xbdc9be483ef1bf35,0xbf753f55bf223ec4,0xbeac3dc93e16bec4,0xbf783f62bf3e3f0e
.quad 0xbf0e3ec4be480000,0xbf7b3f6dbf553f35,0xbf3e3f22bf043ec4,0xbf7d3f75bf673f55,0xbf623f55bf463f35,0xbf7f3f7bbf753f6d,0xbf783f75bf713f6d,0xbf803f7fbf7d3f7b
.quad 0xbf353f80bf350000,0x3f35bf803f350000,0xbf4e3f7fbf2c0000,0x3f67bf753f043e48,0xbf623f7bbf220000,0x3f7fbf553e953ec4,0xbf713f75bf180000,0x3f78bf223d493f0e
.quad 0xbf7b3f6dbf0e0000,0x3f55bec4be483f35,0xbf803f62bf040000,0x3f18bdc9bedb3f55,0xbf7f3f55bef10000,0x3e953e48bf223f6d,0xbf783f46bedb0000,0xbd493ef1bf4e3f7b
.quad 0xbf6d3f35bec40000,0xbec43f35bf6d3f80,0xbf5c3f22beac0000,0xbf2c3f62bf7d3f7b,0xbf463f0ebe950000,0xbf623f7bbf7f3f6d,0xbf2c3ef1be790000,0xbf7d3f7fbf713f55
.quad 0xbf0e3ec4be480000,0xbf7b3f6dbf553f35,0xbedb3e95be160000,0xbf5c3f46bf2c3f0e,0xbe953e48bdc90000,0xbf223f0ebef13ec4,0xbe163dc9bd490000,0xbeac3e95be793e48
.quad 0xbf353f80bf350000,0x3f35bf803f350000,0xbf783f62beacbec4,0x3f80bf463e163f0e,0xbf753f0e3dc9bf35,0x3f46be48bef13f6d,0xbf2c3dc93f04bf6d,0x3e163ef1bf673f7b
.quad 0xbe48bec43f55bf80,0xbf0e3f6dbf7b3f35,0x3eacbf463f7dbf6d,0xbf783f75bf2c3e48,0x3f46bf7b3f75bf35,0xbf623f0ebdc9bec4,0x3f7dbf753f3ebec4,0xbeacbdc93f04bf55
.quad 0x3f6dbf353ec40000,0x3ec4bf353f6dbf80,0x3f18be95bd493ec4,0x3f67bf7f3f78bf55,0x3dc93e48bef13f35,0x3f75bf553f22bec4,0xbedb3f22bf4e3f6d,0x3f04be953d493e48
.quad 0xbf553f6dbf7b3f80,0xbe483ec4bf0e3f35,0xbf803f7fbf783f6d,0xbf4e3f62bf713f7b,0xbf623f55bf463f35,0xbf7f3f7bbf753f6d,0xbf043ef1bedb3ec4,0xbf2c3f22bf183f0e
.quad 0xbf353f80bf350000,0x3f35bf803f350000,0xbf7d3f223d49bf35,0x3f71bef1be793f55,0xbef1be483f46bf80,0x3dc93f0ebf753f6d,0x3edbbf623f7dbf35,0xbf5c3f7fbf3e3e48
.quad 0x3f7bbf6d3f0e0000,0xbf553ec43e48bf35,0x3f3ebe95be793f35,0x3e16bf223f71bf7b,0xbdc93f0ebf623f80,0x3f75bf7b3f46bec4,0xbf5c3f7fbf713f35,0x3f2cbe95be163f0e
.quad 0xbf6d3f35bec40000,0xbec43f35bf6d3f80,0xbe79bdc93edbbf35,0xbf803f75bf4e3f0e,0x3f22bf553f75bf80,0xbef13e483dc9bec4,0x3f80bf753f5cbf35,0x3f18bf463f67bf7b
.quad 0x3f0ebec43e480000,0x3f7bbf6d3f55bf35,0xbeac3ef1bf183f35,0x3e79bdc9bd493e48,0xbf753f7bbf7f3f80,0xbf463f55bf623f6d,0xbf4e3f46bf3e3f35,0xbf673f62bf5c3f55
.quad 0xbf353f80bf350000,0x3f35bf803f350000,0xbf5c3e953edbbf6d,0x3f3ebdc9bf183f7b,0x3e95bf553f7fbf35,0xbf223f7bbf623ec4,0x3f80bf463e793ec4,0xbf4e3e953eacbf55
.quad 0x3e483ec4bf553f80,0x3f0ebf6d3f7bbf35,0xbf673f7fbf4e3ec4,0x3f5cbef1bd493f0e,0xbf223e483e95bf35,0xbef13f55bf7f3f6d,0x3f18bf623f80bf6d,0xbf673f22be79be48
.quad 0x3f6dbf353ec40000,0x3ec4bf353f6dbf80,0xbe163ef1bf3e3f6d,0x3f71bf463f04be48,0xbf7f3f7bbf623f35,0xbe953f0ebf463f6d,0xbeac3dc93e16bec4,0xbf783f62bf3e3f0e
.quad 0x3f55bf6d3f7bbf80,0x3e48bec43f0ebf35,0x3f3ebf223f04bec4,0x3f7dbf753f67bf55,0xbef13f0ebf223f35,0xbdc93e48be953ec4,0xbf783f75bf713f6d,0xbf803f7fbf7d3f7b
.quad 0xbf353f80bf350000,0x3f35bf803f350000,0xbf18bdc93f3ebf80,0x3edb3e95bf5c3f7b,0x3f62bf7b3f220000,0xbf7f3f55be95bec4,0x3eac3e95bf4e3f80,0x3e79bf463f80bf55
.quad 0xbf7b3f6dbf0e0000,0x3f55bec4be483f35,0xbd49bef13f5cbf80,0xbf4e3f7fbf673f0e,0x3f7fbf553ef10000,0xbe95be483f22bf6d,0xbe793f22bf673f80,0x3f80bf623f18be48
.quad 0xbf6d3f35bec40000,0xbec43f35bf6d3f80,0x3f04bf463f71bf80,0xbf3e3ef1be16be48,0x3f46bf0e3e950000,0x3f62bf7b3f7fbf6d,0xbf3e3f62bf783f80,0x3e163dc9beac3f0e
.quad 0xbf0e3ec4be480000,0xbf7b3f6dbf553f35,0x3f67bf753f7dbf80,0x3f04bf223f3ebf55,0x3e95be483dc90000,0x3f22bf0e3ef1bec4,0xbf7d3f7fbf803f80,0xbf713f75bf783f7b
.quad 0xbf353f80bf350000,0x3f35bf803f350000,0xbe79bef13f71bf6d,0x3d493f22bf7d3f55,0x3f75bf0ebdc93f35,0xbf463e483ef1bf6d,0xbf3e3f7fbf5c3ec4,0x3f7dbf623edb3e48
.quad 0xbe48bec43f55bf80,0xbf0e3f6dbf7b3f35,0x3f71bf223e163ec4,0xbe79be953f3ebf7b,0xbf463f7bbf753f35,0x3f62bf0e3dc93ec4,0xbe16be953f2cbf6d,0xbf713f7fbf5c3f0e
.quad 0x3f6dbf353ec40000,0x3ec4bf353f6dbf80,0xbf4e3f75bf803f6d,0x3edbbdc9be793f0e,0xbdc9be483ef1bf35,0xbf753f55bf223ec4,0x3f67bf463f18bec4,0x3f5cbf753f80bf7b
.quad 0xbf553f6dbf7b3f80,0xbe483ec4bf0e3f35,0xbd49bdc93e79bec4,0xbf183ef1beac3e48,0x3f62bf553f46bf35,0x3f7fbf7b3f75bf6d,0xbf5c3f62bf673f6d,0xbf3e3f46bf4e3f55
.quad 0xbf353f80bf350000,0x3f35bf803f350000,0x3e16bf463f80bf35,0xbeac3f62bf783f0e,0x3ef13e48bf463f80,0xbdc9bf0e3f75bf6d,0xbf673ef13e16bf35,0x3f043dc9bf2c3f7b
.quad 0x3f7bbf6d3f0e0000,0xbf553ec43e48bf35,0xbf2c3f75bf783f35,0x3f7dbf463eac3e48,0x3dc9bf0e3f62bf80,0xbf753f7bbf463ec4,0x3f04bdc9beac3f35,0x3f3ebf753f7dbf55
.quad 0xbf6d3f35bec40000,0xbec43f35bf6d3f80,0x3f78bf7f3f67bf35,0xbd49be953f18bf55,0xbf223f55bf753f80,0x3ef1be48bdc93ec4,0x3d49be953f04bf35,0xbf4e3f22bedb3e48
.quad 0x3f0ebec43e480000,0x3f7bbf6d3f55bf35,0xbf713f62bf4e3f35,0xbf783f7fbf803f7b,0x3f75bf7b3f7fbf80,0x3f46bf553f62bf6d,0xbf183f22bf2c3f35,0xbedb3ef1bf043f0e
.quad 0xbf353f80bf350000,0x3f35bf803f350000,0x3f04bf753f67bec4,0xbf2c3f7fbf4e3e48,0xbe953f55bf7f3f35,0x3f22bf7b3f62bec4,0x3d49bf223f78bf6d,0xbf183f75bf713f0e
.quad 0x3e483ec4bf553f80,0x3f0ebf6d3f7bbf35,0xbedbbdc93f18bf6d,0xbf043f62bf803f55,0x3f22be48be953f35,0x3ef1bf553f7fbf6d,0xbf4e3ef1bd49bec4,0xbedb3f46bf783f7b
.quad 0x3f6dbf353ec40000,0x3ec4bf353f6dbf80,0xbf7d3f62bf2c3ec4,0xbeac3f22bf5c3f7b,0x3f7fbf7b3f62bf35,0x3e95bf0e3f46bf6d,0xbf713f7fbf7d3f6d,0xbe793ef1bf2c3f55
.quad 0x3f55bf6d3f7bbf80,0x3e48bec43f0ebf35,0xbf2c3f46bf5c3f6d,0xbe163e95bedb3f0e,0x3ef1bf0e3f22bf35,0x3dc9be483e95bec4,0xbe793e95beac3ec4,0xbd493dc9be163e48
.quad 0xbf353f80bf350000,0x3f35bf803f350000,0x3f4ebf7f3f2c0000,0xbf673f75bf04be48,0xbf623f7bbf220000,0x3f7fbf553e953ec4,0x3f71bf753f180000,0xbf783f22bd49bf0e
.quad 0xbf7b3f6dbf0e0000,0x3f55bec4be483f35,0x3f80bf623f040000,0xbf183dc93edbbf55,0xbf7f3f55bef10000,0x3e953e48bf223f6d,0x3f78bf463edb0000,0x3d49bef13f4ebf7b
.quad 0xbf6d3f35bec40000,0xbec43f35bf6d3f80,0x3f5cbf223eac0000,0x3f2cbf623f7dbf7b,0xbf463f0ebe950000,0xbf623f7bbf7f3f6d,0x3f2cbef13e790000,0x3f7dbf7f3f71bf55
.quad 0xbf0e3ec4be480000,0xbf7b3f6dbf553f35,0x3edbbe953e160000,0x3f5cbf463f2cbf0e,0xbe953e48bdc90000,0xbf223f0ebef13ec4,0x3e16bdc93d490000,0x3eacbe953e79be48
.quad 0xbf353f80bf350000,0x3f35bf803f350000,0x3f78bf623eac3ec4,0xbf803f46be16bf0e,0xbf753f0e3dc9bf35,0x3f46be48bef13f6d,0x3f2cbdc9bf043f6d,0xbe16bef13f67bf7b
.quad 0xbe48bec43f55bf80,0xbf0e3f6dbf7b3f35,0xbeac3f46bf7d3f6d,0x3f78bf753f2cbe48,0x3f46bf7b3f75bf35,0xbf623f0ebdc9bec4,0xbf7d3f75bf3e3ec4,0x3eac3dc9bf043f55
.quad 0x3f6dbf353ec40000,0x3ec4bf353f6dbf80,0xbf183e953d49bec4,0xbf673f7fbf783f55,0x3dc93e48bef13f35,0x3f75bf553f22bec4,0x3edbbf223f4ebf6d,0xbf043e95bd49be48
.quad 0xbf553f6dbf7b3f80,0xbe483ec4bf0e3f35,0x3f80bf7f3f78bf6d,0x3f4ebf623f71bf7b,0xbf623f55bf463f35,0xbf7f3f7bbf753f6d,0x3f04bef13edbbec4,0x3f2cbf223f18bf0e
.quad 0xbf353f80bf350000,0x3f35bf803f350000,0x3f7dbf22bd493f35,0xbf713ef13e79bf55,0xbef1be483f46bf80,0x3dc93f0ebf753f6d,0xbedb3f62bf7d3f35,0x3f5cbf7f3f3ebe48
.quad 0x3f7bbf6d3f0e0000,0xbf553ec43e48bf35,0xbf3e3e953e79bf35,0xbe163f22bf713f7b,0xbdc93f0ebf623f80,0x3f75bf7b3f46bec4,0x3f5cbf7f3f71bf35,0xbf2c3e953e16bf0e
.quad 0xbf6d3f35bec40000,0xbec43f35bf6d3f80,0x3e793dc9bedb3f35,0x3f80bf753f4ebf0e,0x3f22bf553f75bf80,0xbef13e483dc9bec4,0xbf803f75bf5c3f35,0xbf183f46bf673f7b
.quad 0x3f0ebec43e480000,0x3f7bbf6d3f55bf35,0x3eacbef13f18bf35,0xbe793dc93d49be48,0xbf753f7bbf7f3f80,0xbf463f55bf623f6d,0x3f4ebf463f3ebf35,0x3f67bf623f5cbf55
.quad 0xbf353f80bf350000,0x3f35bf803f350000,0x3f5cbe95bedb3f6d,0xbf3e3dc93f18bf7b,0x3e95bf553f7fbf35,0xbf223f7bbf623ec4,0xbf803f46be79bec4,0x3f4ebe95beac3f55
.quad 0x3e483ec4bf553f80,0x3f0ebf6d3f7bbf35,0x3f67bf7f3f4ebec4,0xbf5c3ef13d49bf0e,0xbf223e483e95bf35,0xbef13f55bf7f3f6d,0xbf183f62bf803f6d,0x3f67bf223e793e48
.quad 0x3f6dbf353ec40000,0x3ec4bf353f6dbf80,0x3e16bef13f3ebf6d,0xbf713f46bf043e48,0xbf7f3f7bbf623f35,0xbe953f0ebf463f6d,0x3eacbdc9be163ec4,0x3f78bf623f3ebf0e
.quad 0x3f55bf6d3f7bbf80,0x3e48bec43f0ebf35,0xbf3e3f22bf043ec4,0xbf7d3f75bf673f55,0xbef13f0ebf223f35,0xbdc93e48be953ec4,0x3f78bf753f71bf6d,0x3f80bf7f3f7dbf7b
.quad 0xbf353f80bf350000,0x3f35bf803f350000,0x3f183dc9bf3e3f80,0xbedbbe953f5cbf7b,0x3f62bf7b3f220000,0xbf7f3f55be95bec4,0xbeacbe953f4ebf80,0xbe793f46bf803f55
.quad 0xbf7b3f6dbf0e0000,0x3f55bec4be483f35,0x3d493ef1bf5c3f80,0x3f4ebf7f3f67bf0e,0x3f7fbf553ef10000,0xbe95be483f22bf6d,0x3e79bf223f67bf80,0xbf803f62bf183e48
.quad 0xbf6d3f35bec40000,0xbec43f35bf6d3f80,0xbf043f46bf713f80,0x3f3ebef13e163e48,0x3f46bf0e3e950000,0x3f62bf7b3f7fbf6d,0x3f3ebf623f78bf80,0xbe16bdc93eacbf0e
.quad 0xbf0e3ec4be480000,0xbf7b3f6dbf553f35,0xbf673f75bf7d3f80,0xbf043f22bf3e3f55,0x3e95be483dc90000,0x3f22bf0e3ef1bec4,0x3f7dbf7f3f80bf80,0x3f71bf753f78bf7b
.quad 0xbf353f80bf350000,0x3f35bf803f350000,0x3e793ef1bf713f6d,0xbd49bf223f7dbf55,0x3f75bf0ebdc93f35,0xbf463e483ef1bf6d,0x3f3ebf7f3f5cbec4,0xbf7d3f62bedbbe48
.quad 0xbe48bec43f55bf80,0xbf0e3f6dbf7b3f35,0xbf713f22be16bec4,0x3e793e95bf3e3f7b,0xbf463f7bbf753f35,0x3f62bf0e3dc93ec4,0x3e163e95bf2c3f6d,0x3f71bf7f3f5cbf0e
.quad 0x3f6dbf353ec40000,0x3ec4bf353f6dbf80,0x3f4ebf753f80bf6d,0xbedb3dc93e79bf0e,0xbdc9be483ef1bf35,0xbf753f55bf223ec4,0xbf673f46bf183ec4,0xbf5c3f75bf803f7b
.quad 0xbf553f6dbf7b3f80,0xbe483ec4bf0e3f35,0x3d493dc9be793ec4,0x3f18bef13eacbe48,0x3f62bf553f46bf35,0x3f7fbf7b3f75bf6d,0x3f5cbf623f67bf6d,0x3f3ebf463f4ebf55
.quad 0xbf353f80bf350000,0x3f35bf803f350000,0xbe163f46bf803f35,0x3eacbf623f78bf0e,0x3ef13e48bf463f80,0xbdc9bf0e3f75bf6d,0x3f67bef1be163f35,0xbf04bdc93f2cbf7b
.quad 0x3f7bbf6d3f0e0000,0xbf553ec43e48bf35,0x3f2cbf753f78bf35,0xbf7d3f46beacbe48,0x3dc9bf0e3f62bf80,0xbf753f7bbf463ec4,0xbf043dc93eacbf35,0xbf3e3f75bf7d3f55
.quad 0xbf6d3f35bec40000,0xbec43f35bf6d3f80,0xbf783f7fbf673f35,0x3d493e95bf183f55,0xbf223f55bf753f80,0x3ef1be48bdc93ec4,0xbd493e95bf043f35,0x3f4ebf223edbbe48
.quad 0x3f0ebec43e480000,0x3f7bbf6d3f55bf35,0x3f71bf623f4ebf35,0x3f78bf7f3f80bf7b,0x3f75bf7b3f7fbf80,0x3f46bf553f62bf6d,0x3f18bf223f2cbf35,0x3edbbef13f04bf0e
.quad 0xbf353f80bf350000,0x3f35bf803f350000,0xbf043f75bf673ec4,0x3f2cbf7f3f4ebe48,0xbe953f55bf7f3f35,0x3f22bf7b3f62bec4,0xbd493f22bf783f6d,0x3f18bf753f71bf0e
.quad 0x3e483ec4bf553f80,0x3f0ebf6d3f7bbf35,0x3edb3dc9bf183f6d,0x3f04bf623f80bf55,0x3f22be48be953f35,0x3ef1bf553f7fbf6d,0x3f4ebef13d493ec4,0x3edbbf463f78bf7b
.quad 0x3f6dbf353ec40000,0x3ec4bf353f6dbf80,0x3f7dbf623f2cbec4,0x3eacbf223f5cbf7b,0x3f7fbf7b3f62bf35,0x3e95bf0e3f46bf6d,0x3f71bf7f3f7dbf6d,0x3e79bef13f2cbf55
.quad 0x3f55bf6d3f7bbf80,0x3e48bec43f0ebf35,0x3f2cbf463f5cbf6d,0x3e16be953edbbf0e,0x3ef1bf0e3f22bf35,0x3dc9be483e95bec4,0x3e79be953eacbec4,0x3d49bdc93e16be48
.quad 0x3f8000003f800000,0x3f8000003f800000,0x3f7ff35e3f7ffcd7,0x3f7fcd793f7fe394,0x3f7fcd793f7ff35e,0x3f7f35f93f7f8e56,0x3f7f8e563f7fe394,0x3f7e39bc3f7f0059
.quad 0x3f7f35f93f7fcd79,0x3f7cd9253f7e39bc,0x3f7ec46d3f7fb10f,0x3f7b14be3f7d3aac,0x3f7e39bc3f7f8e56,0x3f78ed3c3f7c0361,0x3f7d95f43f7f654e,0x3f7663773f7a9421
.quad 0x3f7cd9253f7f35f9,0x3f7378713f78ed3c,0x3f7c03613f7f0059,0x3f702d4f3f770f11,0x3f7b14be3f7ec46d,0x3f6c835e3f74fa0b,0x3f7a0d543f7e8238,0x3f687c123f72ae9e
.quad 0x3f78ed3c3f7e39bc,0x3f6419013f702d4f,0x3f77b4933f7deafa,0x3f5f5be63f6d76aa,0x3f7663773f7d95f4,0x3f5a46a03f6a8b4b,0x3f74fa0b3f7d3aac,0x3f54db313f676bd8
.quad 0x0,0x0,0x3ca0d6d63c20d8d2,0x3d20cee73cf13d4c,0x3d20cee73ca0d6d6,0x3da0af2a3d712283,0x3d7122833cf13d4c,0x3df0b7723db4b86a
.quad 0x3da0af2a3d20cee7,0x3e20305b3df0b772,0x3dc8bd363d48fb30,0x3e47c5c23e164083,0x3df0b7723d712283,0x3e6f0c4d3e3403f1,0x3e0c4cf73d8ca1f2,0x3e8afa3e3e519f65
.quad 0x3e20305b3da0af2a,0x3e9e377a3e6f0c4d,0x3e3403f13db4b86a,0x3eb136413e862210,0x3e47c5c23dc8bd36,0x3ec3ef153e94a031,0x3e5b73dc3ddcbd0d,0x3ed65a923ea2fd52
.quad 0x3e6f0c4d3df0b772,0x3ee871713eb13641,0x3e8146933e0255f4,0x3efa2c903ebf47d7,0x3e8afa3e3e0c4cf7,0x3f05c2773ecd2ef3,0x3e94a0313e164083,0x3f0e39da3edae880
.quad 0x3f800000bf800000,0x3f800000bf800000,0x3f7ff35e3f7ffcd7,0x3f7fcd793f7fe394,0x3f7fcd793f7ff35e,0x3f7f35f93f7f8e56,0x3f7f8e563f7fe394,0x3f7e39bc3f7f0059
.quad 0x3f7f35f93f7fcd79,0x3f7cd9253f7e39bc,0x3f7ec46d3f7fb10f,0x3f7b14be3f7d3aac,0x3f7e39bc3f7f8e56,0x3f78ed3c3f7c0361,0x3f7d95f43f7f654e,0x3f7663773f7a9421
.quad 0x3f7cd9253f7f35f9,0x3f7378713f78ed3c,0x3f7c03613f7f0059,0x3f702d4f3f770f11,0x3f7b14be3f7ec46d,0x3f6c835e3f74fa0b,0x3f7a0d543f7e8238,0x3f687c123f72ae9e
.quad 0x3f78ed3c3f7e39bc,0x3f6419013f702d4f,0x3f77b4933f7deafa,0x3f5f5be63f6d76aa,0x3f7663773f7d95f4,0x3f5a46a03f6a8b4b,0x3f74fa0b3f7d3aac,0x3f54db313f676bd8
.quad 0x3f00000000000000,0x0,0x3f8000003f800000,0x0,0x3f8000003f800000,0x0,0x3f8000003f800000,0x0
.quad 0x3f8000003f800000,0x0,0x3f8000003f800000,0x0,0x3f8000003f800000,0x0,0x3f8000003f800000,0x0
.quad 0x3f8000003f800000,0x0,0x3f8000003f800000,0x0,0x3f8000003f800000,0x0,0x3f8000003f800000,0x0
.quad 0x3f8000003f800000,0x0,0x3f8000003f800000,0x0,0x3f8000003f800000,0x0,0x3f8000003f800000,0x0
.quad 0x3f7378713f7cd925,0x3f4f1bbd3f641901,0x3f71decf3f7c7160,0x3f490a883f609384,0x3f702d4f3f7c0361,0x3f42a9f73f5cdc29,0x3f6e641a3f7b8f2a,0x3f3bfc8f3f58f3c4
.quad 0x3f6c835e3f7b14be,0x3f3504f33f54db31,0x3f6a8b4b3f7a9421,0x3f2dc5e33f50935b,0x3f687c123f7a0d54,0x3f26423a3f4c1d35,0x3f6655e73f79805c,0x3f1e7cf13f4779bc
.quad 0x3f6419013f78ed3c,0x3f1679183f42a9f7,0x3f61c5983f7853f8,0x3f0e39da3f3daef9,0x3f5f5be63f77b493,0x3f05c2773f3889dc,0x3f5cdc293f770f11,0x3efa2c903f333bc6
.quad 0x3f5a46a03f766377,0x3ee871713f2dc5e3,0x3f579b8c3f75b1c9,0x3ed65a923f28296a,0x3f54db313f74fa0b,0x3ec3ef153f226799,0x3f5205d43f743c41,0x3eb136413f1c81b9
.quad 0x3e9e377a3e20305b,0x3f1679183ee87171,0x3ea7bf253e2a1c3f,0x3f1e7cf13ef5c6c5,0x3eb136413e3403f1,0x3f26423a3f0172c3,0x3eba9be13e3de731,0x3f2dc5e33f07e565
.quad 0x3ec3ef153e47c5c2,0x3f3504f33f0e39da,0x3ecd2ef33e519f65,0x3f3bfc8f3f146eba,0x3ed65a923e5b73dc,0x3f42a9f73f1a82a4,0x3edf71083e6542e9,0x3f490a883f207440
.quad 0x3ee871713e6f0c4d,0x3f4f1bbd3f26423a,0x3ef15aea3e78cfcc,0x3f54db313f2beb4a,0x3efa2c903e814693,0x3f5a46a03f316e2c,0x3f0172c33e862210,0x3f5f5be63f36c9a9
.quad 0x3f05c2773e8afa3e,0x3f6419013f3bfc8f,0x3f0a04f83e8fcefe,0x3f687c123f4105b8,0x3f0e39da3e94a031,0x3f6c835e3f45e403,0x3f1260b23e996dba,0x3f702d4f3f4a965e
.quad 0x3f7378713f7cd925,0x3f4f1bbd3f641901,0x3f71decf3f7c7160,0x3f490a883f609384,0x3f702d4f3f7c0361,0x3f42a9f73f5cdc29,0x3f6e641a3f7b8f2a,0x3f3bfc8f3f58f3c4
.quad 0x3f6c835e3f7b14be,0x3f3504f33f54db31,0x3f6a8b4b3f7a9421,0x3f2dc5e33f50935b,0x3f687c123f7a0d54,0x3f26423a3f4c1d35,0x3f6655e73f79805c,0x3f1e7cf13f4779bc
.quad 0x3f6419013f78ed3c,0x3f1679183f42a9f7,0x3f61c5983f7853f8,0x3f0e39da3f3daef9,0x3f5f5be63f77b493,0x3f05c2773f3889dc,0x3f5cdc293f770f11,0x3efa2c903f333bc6
.quad 0x3f5a46a03f766377,0x3ee871713f2dc5e3,0x3f579b8c3f75b1c9,0x3ed65a923f28296a,0x3f54db313f74fa0b,0x3ec3ef153f226799,0x3f5205d43f743c41,0x3eb136413f1c81b9
.quad 0x3f8000003f800000,0x0,0x3f8000003f800000,0x0,0x3f8000003f800000,0x0,0x3f8000003f800000,0x0
.quad 0x3f8000003f800000,0x0,0x3f8000003f800000,0x0,0x3f8000003f800000,0x0,0x3f8000003f800000,0x0
.quad 0x3f8000003f800000,0x0,0x3f8000003f800000,0x0,0x3f8000003f800000,0x0,0x3f8000003f800000,0x0
.quad 0x3f8000003f800000,0x0,0x3f8000003f800000,0x0,0x3f8000003f800000,0x0,0x3f8000003f800000,0x0
.quad 0x3f4f1bbd3f737871,0x3e9e377a3f167918,0x3f4c1d353f72ae9e,0x3e8afa3e3f104f0e,0x3f490a883f71decf,0x3e6f0c4d3f0a04f8,0x3f45e4033f710908,0x3e47c5c23f039c3d
.quad 0x3f42a9f73f702d4f,0x3e20305b3efa2c90,0x3f3f5cb53f6f4ba8,0x3df0b7723eece91a,0x3f3bfc8f3f6e641a,0x3da0af2a3edf7108,0x3f3889dc3f6d76aa,0x3d20cee73ed1c759
.quad 0x3f3504f33f6c835e,0x248d31323ec3ef15,0x3f316e2c3f6b8a3d,0xbd20cee73eb5eb4f,0x3f2dc5e33f6a8b4b,0xbda0af2a3ea7bf25,0x3f2a0c733f698690,0xbdf0b7723e996dba
.quad 0x3f26423a3f687c12,0xbe20305b3e8afa3e,0x3f2267993f676bd8,0xbe47c5c23e78cfcc,0x3f1e7cf13f6655e7,0xbe6f0c4d3e5b73dc,0x3f1a82a43f653a48,0xbe8afa3e3e3de731
.quad 0x3f1679183e9e377a,0x3f7378713f4f1bbd,0x3f1a82a43ea2fd52,0x3f7663773f53731f,0x3f1e7cf13ea7bf25,0x3f78ed3c3f579b8c,0x3f2267993eac7cd4,0x3f7b14be3f5b941a
.quad 0x3f26423a3eb13641,0x3f7cd9253f5f5be6,0x3f2a0c733eb5eb4f,0x3f7e39bc3f62f219,0x3f2dc5e33eba9be1,0x3f7f35f93f6655e7,0x3f316e2c3ebf47d7,0x3f7fcd793f698690
.quad 0x3f3504f33ec3ef15,0x3f8000003f6c835e,0x3f3889dc3ec8917e,0x3f7fcd793f6f4ba8,0x3f3bfc8f3ecd2ef3,0x3f7f35f93f71decf,0x3f3f5cb53ed1c759,0x3f7e39bc3f743c41
.quad 0x3f42a9f73ed65a92,0x3f7cd9253f766377,0x3f45e4033edae880,0x3f7b14be3f7853f8,0x3f490a883edf7108,0x3f78ed3c3f7a0d54,0x3f4c1d353ee3f40d,0x3f7663773f7b8f2a
.quad 0x3f4f1bbd3f737871,0x3e9e377a3f167918,0x3f4c1d353f72ae9e,0x3e8afa3e3f104f0e,0x3f490a883f71decf,0x3e6f0c4d3f0a04f8,0x3f45e4033f710908,0x3e47c5c23f039c3d
.quad 0x3f42a9f73f702d4f,0x3e20305b3efa2c90,0x3f3f5cb53f6f4ba8,0x3df0b7723eece91a,0x3f3bfc8f3f6e641a,0x3da0af2a3edf7108,0x3f3889dc3f6d76aa,0x3d20cee73ed1c759
.quad 0x3f3504f33f6c835e,0x248d31323ec3ef15,0x3f316e2c3f6b8a3d,0xbd20cee73eb5eb4f,0x3f2dc5e33f6a8b4b,0xbda0af2a3ea7bf25,0x3f2a0c733f698690,0xbdf0b7723e996dba
.quad 0x3f26423a3f687c12,0xbe20305b3e8afa3e,0x3f2267993f676bd8,0xbe47c5c23e78cfcc,0x3f1e7cf13f6655e7,0xbe6f0c4d3e5b73dc,0x3f1a82a43f653a48,0xbe8afa3e3e3de731
.quad 0x3f8000003f800000,0x0,0x3f8000003f800000,0x0,0x3f8000003f800000,0x0,0x3f8000003f800000,0x0
.quad 0x3f8000003f800000,0x0,0x3f8000003f800000,0x0,0x3f8000003f800000,0x0,0x3f8000003f800000,0x0
.quad 0x3f8000003f800000,0x0,0x3f8000003f800000,0x0,0x3f8000003f800000,0x0,0x3f8000003f800000,0x0
.quad 0x3f8000003f800000,0x0,0x3f8000003f800000,0x0,0x3f8000003f800000,0x0,0x3f8000003f800000,0x0
.quad 0x3f1679183f641901,0xbe9e377a3e20305b,0x3f1260b23f62f219,0xbeb136413e0255f4,0x3f0e39da3f61c598,0xbec3ef153dc8bd36,0x3f0a04f83f609384,0xbed65a923d8ca1f2
.quad 0x3f05c2773f5f5be6,0xbee871713d20cee7,0x3f0172c33f5e1ec5,0xbefa2c903c20d8d2,0x3efa2c903f5cdc29,0xbf05c277bca0d6d6,0x3ef15aea3f5b941a,0xbf0e39dabd48fb30
.quad 0x3ee871713f5a46a0,0xbf167918bda0af2a,0x3edf71083f58f3c4,0xbf1e7cf1bddcbd0d,0x3ed65a923f579b8c,0xbf26423abe0c4cf7,0x3ecd2ef33f563e03,0xbf2dc5e3be2a1c3f
.quad 0x3ec3ef153f54db31,0xbf3504f3be47c5c2,0x3eba9be13f53731f,0xbf3bfc8fbe6542e9,0x3eb136413f5205d4,0xbf42a9f7be814693,0x3ea7bf253f50935b,0xbf490a88be8fcefe
.quad 0x3f4f1bbd3ee87171,0x3f7378713f7cd925,0x3f5205d43eece91a,0x3f702d4f3f7deafa,0x3f54db313ef15aea,0x3f6c835e3f7ec46d,0x3f579b8c3ef5c6c5,0x3f687c123f7f654e
.quad 0x3f5a46a03efa2c90,0x3f6419013f7fcd79,0x3f5cdc293efe8c2f,0x3f5f5be63f7ffcd7,0x3f5f5be63f0172c3,0x3f5a46a03f7ff35e,0x3f61c5983f039c3d,0x3f54db313f7fb10f
.quad 0x3f6419013f05c277,0x3f4f1bbd3f7f35f9,0x3f6655e73f07e565,0x3f490a883f7e8238,0x3f687c123f0a04f8,0x3f42a9f73f7d95f4,0x3f6a8b4b3f0c2124,0x3f3bfc8f3f7c7160
.quad 0x3f6c835e3f0e39da,0x3f3504f33f7b14be,0x3f6e641a3f104f0e,0x3f2dc5e33f79805c,0x3f702d4f3f1260b2,0x3f26423a3f77b493,0x3f71decf3f146eba,0x3f1e7cf13f75b1c9
.quad 0x3f1679183f641901,0xbe9e377a3e20305b,0x3f1260b23f62f219,0xbeb136413e0255f4,0x3f0e39da3f61c598,0xbec3ef153dc8bd36,0x3f0a04f83f609384,0xbed65a923d8ca1f2
.quad 0x3f05c2773f5f5be6,0xbee871713d20cee7,0x3f0172c33f5e1ec5,0xbefa2c903c20d8d2,0x3efa2c903f5cdc29,0xbf05c277bca0d6d6,0x3ef15aea3f5b941a,0xbf0e39dabd48fb30
.quad 0x3ee871713f5a46a0,0xbf167918bda0af2a,0x3edf71083f58f3c4,0xbf1e7cf1bddcbd0d,0x3ed65a923f579b8c,0xbf26423abe0c4cf7,0x3ecd2ef33f563e03,0xbf2dc5e3be2a1c3f
.quad 0x3ec3ef153f54db31,0xbf3504f3be47c5c2,0x3eba9be13f53731f,0xbf3bfc8fbe6542e9,0x3eb136413f5205d4,0xbf42a9f7be814693,0x3ea7bf253f50935b,0xbf490a88be8fcefe
.quad 0x3f8000003f800000,0x0,0x3f8000003f800000,0x0,0x3f8000003f800000,0x0,0x3f8000003f800000,0x0
.quad 0x3f8000003f800000,0x0,0x3f8000003f800000,0x0,0x3f8000003f800000,0x0,0x3f8000003f800000,0x0
.quad 0x3f8000003f800000,0x0,0x3f8000003f800000,0x0,0x3f8000003f800000,0x0,0x3f8000003f800000,0x0
.quad 0x3f8000003f800000,0x0,0x3f8000003f800000,0x0,0x3f8000003f800000,0x0,0x3f8000003f800000,0x0
.quad 0x2188000000000,0x68c20000473a0,0x2189000000010,0x68c30000473b0,0x218a000000020,0x68c40000473c0,0x218b000000030,0x68c50000473d0
.quad 0x218c000000040,0x6cf00000473e0,0x218d000000050,0x6cf10000473f0,0x25b8000000060,0x6cf2000047400,0x25b9000000070,0x6cf3000047410
.quad 0x25ba000000080,0x6cf4000047420,0x25bb000000090,0x6cf5000047430,0x25bc0000000a0,0x6cf6000047440,0x25bd0000000b0,0x6cf7000047450
.quad 0x25be0000000c0,0x6cf800004b700,0x25bf0000000d0,0x6cf900004b710,0x25c0000004380,0x6cfa00004b720,0x25c1000004390,0x6cfb00004b730
.quad 0x25c20000043a0,0x6cfc00004b740,0x25c30000043b0,0x6cfd00004b750,0x25c40000043c0,0x712800004b760,0x25c50000043d0,0x712900004b770
.quad 0x29f00000043e0,0x712a00004b780,0x29f10000043f0,0x712b00004b790,0x29f2000004400,0x712c00004b7a0,0x29f3000004410,0x712d00004b7b0
.quad 0x29f4000004420,0x712e00004b7c0,0x29f5000004430,0x712f00004b7d0,0x29f6000004440,0x713000004fa80,0x29f7000004450,0x713100004fa90
.quad 0x29f8000008700,0x713200004faa0,0x29f9000008710,0x713300004fab0,0x29fa000008720,0x713400004fac0,0x29fb000008730,0x713500004fad0
.quad 0x29fc000008740,0x102000004fae0,0x29fd000008750,0x102100004faf0,0x2e28000008760,0x102200004fb00,0x2e29000008770,0x102300004fb10
.quad 0x2e2a000008780,0x102400004fb20,0x2e2b000008790,0x102500004fb30,0x2e2c0000087a0,0x102600004fb40,0x2e2d0000087b0,0x102700004fb50
.quad 0x2e2e0000087c0,0x1028000064c00,0x2e2f0000087d0,0x1029000064c10,0x2e3000000ca80,0x102a000064c20,0x2e3100000ca90,0x102b000064c30
.quad 0x2e3200000caa0,0x102c000064c40,0x2e3300000cab0,0x102d000064c50,0x2e3400000cac0,0x1458000064c60,0x2e3500000cad0,0x1459000064c70
.quad 0x434000000cae0,0x145a000064c80,0x434100000caf0,0x145b000064c90,0x434200000cb00,0x145c000064ca0,0x434300000cb10,0x145d000064cb0
.quad 0x434400000cb20,0x145e000064cc0,0x434500000cb30,0x145f000064cd0,0x434600000cb40,0x1460000068f80,0x434700000cb50,0x1461000068f90
.quad 0x4348000021c00,0x1462000068fa0,0x4349000021c10,0x1463000068fb0,0x434a000021c20,0x1464000068fc0,0x434b000021c30,0x1465000068fd0
.quad 0x434c000021c40,0x1890000068fe0,0x434d000021c50,0x1891000068ff0,0x4778000021c60,0x1892000069000,0x4779000021c70,0x1893000069010
.quad 0x3adc000019540,0x608e0,0x3add000019550,0x608f0,0x3f08000019560,0x60900,0x3f09000019570,0x60910
.quad 0x3f0a000019580,0x60920,0x3f0b000019590,0x60930,0x3f0c0000195a0,0x60940,0x3f0d0000195b0,0x60950
.quad 0x3f0e0000195c0,0x75a00,0x3f0f0000195d0,0x75a10,0x3f1000001d880,0x75a20,0x3f1100001d890,0x75a30
.quad 0x3f1200001d8a0,0x75a40,0x3f1300001d8b0,0x75a50,0x3f1400001d8c0,0x75a60,0x3f1500001d8d0,0x75a70
.quad 0x542000001d8e0,0x75a80,0x542100001d8f0,0x75a90,0x542200001d900,0x75aa0,0x542300001d910,0x75ab0
.quad 0x542400001d920,0x75ac0,0x542500001d930,0x75ad0,0x542600001d940,0x79d80,0x542700001d950,0x79d90
.quad 0x5428000032a00,0x79da0,0x5429000032a10,0x79db0,0x542a000032a20,0x79dc0,0x542b000032a30,0x79dd0
.quad 0x542c000032a40,0x79de0,0x542d000032a50,0x79df0,0x5858000032a60,0x79e00,0x5859000032a70,0x79e10
.quad 0x585a000032a80,0x79e20,0x585b000032a90,0x79e30,0x585c000032aa0,0x79e40,0x585d000032ab0,0x79e50
.quad 0x585e000032ac0,0x7e100,0x585f000032ad0,0x7e110,0x5860000036d80,0x7e120,0x5861000036d90,0x7e130
.quad 0x5862000036da0,0x7e140,0x5863000036db0,0x7e150,0x5864000036dc0,0x7e160,0x5865000036dd0,0x7e170
.quad 0x5c90000036de0,0x7e180,0x5c91000036df0,0x7e190,0x5c92000036e00,0x7e1a0,0x5c93000036e10,0x7e1b0
.quad 0x5c94000036e20,0x7e1c0,0x5c95000036e30,0x7e1d0,0x5c96000036e40,0x82480,0x5c97000036e50,0x82490
.quad 0x5c9800003b100,0x824a0,0x5c9900003b110,0x824b0,0x5c9a00003b120,0x824c0,0x5c9b00003b130,0x824d0
.quad 0x5c9c00003b140,0x824e0,0x5c9d00003b150,0x824f0,0x60c800003b160,0x82500,0x60c900003b170,0x82510
.quad 0x60ca00003b180,0x82520,0x60cb00003b190,0x82530,0x60cc00003b1a0,0x82540,0x60cd00003b1b0,0x82550
.quad 0x3f803f803f80,0x3f8000003f80,0xbd493f80bf803f80,0xbe163f7dbdc93f7f,0xbdc93f7f3f803f80,0xbe953f75be483f7b,0xbe163f7dbf803f80,0xbedb3f67be953f75
.quad 0xbec43f6d3f803f80,0xbf6d3ec4bf353f35,0xbedb3f67bf803f80,0xbf783e79bf463f22,0xbef13f623f803f80,0xbf7f3dc9bf553f0e,0xbf043f5cbf803f80,0xbf80bd49bf623ef1
.quad 0xbf353f353f803f80,0xbf35bf35bf800000,0xbf3e3f2cbf803f80,0xbf18bf4ebf7fbdc9,0xbf463f223f803f80,0xbef1bf62bf7bbe48,0xbf4e3f18bf803f80,0xbeacbf71bf75be95
.quad 0xbf6d3ec43f803f80,0x3ec4bf6dbf35bf35,0xbf713eacbf803f80,0x3f04bf5cbf22bf46,0xbf753e953f803f80,0x3f22bf46bf0ebf55,0xbf783e79bf803f80,0x3f3ebf2cbef1bf62
.quad 0x3f8000003f80,0x3f8000003f80,0xbe793f78be483f7b,0xbeac3f71be953f75,0xbef13f62bec43f6d,0xbf223f46bf0e3f55,0xbf2c3f3ebf0e3f55,0xbf5c3f04bf463f22
.quad 0xbf6dbec4bf800000,0xbec4bf6dbf35bf35,0xbf4ebf18bf7bbe48,0xbd49bf80bef1bf62,0xbf22bf46bf6dbec4,0x3e95bf75be48bf7b,0xbedbbf67bf55bf0e,0x3f18bf4e3dc9bf7f
.quad 0x3f35bf350000bf80,0x3f353f353f800000,0x3f5cbf043e48bf7b,0x3edb3f673f753e95,0x3f75be953ec4bf6d,0x3dc93f7f3f553f0e,0x3f80bd493f0ebf55,0xbe793f783f223f46
.quad 0x3ec43f6d3f800000,0xbf6dbec4bf353f35,0x3e163f7d3f7b3e48,0xbf3ebf2cbf623ef1,0xbdc93f7f3f6d3ec4,0xbef1bf62bf7b3e48,0xbeac3f713f553f0e,0xbe16bf7dbf7fbdc9
.quad 0x3f8000003f80,0x3f8000003f80,0xbedb3f67bec43f6d,0xbf043f5cbef13f62,0xbf463f22bf353f35,0xbf623ef1bf553f0e,0xbf783e79bf6d3ec4,0xbf80bd49bf7f3dc9
.quad 0x3ec4bf6d0000bf80,0x3f6dbec43f35bf35,0x3f3ebf2c3ec4bf6d,0x3f7d3e163f75be95,0x3f75be953f35bf35,0x3f463f223f7b3e48,0x3f7d3e163f6dbec4,0x3eac3f713f463f22
.quad 0xbf353f3500003f80,0xbf35bf35bf800000,0xbf713eacbec43f6d,0xbe79bf78bf62bef1,0xbf7fbdc9bf353f35,0x3e95bf75bf0ebf55,0xbf5cbf04bf6d3ec4,0x3f3ebf2cbdc9bf7f
.quad 0x3f6dbec40000bf80,0xbec43f6d3f353f35,0x3f803d493ec4bf6d,0xbf4e3f183e953f75,0x3f623ef13f35bf35,0xbf7f3dc9be483f7b,0x3f183f4e3f6dbec4,0xbf67bedbbf223f46
.quad 0x3f8000003f80,0x3f8000003f80,0xbf183f4ebf0e3f55,0xbf2c3f3ebf223f46,0xbf753e95bf6d3ec4,0xbf7f3dc9bf7b3e48,0xbf71beacbf7bbe48,0xbf4ebf18bf62bef1
.quad 0x3f6d3ec43f800000,0x3ec43f6d3f353f35,0x3f043f5c3f553f0e,0xbeac3f713dc93f7f,0xbdc93f7f3ec43f6d,0xbf623ef1bf0e3f55,0xbf2c3f3ebe483f7b,0xbf78be79bf753e95
.quad 0x3f35bf350000bf80,0x3f353f353f800000,0x3f7dbe163f0ebf55,0x3d493f803f463f22,0x3f623ef13f6dbec4,0xbf223f463e483f7b,0x3edb3f673f7b3e48,0xbf7d3e16bef13f62
.quad 0xbec4bf6dbf800000,0x3f6d3ec43f35bf35,0x3e79bf78bf55bf0e,0x3edb3f673f7fbdc9,0x3f46bf22bec4bf6d,0xbe953f753f553f0e,0x3f80bd493e48bf7b,0xbf5c3f043e953f75
.quad 0x3f8000003f80,0x3f8000003f80,0xbf3e3f2cbf353f35,0xbf4e3f18bf463f22,0xbf7fbdc9bf800000,0xbf75be95bf7bbe48,0xbf18bf4ebf35bf35,0xbeacbf71bef1bf62
.quad 0xbec43f6d00003f80,0xbf6d3ec4bf353f35,0xbf713eacbf353f35,0xbf5cbf04bf7fbdc9,0xbf62bef1bf800000,0xbdc9bf7fbf0ebf55,0xbe79bf78bf35bf35,0x3f3ebf2c3e95bf75
.quad 0xbf353f3500003f80,0xbf35bf35bf800000,0xbf80bd49bf353f35,0x3e16bf7dbf22bf46,0xbf22bf46bf800000,0x3f62bef13e48bf7b,0x3e16bf7dbf35bf35,0x3f673edb3f62bef1
.quad 0xbf6d3ec400003f80,0x3ec4bf6dbf35bf35,0xbf67bedbbf353f35,0x3f78be793dc9bf7f,0xbe95bf75bf800000,0x3f463f223f55bf0e,0x3f04bf5cbf35bf35,0xbd493f803f753e95
.quad 0x3f8000003f80,0x3f8000003f80,0xbf5c3f04bf553f0e,0xbf673edbbf623ef1,0xbf62bef1bf6dbec4,0xbf46bf22bf55bf0e,0xbd49bf80be48bf7b,0x3e79bf783dc9bf7f
.quad 0xbf6dbec4bf800000,0xbec4bf6dbf35bf35,0xbe16bf7dbf0ebf55,0x3f2cbf3e3e95bf75,0x3f46bf223ec4bf6d,0x3f753e953f7bbe48,0x3f713eac3f7bbe48,0x3e163f7d3f223f46
.quad 0x3f35bf350000bf80,0x3f353f353f800000,0x3f783e793f55bf0e,0xbeac3f713ef13f62,0x3e953f753f6d3ec4,0xbf7f3dc9bf0e3f55,0xbf2c3f3e3e483f7b,0xbf04bf5cbf7fbdc9
.quad 0x3ec43f6d3f800000,0xbf6dbec4bf353f35,0xbf183f4e3f0e3f55,0xbd49bf80bf75be95,0xbf7fbdc9bec43f6d,0x3f62bef1be48bf7b,0xbedbbf67bf7b3e48,0x3f4e3f183f46bf22
.quad 0x3f8000003f80,0x3f8000003f80,0xbf713eacbf6d3ec4,0xbf783e79bf753e95,0xbf22bf46bf35bf35,0xbef1bf62bf0ebf55,0x3f04bf5c3ec4bf6d,0x3f3ebf2c3f22bf46
.quad 0x3ec4bf6d0000bf80,0x3f6dbec43f35bf35,0x3f803d493f6dbec4,0x3f183f4e3f623ef1,0x3e953f753f353f35,0xbf223f46be483f7b,0xbf4e3f18bec43f6d,0xbf67bedbbf7f3dc9
.quad 0xbf353f3500003f80,0xbf35bf35bf800000,0xbf67bedbbf6d3ec4,0x3f04bf5cbe95bf75,0x3dc9bf7fbf35bf35,0x3f753e953f55bf0e,0x3f78be793ec4bf6d,0xbd493f803f463f22
.quad 0x3f6dbec40000bf80,0xbec43f6d3f353f35,0x3f2c3f3e3f6dbec4,0xbf7dbe16bef13f62,0xbef13f623f353f35,0xbdc9bf7fbf7bbe48,0xbf7dbe16bec43f6d,0x3f71beacbdc9bf7f
.quad 0x3f8000003f80,0x3f8000003f80,0xbf7d3e16bf7b3e48,0xbf803d49bf7f3dc9,0xbe95bf75bec4bf6d,0xbdc9bf7fbe48bf7b,0x3f67bedb3f55bf0e,0x3f7dbe163f75be95
.quad 0x3f6d3ec43f800000,0x3ec43f6d3f353f35,0xbe793f783e483f7b,0xbf673edbbf223f46,0xbf7fbdc9bf6d3ec4,0xbef1bf62bf55bf0e,0xbd49bf80bf0ebf55,0x3f5cbf043ef1bf62
.quad 0x3f35bf350000bf80,0x3f353f353f800000,0x3f4e3f183f7bbe48,0xbf2c3f3e3dc93f7f,0xbef13f623ec43f6d,0xbf46bf22bf7b3e48,0xbf71beacbf553f0e,0x3f18bf4ebe95bf75
.quad 0xbec4bf6dbf800000,0x3f6d3ec43f35bf35,0x3f5cbf04be48bf7b,0xbeac3f713f463f22,0x3f223f463f6dbec4,0xbf75be95bf0e3f55,0xbf2c3f3e3f0e3f55,0x3e79bf78bf62bef1
.quad 0x3f8000003f80,0x3f8000003f80,0xbf80bd49bf800000,0xbf7dbe16bf7fbdc9,0x3dc9bf7f0000bf80,0x3e95bf753e48bf7b,0x3f7d3e163f800000,0x3f673edb3f753e95
.quad 0xbec43f6d00003f80,0xbf6d3ec4bf353f35,0xbf67bedbbf800000,0xbe79bf78bf22bf46,0x3ef1bf620000bf80,0x3f7fbdc93f55bf0e,0x3f5c3f043f800000,0xbd493f803ef13f62
.quad 0xbf353f3500003f80,0xbf35bf35bf800000,0xbf2cbf3ebf800000,0x3f4ebf183dc9bf7f,0x3f46bf220000bf80,0x3ef13f623f7b3e48,0x3f183f4e3f800000,0xbf713eacbe953f75
.quad 0xbf6d3ec400003f80,0x3ec4bf6dbf35bf35,0xbeacbf71bf800000,0x3f5c3f043f46bf22,0x3f75be950000bf80,0xbf223f463f0e3f55,0x3e793f783f800000,0xbf2cbf3ebf623ef1
.quad 0x3f8000003f80,0x3f8000003f80,0xbf78be79bf7bbe48,0xbf71beacbf75be95,0x3ef1bf623ec4bf6d,0x3f22bf463f0ebf55,0x3f3e3f2c3f553f0e,0x3f043f5c3f223f46
.quad 0xbf6dbec4bf800000,0xbec4bf6dbf35bf35,0x3f18bf4e3e48bf7b,0x3f80bd493f62bef1,0x3f223f463f6d3ec4,0xbe953f753e483f7b,0xbf673edbbf0e3f55,0xbf4ebf18bf7fbdc9
.quad 0x3f35bf350000bf80,0x3f353f353f800000,0x3f043f5c3f7b3e48,0xbf673edbbe953f75,0xbf753e95bec43f6d,0xbdc9bf7fbf55bf0e,0xbd49bf80bf55bf0e,0x3f783e793f46bf22
.quad 0x3ec43f6d3f800000,0xbf6dbec4bf353f35,0xbf7d3e16be483f7b,0x3f2cbf3ebef1bf62,0x3dc9bf7fbf6dbec4,0x3ef13f623f7bbe48,0x3f713eac3f0ebf55,0xbf7d3e16bdc93f7f
.quad 0x3f8000003f80,0x3f8000003f80,0xbf67bedbbf6dbec4,0xbf5cbf04bf62bef1,0x3f46bf223f35bf35,0x3f62bef13f55bf0e,0x3e793f783ec43f6d,0xbd493f803dc93f7f
.quad 0x3ec4bf6d0000bf80,0x3f6dbec43f35bf35,0x3f2c3f3e3f6d3ec4,0xbe163f7d3e953f75,0xbf753e95bf353f35,0xbf46bf22bf7bbe48,0x3e16bf7dbec4bf6d,0x3f71beac3f22bf46
.quad 0xbf353f3500003f80,0xbf35bf35bf800000,0xbeacbf71bf6dbec4,0x3f78be793ef1bf62,0x3f7f3dc93f35bf35,0xbe953f753f0e3f55,0xbf043f5c3ec43f6d,0xbf2cbf3ebf7f3dc9
.quad 0x3f6dbec40000bf80,0xbec43f6d3f353f35,0xbd493f803f6d3ec4,0xbf18bf4ebf753e95,0xbf62bef1bf353f35,0x3f7fbdc93e48bf7b,0x3f4ebf18bec4bf6d,0xbedb3f673f463f22
.quad 0x3f8000003f80,0x3f8000003f80,0xbf4ebf18bf55bf0e,0xbf3ebf2cbf46bf22,0x3f75be953f6dbec4,0x3f7fbdc93f7bbe48,0xbeac3f71be483f7b,0xbf183f4ebef13f62
.quad 0x3f6d3ec43f800000,0x3ec43f6d3f353f35,0xbf5c3f04bf0e3f55,0xbf71beacbf7f3dc9,0x3dc9bf7fbec4bf6d,0x3f62bef13f0ebf55,0x3f3e3f2c3f7b3e48,0xbe793f783e953f75
.quad 0x3f35bf350000bf80,0x3f353f353f800000,0x3e163f7d3f553f0e,0xbf803d49bf223f46,0xbf62bef1bf6d3ec4,0x3f22bf46be48bf7b,0x3f67bedb3e48bf7b,0x3e163f7d3f623ef1
.quad 0xbec4bf6dbf800000,0x3f6d3ec43f35bf35,0x3f783e793f0ebf55,0xbf673edb3dc93f7f,0xbf463f223ec43f6d,0x3e95bf75bf55bf0e,0xbd49bf80bf7bbe48,0x3f043f5c3f75be95
.quad 0x3f8000003f80,0x3f8000003f80,0xbf2cbf3ebf35bf35,0xbf18bf4ebf22bf46,0x3f7f3dc93f800000,0x3f753e953f7b3e48,0xbf4e3f18bf353f35,0xbf713eacbf623ef1
.quad 0xbec43f6d00003f80,0xbf6d3ec4bf353f35,0xbeacbf71bf35bf35,0x3f04bf5c3dc9bf7f,0x3f623ef13f800000,0x3dc93f7f3f0e3f55,0xbf783e79bf353f35,0xbf2cbf3ebf75be95
.quad 0xbf353f3500003f80,0xbf35bf35bf800000,0x3d49bf80bf35bf35,0x3f7d3e163f46bf22,0x3f223f463f800000,0xbf623ef1be483f7b,0xbf7dbe16bf353f35,0x3edbbf67bef1bf62
.quad 0xbf6d3ec400003f80,0x3ec4bf6dbf35bf35,0x3edbbf67bf35bf35,0x3e793f783f7f3dc9,0x3e953f753f800000,0xbf46bf22bf553f0e,0xbf5cbf04bf353f35,0x3f803d493e95bf75
.quad 0x3f8000003f80,0x3f8000003f80,0xbf04bf5cbf0ebf55,0xbedbbf67bef1bf62,0x3f623ef13f6d3ec4,0x3f463f223f553f0e,0xbf803d49bf7b3e48,0xbf78be79bf7fbdc9
.quad 0xbf6dbec4bf800000,0xbec4bf6dbf35bf35,0x3f7dbe163f55bf0e,0x3f3e3f2c3f753e95,0xbf463f22bec43f6d,0xbf75be95bf7b3e48,0x3eacbf71be48bf7b,0x3f7dbe163f46bf22
.quad 0x3f35bf350000bf80,0x3f353f353f800000,0xbe793f783f0e3f55,0xbf71beacbf623ef1,0xbe95bf75bf6dbec4,0x3f7fbdc93f0ebf55,0x3f3e3f2c3f7bbe48,0xbf5c3f04bdc93f7f
.quad 0x3ec43f6d3f800000,0xbf6dbec4bf353f35,0xbf4ebf18bf553f0e,0x3f80bd493e95bf75,0x3f7f3dc93ec4bf6d,0xbf623ef13e483f7b,0xbf673edb3e483f7b,0x3f18bf4ebf22bf46
.quad 0x3f8000003f80,0x3f8000003f80,0xbeacbf71bec4bf6d,0xbe79bf78be95bf75,0x3f223f463f353f35,0x3ef13f623f0e3f55,0xbf5cbf04bf6dbec4,0xbf2cbf3ebf46bf22
.quad 0x3ec4bf6d0000bf80,0x3f6dbec43f35bf35,0xbd493f803ec43f6d,0xbf4e3f18bef13f62,0xbe95bf75bf35bf35,0x3f22bf463e48bf7b,0x3f183f4e3f6d3ec4,0xbedb3f673dc93f7f
.quad 0xbf353f3500003f80,0xbf35bf35bf800000,0x3edbbf67bec4bf6d,0x3f5c3f043f75be95,0xbdc93f7f3f353f35,0xbf75be95bf553f0e,0xbe79bf78bf6dbec4,0x3f803d493f22bf46
.quad 0x3f6dbec40000bf80,0xbec43f6d3f353f35,0xbf3e3f2c3ec43f6d,0x3e16bf7dbf62bef1,0x3ef1bf62bf35bf35,0x3dc93f7f3f7b3e48,0xbe163f7d3f6d3ec4,0xbeacbf71bf7f3dc9
.quad 0x3f8000003f80,0x3f8000003f80,0xbe16bf7dbe48bf7b,0xbd49bf80bdc9bf7f,0x3e953f753ec43f6d,0x3dc93f7f3e483f7b,0xbedbbf67bf0ebf55,0xbe16bf7dbe95bf75
.quad 0x3f6d3ec43f800000,0x3ec43f6d3f353f35,0xbf78be79bf7b3e48,0xbedbbf67bf46bf22,0x3f7f3dc93f6dbec4,0x3ef13f623f553f0e,0xbf803d49bf553f0e,0xbf04bf5cbf62bef1
.quad 0x3f35bf350000bf80,0x3f353f353f800000,0xbf183f4e3e483f7b,0xbf3ebf2cbf7f3dc9,0x3ef1bf62bec4bf6d,0x3f463f223f7bbe48,0xbeac3f713f0e3f55,0xbf4ebf18bf753e95
.quad 0xbec4bf6dbf800000,0x3f6d3ec43f35bf35,0x3f043f5c3f7bbe48,0xbf71beacbf223f46,0xbf22bf46bf6d3ec4,0x3f753e953f0ebf55,0x3f3e3f2c3f55bf0e,0xbf78be79bef13f62
.quad 0xbe483f7b3f803f80,0xbf0e3f55bec43f6d,0xbe793f78bf803f80,0xbf2c3f3ebef13f62,0xbe953f753f803f80,0xbf463f22bf0e3f55,0xbeac3f71bf803f80,0xbf5c3f04bf223f46
.quad 0xbf0e3f553f803f80,0xbf7bbe48bf6d3ec4,0xbf183f4ebf803f80,0xbf71beacbf753e95,0xbf223f463f803f80,0xbf62bef1bf7b3e48,0xbf2c3f3ebf803f80,0xbf4ebf18bf7f3dc9
.quad 0xbf553f0e3f803f80,0xbe48bf7bbf6dbec4,0xbf5c3f04bf803f80,0xbd49bf80bf62bef1,0xbf623ef13f803f80,0x3dc9bf7fbf55bf0e,0xbf673edbbf803f80,0x3e79bf78bf46bf22
.quad 0xbf7b3e483f803f80,0x3f55bf0ebec4bf6d,0xbf7d3e16bf803f80,0x3f67bedbbe95bf75,0xbf7f3dc93f803f80,0x3f75be95be48bf7b,0xbf803d49bf803f80,0x3f7dbe16bdc9bf7f
.quad 0xbf553f0ebf353f35,0xbf7b3e48bf6d3ec4,0xbf713eacbf553f0e,0xbf7dbe16bf7f3dc9,0xbf7f3dc9bf6d3ec4,0xbf62bef1bf7bbe48,0xbf7dbe16bf7b3e48,0xbf2cbf3ebf62bef1
.quad 0xbe48bf7bbf35bf35,0x3f55bf0e3ec4bf6d,0x3d49bf80bf0ebf55,0x3f78be793f22bf46,0x3e95bf75bec4bf6d,0x3f7f3dc93f55bf0e,0x3f04bf5cbe48bf7b,0x3f673edb3f75be95
.quad 0x3f7b3e483f35bf35,0xbf0e3f553ec43f6d,0x3f673edb3f55bf0e,0xbf4e3f183dc93f7f,0x3f463f223f6dbec4,0xbf753e95be483f7b,0x3f183f4e3f7bbe48,0xbf80bd49bef13f62
.quad 0xbf0e3f553f353f35,0x3e48bf7bbf6dbec4,0xbf3e3f2c3f0e3f55,0x3f04bf5cbf46bf22,0xbf623ef13ec43f6d,0x3f46bf22bf0ebf55,0xbf783e793e483f7b,0x3f71beacbe95bf75
.quad 0xbf7bbe48bf800000,0xbf55bf0ebf6dbec4,0xbf4ebf18bf6dbec4,0xbedbbf67bf22bf46,0xbef1bf62bf35bf35,0x3dc9bf7fbe48bf7b,0xbd49bf80bec4bf6d,0x3f18bf4e3e95bf75
.quad 0x3f553f0e3f800000,0xbe483f7b3ec43f6d,0x3f043f5c3f6d3ec4,0xbf2c3f3ebdc93f7f,0x3dc93f7f3f353f35,0xbf753e95bf0e3f55,0xbeac3f713ec43f6d,0xbf78be79bf623ef1
.quad 0xbf0ebf55bf800000,0x3f7bbe483ec4bf6d,0xbe16bf7dbf6dbec4,0x3f713eac3f46bf22,0x3e95bf75bf35bf35,0x3f223f463f7bbe48,0x3f2cbf3ebec4bf6d,0x3e163f7d3f753e95
.quad 0x3e483f7b3f800000,0xbf0ebf55bf6d3ec4,0xbe793f783f6d3ec4,0xbd49bf80bf7fbdc9,0xbf223f463f353f35,0x3ef1bf62bf55bf0e,0xbf673edb3ec43f6d,0x3f5cbf04bef1bf62
.quad 0xbf0ebf55bf35bf35,0xbe48bf7bbec4bf6d,0x3d49bf80be48bf7b,0x3f04bf5c3e95bf75,0x3f22bf463ec4bf6d,0x3f75be953f55bf0e,0x3f78be793f55bf0e,0x3f673edb3f7f3dc9
.quad 0xbf7b3e48bf353f35,0xbf0ebf55bf6dbec4,0xbf67bedbbf7b3e48,0x3e16bf7dbef1bf62,0xbef1bf62bf6dbec4,0x3f46bf223e48bf7b,0x3e16bf7dbf0ebf55,0x3f803d493f46bf22
.quad 0xbe483f7b3f353f35,0xbf55bf0ebf6d3ec4,0xbf3e3f2c3e483f7b,0xbe79bf78bf75be95,0xbf7f3dc9bec43f6d,0x3ef1bf62bf0ebf55,0xbf5cbf04bf553f0e,0x3f71beac3dc9bf7f
.quad 0x3f553f0e3f35bf35,0xbf7bbe48bec43f6d,0x3eac3f713f7bbe48,0xbf18bf4ebf623ef1,0xbe953f753f6d3ec4,0x3dc9bf7fbf7bbe48,0xbf4e3f183f0e3f55,0x3f3ebf2cbf22bf46
.quad 0x3e48bf7b0000bf80,0x3f0ebf553ec4bf6d,0x3f5cbf043f35bf35,0x3f80bd493f75be95,0x3f753e953f800000,0x3f223f463f553f0e,0x3edb3f673f353f35,0xbe793f783dc93f7f
.quad 0x3f0ebf550000bf80,0x3f7b3e483f6dbec4,0x3f7dbe163f35bf35,0x3edb3f673f623ef1,0x3f463f223f800000,0xbef13f623e483f7b,0x3d493f803f353f35,0xbf7d3e16bf223f46
.quad 0x3f55bf0e0000bf80,0x3e483f7b3f6d3ec4,0x3f783e793f35bf35,0xbf2c3f3e3e953f75,0x3ef13f623f800000,0xbf7fbdc9bf0e3f55,0xbeac3f713f353f35,0xbf04bf5cbf7f3dc9
.quad 0x3f7bbe480000bf80,0xbf553f0e3ec43f6d,0x3f4e3f183f35bf35,0xbf71beacbef13f62,0x3dc93f7f3f800000,0xbe95bf75bf7b3e48,0xbf2c3f3e3f353f35,0x3f18bf4ebf46bf22
.quad 0x3f55bf0e3f35bf35,0x3f7bbe483f6dbec4,0x3f673edb3f7b3e48,0x3f183f4e3f463f22,0x3dc93f7f3ec43f6d,0xbef13f62be483f7b,0xbf4e3f18bf0e3f55,0xbf80bd49bf753e95
.quad 0x3e483f7b3f353f35,0xbf553f0ebec43f6d,0xbf3e3f2cbe483f7b,0xbf5cbf04bf7f3dc9,0xbf75be95bf6d3ec4,0x3dc9bf7fbf0ebf55,0xbe79bf78bf55bf0e,0x3f71beac3ef1bf62
.quad 0xbf7bbe48bf353f35,0x3f0ebf55bec4bf6d,0xbeacbf71bf7bbe48,0x3f7d3e163f22bf46,0x3f22bf46bec4bf6d,0x3e953f753f7b3e48,0x3f7d3e163f0ebf55,0xbf3e3f2c3e953f75
.quad 0x3f0ebf55bf35bf35,0xbe483f7b3f6d3ec4,0x3f803d493e48bf7b,0xbf783e793dc93f7f,0x3ef13f623f6dbec4,0xbf22bf46bf553f0e,0xbf043f5c3f553f0e,0x3edbbf67bf62bef1
.quad 0x3f7b3e483f800000,0x3f553f0e3f6d3ec4,0x3e163f7d3ec43f6d,0xbeac3f71bdc93f7f,0xbf623ef1bf353f35,0xbf7fbdc9bf7b3e48,0xbf3ebf2cbf6dbec4,0xbe16bf7dbef1bf62
.quad 0xbf55bf0ebf800000,0x3e48bf7bbec4bf6d,0x3e79bf78bec4bf6d,0x3f80bd493f46bf22,0x3f7fbdc93f35bf35,0x3e953f753f553f0e,0x3edb3f673f6d3ec4,0xbf5c3f04be953f75
.quad 0x3f0e3f553f800000,0xbf7b3e48bec43f6d,0xbf183f4e3ec43f6d,0xbedbbf67bf7fbdc9,0xbf75be95bf353f35,0x3f46bf22be48bf7b,0xbd49bf80bf6dbec4,0x3f4e3f183f62bef1
.quad 0xbe48bf7bbf800000,0x3f0e3f553f6dbec4,0x3f5cbf04bec4bf6d,0xbf2c3f3e3f223f46,0x3f463f223f35bf35,0xbf62bef1bf0e3f55,0xbeac3f713f6d3ec4,0x3e79bf78bf75be95
.quad 0x3f0e3f553f353f35,0x3e483f7b3ec43f6d,0xbf3e3f2cbf0e3f55,0xbf783e79bf623ef1,0xbf46bf22bf6dbec4,0xbe95bf75bf0ebf55,0x3f04bf5c3e48bf7b,0x3f71beac3f46bf22
.quad 0x3f7bbe483f35bf35,0x3f0e3f553f6d3ec4,0x3eac3f713f553f0e,0xbf4e3f18be953f75,0xbf623ef1bec43f6d,0xbf22bf46bf7bbe48,0xbf18bf4ebf7bbe48,0x3f3ebf2c3dc9bf7f
.quad 0x3e48bf7bbf35bf35,0x3f553f0e3f6dbec4,0x3f803d493f0ebf55,0xbf043f5c3ef13f62,0x3dc93f7f3f6d3ec4,0xbf62bef1bf553f0e,0xbf783e79be483f7b,0x3edbbf67bf22bf46
.quad 0xbf55bf0ebf353f35,0x3f7b3e483ec4bf6d,0x3edbbf67bf55bf0e,0xbe163f7d3f753e95,0x3f753e953ec4bf6d,0xbf7fbdc9be483f7b,0xbe163f7d3f7b3e48,0x3d49bf80bf7fbdc9
.quad 0xbe483f7b00003f80,0xbf0e3f55bec43f6d,0xbf78be79bf800000,0xbf3ebf2cbf62bef1,0x3e95bf750000bf80,0x3f46bf223f0ebf55,0x3f713eac3f800000,0x3f043f5c3f463f22
.quad 0xbf0e3f5500003f80,0xbf7bbe48bf6d3ec4,0xbf4ebf18bf800000,0x3eacbf71be95bf75,0x3f22bf460000bf80,0x3f623ef13f7bbe48,0x3f3e3f2c3f800000,0xbf183f4e3dc93f7f
.quad 0xbf553f0e00003f80,0xbe48bf7bbf6dbec4,0xbf04bf5cbf800000,0x3f80bd493ef1bf62,0x3f62bef10000bf80,0xbdc93f7f3f553f0e,0x3edb3f673f800000,0xbf78be79bf223f46
.quad 0xbf7b3e4800003f80,0x3f55bf0ebec4bf6d,0xbe16bf7dbf800000,0x3edb3f673f75be95,0x3f7fbdc90000bf80,0xbf753e953e483f7b,0x3d493f803f800000,0xbe16bf7dbf7f3dc9
.quad 0xbf553f0ebf353f35,0xbf7b3e48bf6d3ec4,0xbeacbf71bf0ebf55,0x3e16bf7dbdc9bf7f,0x3f7fbdc93f6dbec4,0x3f623ef13f7b3e48,0xbe163f7d3e483f7b,0xbf3e3f2cbef13f62
.quad 0xbe48bf7bbf35bf35,0x3f55bf0e3ec4bf6d,0x3f803d493f55bf0e,0x3e793f783f463f22,0xbe953f753ec43f6d,0xbf7fbdc9bf553f0e,0xbf5cbf04bf7b3e48,0x3edbbf67be95bf75
.quad 0x3f7b3e483f35bf35,0xbf0e3f553ec43f6d,0xbedb3f673f0e3f55,0xbf18bf4ebf7f3dc9,0xbf46bf22bf6d3ec4,0x3f75be953e48bf7b,0x3f4ebf18be48bf7b,0xbd493f803f623ef1
.quad 0xbf0e3f553f353f35,0x3e48bf7bbf6dbec4,0xbf2cbf3ebf553f0e,0x3f5c3f043f22bf46,0x3f62bef1bec4bf6d,0xbf463f223f0e3f55,0x3e793f783f7bbe48,0xbeacbf71bf753e95
.quad 0xbf7bbe48bf800000,0xbf55bf0ebf6dbec4,0x3f18bf4e3ec4bf6d,0x3f67bedb3f46bf22,0x3ef13f623f353f35,0xbdc93f7f3e483f7b,0xbf803d49bf6d3ec4,0xbf4ebf18bf75be95
.quad 0x3f553f0e3f800000,0xbe483f7b3ec43f6d,0xbf5c3f04bec43f6d,0xbf3ebf2cbf7fbdc9,0xbdc9bf7fbf35bf35,0x3f75be953f0ebf55,0x3f713eac3f6dbec4,0xbe793f783ef13f62
.quad 0xbf0ebf55bf800000,0x3f7bbe483ec4bf6d,0x3f7dbe163ec4bf6d,0xbeac3f713f223f46,0xbe953f753f353f35,0xbf22bf46bf7b3e48,0xbf3ebf2cbf6d3ec4,0x3f7dbe163e95bf75
.quad 0x3e483f7b3f800000,0xbf0ebf55bf6d3ec4,0xbf78be79bec43f6d,0x3f80bd493dc9bf7f,0x3f22bf46bf35bf35,0xbef13f623f553f0e,0x3edb3f673f6dbec4,0xbf04bf5cbf623ef1
.quad 0xbf0ebf55bf35bf35,0xbe48bf7bbec4bf6d,0x3f803d493f7bbe48,0x3f5c3f043f753e95,0xbf223f46bec43f6d,0xbf753e95bf553f0e,0xbe79bf78bf0ebf55,0x3edbbf673dc9bf7f
.quad 0xbf7b3e48bf353f35,0xbf0ebf55bf6dbec4,0x3edbbf67be48bf7b,0x3f7d3e163f62bef1,0x3ef13f623f6d3ec4,0xbf463f22be483f7b,0xbf7dbe16bf553f0e,0x3d49bf80bf22bf46
.quad 0xbe483f7b3f353f35,0xbf55bf0ebf6d3ec4,0xbf2cbf3ebf7b3e48,0x3f78be793e95bf75,0x3f7fbdc93ec4bf6d,0xbef13f623f0e3f55,0xbf043f5c3f0e3f55,0xbeacbf71bf7fbdc9
.quad 0x3f553f0e3f35bf35,0xbf7bbe48bec43f6d,0xbf713eac3e483f7b,0x3f4ebf18bef1bf62,0x3e95bf75bf6dbec4,0xbdc93f7f3f7b3e48,0x3f183f4e3f55bf0e,0xbf2cbf3ebf463f22
.quad 0x3e48bf7b0000bf80,0x3f0ebf553ec4bf6d,0x3f043f5c3f353f35,0x3d493f803e953f75,0xbf75be95bf800000,0xbf22bf46bf55bf0e,0x3f67bedb3f35bf35,0x3f783e793f7fbdc9
.quad 0x3f0ebf550000bf80,0x3f7b3e483f6dbec4,0x3e163f7d3f353f35,0xbf673edbbef13f62,0xbf46bf22bf800000,0x3ef1bf62be48bf7b,0x3f80bd493f35bf35,0x3e163f7d3f463f22
.quad 0x3f55bf0e0000bf80,0x3e483f7b3f6d3ec4,0xbe793f783f353f35,0xbf3ebf2cbf753e95,0xbef1bf62bf800000,0x3f7f3dc93f0ebf55,0x3f713eac3f35bf35,0xbf5c3f043dc93f7f
.quad 0x3f7bbe480000bf80,0xbf553f0e3ec43f6d,0xbf183f4e3f353f35,0x3eacbf71bf62bef1,0xbdc9bf7fbf800000,0x3e953f753f7bbe48,0x3f3e3f2c3f35bf35,0xbf4ebf18bf223f46
.quad 0x3f55bf0e3f35bf35,0x3f7bbe483f6dbec4,0xbedb3f67be483f7b,0xbf4e3f18bf223f46,0xbdc9bf7fbec4bf6d,0x3ef1bf623e48bf7b,0x3f183f4e3f553f0e,0xbd493f803e953f75
.quad 0x3e483f7b3f353f35,0xbf553f0ebec43f6d,0xbf2cbf3ebf7bbe48,0x3f04bf5cbdc9bf7f,0x3f753e953f6dbec4,0xbdc93f7f3f0e3f55,0xbf783e79bf0e3f55,0xbeacbf71bf62bef1
.quad 0xbf7bbe48bf353f35,0x3f0ebf55bec4bf6d,0x3f71beac3e48bf7b,0xbe163f7d3f463f22,0xbf223f463ec43f6d,0xbe95bf75bf7bbe48,0x3e16bf7dbf55bf0e,0x3f2c3f3e3f75be95
.quad 0x3f0ebf55bf35bf35,0xbe483f7b3f6d3ec4,0xbd493f803f7b3e48,0xbe79bf78bf7f3dc9,0xbef1bf62bf6d3ec4,0x3f223f463f55bf0e,0x3f5c3f043f0ebf55,0xbf67bedbbef13f62
.quad 0x3f7b3e483f800000,0x3f553f0e3f6d3ec4,0xbf7d3e16bf6d3ec4,0xbf71beacbf7fbdc9,0x3f62bef13f35bf35,0x3f7f3dc93f7bbe48,0xbf2c3f3ebec43f6d,0xbf7d3e16bf623ef1
.quad 0xbf55bf0ebf800000,0x3e48bf7bbec4bf6d,0x3f783e793f6dbec4,0x3d493f803f223f46,0xbf7f3dc9bf353f35,0xbe95bf75bf55bf0e,0x3f67bedb3ec4bf6d,0x3f043f5c3f753e95
.quad 0x3f0e3f553f800000,0xbf7b3e48bec43f6d,0xbf4ebf18bf6d3ec4,0x3f67bedb3dc9bf7f,0x3f753e953f35bf35,0xbf463f223e483f7b,0xbf803d49bec43f6d,0x3f18bf4ebef1bf62
.quad 0xbe48bf7bbf800000,0x3f0e3f553f6dbec4,0x3f043f5c3f6dbec4,0xbf3ebf2cbf463f22,0xbf46bf22bf353f35,0x3f623ef13f0ebf55,0x3f713eac3ec4bf6d,0xbf78be79be953f75
.quad 0x3f0e3f553f353f35,0x3e483f7b3ec43f6d,0xbf2cbf3ebf55bf0e,0xbe79bf78bef1bf62,0x3f463f223f6d3ec4,0x3e953f753f0e3f55,0xbf5cbf04bf7bbe48,0xbeacbf71bf22bf46
.quad 0x3f7bbe483f35bf35,0x3f0e3f553f6d3ec4,0xbf713eacbf0e3f55,0xbf18bf4ebf75be95,0x3f62bef13ec4bf6d,0x3f223f463f7b3e48,0xbf4e3f18be483f7b,0xbf2cbf3ebf7fbdc9
.quad 0x3e48bf7bbf35bf35,0x3f553f0e3f6dbec4,0xbd493f803f553f0e,0xbf5cbf04bf623ef1,0xbdc9bf7fbf6dbec4,0x3f623ef13f55bf0e,0x3e793f783f7b3e48,0xbf67bedbbf463f22
.quad 0xbf55bf0ebf353f35,0x3f7b3e483ec4bf6d,0x3f673edb3f0ebf55,0xbf7dbe16be953f75,0xbf75be95bec43f6d,0x3f7f3dc93e48bf7b,0x3f7d3e163e48bf7b,0xbf80bd49bdc93f7f
.quad 0xbf8000003f803f80,0x3f8000000000bf80,0xbf80bd49bf803f80,0x3f7d3e163dc9bf7f,0xbf7fbdc93f803f80,0x3f753e953e48bf7b,0xbf7dbe16bf803f80,0x3f673edb3e95bf75
.quad 0xbf6dbec43f803f80,0x3ec43f6d3f35bf35,0xbf67bedbbf803f80,0x3e793f783f46bf22,0xbf62bef13f803f80,0x3dc93f7f3f55bf0e,0xbf5cbf04bf803f80,0xbd493f803f62bef1
.quad 0xbf35bf353f803f80,0xbf353f353f800000,0xbf2cbf3ebf803f80,0xbf4e3f183f7f3dc9,0xbf22bf463f803f80,0xbf623ef13f7b3e48,0xbf18bf4ebf803f80,0xbf713eac3f753e95
.quad 0xbec4bf6d3f803f80,0xbf6dbec43f353f35,0xbeacbf71bf803f80,0xbf5cbf043f223f46,0xbe95bf753f803f80,0xbf46bf223f0e3f55,0xbe79bf78bf803f80,0xbf2cbf3e3ef13f62
.quad 0xbf80000000003f80,0x3f8000000000bf80,0xbf78be79be483f7b,0x3f713eac3e95bf75,0xbf62bef1bec43f6d,0x3f463f223f0ebf55,0xbf3ebf2cbf0e3f55,0x3f043f5c3f46bf22
.quad 0x3ec4bf6dbf800000,0xbf6d3ec43f353f35,0x3f18bf4ebf7bbe48,0xbf803d493ef13f62,0x3f46bf22bf6dbec4,0xbf75be953e483f7b,0x3f67bedbbf55bf0e,0xbf4ebf18bdc93f7f
.quad 0x3f353f350000bf80,0x3f35bf35bf800000,0x3f043f5c3e48bf7b,0x3f67bedbbf75be95,0x3e953f753ec4bf6d,0x3f7fbdc9bf55bf0e,0x3d493f803f0ebf55,0x3f783e79bf22bf46
.quad 0xbf6d3ec43f800000,0xbec43f6d3f35bf35,0xbf7d3e163f7b3e48,0xbf2c3f3e3f62bef1,0xbf7fbdc93f6d3ec4,0xbf623ef13f7bbe48,0xbf71beac3f553f0e,0xbf7d3e163f7f3dc9
.quad 0xbf80000000003f80,0x3f8000000000bf80,0xbf67bedbbec43f6d,0x3f5c3f043ef1bf62,0xbf22bf46bf353f35,0x3ef13f623f55bf0e,0xbe79bf78bf6d3ec4,0xbd493f803f7fbdc9
.quad 0x3f6d3ec40000bf80,0xbec4bf6dbf353f35,0x3f2c3f3e3ec4bf6d,0x3e16bf7dbf753e95,0x3e953f753f35bf35,0x3f22bf46bf7bbe48,0xbe163f7d3f6dbec4,0x3f71beacbf46bf22
.quad 0xbf35bf3500003f80,0xbf353f353f800000,0xbeacbf71bec43f6d,0xbf783e793f623ef1,0x3dc9bf7fbf353f35,0xbf75be953f0e3f55,0x3f04bf5cbf6d3ec4,0xbf2cbf3e3dc93f7f
.quad 0x3ec43f6d0000bf80,0x3f6d3ec4bf35bf35,0xbd493f803ec4bf6d,0x3f183f4ebe95bf75,0xbef13f623f35bf35,0x3dc93f7f3e48bf7b,0xbf4e3f183f6dbec4,0xbedb3f673f22bf46
.quad 0xbf80000000003f80,0x3f8000000000bf80,0xbf4ebf18bf0e3f55,0x3f3e3f2c3f22bf46,0xbe95bf75bf6d3ec4,0x3dc93f7f3f7bbe48,0x3eacbf71bf7bbe48,0xbf183f4e3f623ef1
.quad 0xbec43f6d3f800000,0x3f6dbec4bf35bf35,0xbf5c3f043f553f0e,0x3f713eacbdc9bf7f,0xbf7fbdc93ec43f6d,0x3ef13f623f0ebf55,0xbf3ebf2cbe483f7b,0xbe793f783f75be95
.quad 0x3f353f350000bf80,0x3f35bf35bf800000,0x3e163f7d3f0ebf55,0x3f80bd49bf46bf22,0xbef13f623f6dbec4,0x3f463f22be48bf7b,0xbf673edb3f7b3e48,0x3e163f7d3ef1bf62
.quad 0x3f6dbec4bf800000,0x3ec4bf6dbf353f35,0x3f783e79bf55bf0e,0x3f67bedbbf7f3dc9,0x3f223f46bec4bf6d,0x3f753e95bf55bf0e,0x3d493f803e48bf7b,0x3f043f5cbe95bf75
.quad 0xbf80000000003f80,0x3f8000000000bf80,0xbf2cbf3ebf353f35,0x3f183f4e3f46bf22,0x3dc9bf7fbf800000,0xbe953f753f7b3e48,0x3f4ebf18bf35bf35,0xbf713eac3ef13f62
.quad 0xbf6dbec400003f80,0x3ec43f6d3f35bf35,0xbeacbf71bf353f35,0xbf043f5c3f7f3dc9,0x3ef1bf62bf800000,0xbf7f3dc93f0e3f55,0x3f78be79bf35bf35,0xbf2cbf3ebe953f75
.quad 0xbf35bf3500003f80,0xbf353f353f800000,0x3d49bf80bf353f35,0xbf7dbe163f223f46,0x3f46bf22bf800000,0xbef1bf62be483f7b,0x3f7d3e16bf35bf35,0x3edbbf67bf623ef1
.quad 0xbec4bf6d00003f80,0xbf6dbec43f353f35,0x3edbbf67bf353f35,0xbe79bf78bdc93f7f,0x3f75be95bf800000,0x3f22bf46bf553f0e,0x3f5c3f04bf35bf35,0x3f803d49bf75be95
.quad 0xbf80000000003f80,0x3f8000000000bf80,0xbf04bf5cbf553f0e,0x3edb3f673f62bef1,0x3ef1bf62bf6dbec4,0xbf223f463f553f0e,0x3f80bd49be48bf7b,0xbf78be79bdc93f7f
.quad 0x3ec4bf6dbf800000,0xbf6d3ec43f353f35,0x3f7dbe16bf0ebf55,0xbf3ebf2cbe953f75,0x3f223f463ec4bf6d,0x3e95bf75bf7b3e48,0xbeac3f713f7bbe48,0x3f7dbe16bf22bf46
.quad 0x3f353f350000bf80,0x3f35bf35bf800000,0xbe793f783f55bf0e,0x3f713eacbef1bf62,0xbf753e953f6d3ec4,0x3dc93f7f3f0ebf55,0xbf3ebf2c3e483f7b,0xbf5c3f043f7f3dc9
.quad 0xbf6d3ec43f800000,0xbec43f6d3f35bf35,0xbf4ebf183f0e3f55,0xbf803d493f753e95,0x3dc9bf7fbec43f6d,0xbef1bf623e483f7b,0x3f67bedbbf7b3e48,0x3f18bf4ebf463f22
.quad 0xbf80000000003f80,0x3f8000000000bf80,0xbeacbf71bf6d3ec4,0x3e793f783f75be95,0x3f46bf22bf35bf35,0xbf623ef13f0e3f55,0x3f5c3f043ec4bf6d,0xbf2cbf3ebf223f46
.quad 0x3f6d3ec40000bf80,0xbec4bf6dbf353f35,0xbd493f803f6dbec4,0x3f4ebf18bf62bef1,0xbf753e953f353f35,0x3f463f223e48bf7b,0xbf18bf4ebec43f6d,0xbedb3f673f7fbdc9
.quad 0xbf35bf3500003f80,0xbf353f353f800000,0x3edbbf67bf6d3ec4,0xbf5cbf043e953f75,0x3f7f3dc9bf35bf35,0x3e95bf75bf553f0e,0x3e793f783ec4bf6d,0x3f803d49bf46bf22
.quad 0x3ec43f6d0000bf80,0x3f6d3ec4bf35bf35,0xbf3e3f2c3f6dbec4,0xbe163f7d3ef1bf62,0xbf62bef13f353f35,0xbf7f3dc93f7b3e48,0x3e16bf7dbec43f6d,0xbeacbf713dc93f7f
.quad 0xbf80000000003f80,0x3f8000000000bf80,0xbe16bf7dbf7b3e48,0x3d493f803f7fbdc9,0x3f75be95bec4bf6d,0xbf7f3dc93e483f7b,0x3edb3f673f55bf0e,0xbe16bf7dbf753e95
.quad 0xbec43f6d3f800000,0x3f6dbec4bf35bf35,0xbf78be793e483f7b,0x3edb3f673f22bf46,0x3dc9bf7fbf6d3ec4,0xbf623ef13f553f0e,0x3f80bd49bf0ebf55,0xbf04bf5cbef13f62
.quad 0x3f353f350000bf80,0x3f35bf35bf800000,0xbf183f4e3f7bbe48,0x3f3e3f2cbdc9bf7f,0xbf62bef13ec43f6d,0xbf223f463f7bbe48,0x3eacbf71bf553f0e,0xbf4ebf183e953f75
.quad 0x3f6dbec4bf800000,0x3ec4bf6dbf353f35,0x3f043f5cbe48bf7b,0x3f713eacbf46bf22,0xbf463f223f6dbec4,0xbe953f753f0ebf55,0xbf3ebf2c3f0e3f55,0xbf78be793f623ef1
.quad 0xbf80000000003f80,0x3f8000000000bf80,0x3d49bf80bf800000,0xbe163f7d3f7f3dc9,0x3f7f3dc90000bf80,0xbf75be95be483f7b,0xbe163f7d3f800000,0x3edbbf67bf75be95
.quad 0xbf6dbec400003f80,0x3ec43f6d3f35bf35,0x3edbbf67bf800000,0xbf783e793f223f46,0x3f623ef10000bf80,0xbdc9bf7fbf553f0e,0xbf043f5c3f800000,0x3f803d49bef1bf62
.quad 0xbf35bf3500003f80,0xbf353f353f800000,0x3f3ebf2cbf800000,0xbf18bf4ebdc93f7f,0x3f223f460000bf80,0x3f62bef1bf7bbe48,0xbf4e3f183f800000,0x3eac3f713e95bf75
.quad 0xbec4bf6d00003f80,0xbf6dbec43f353f35,0x3f71beacbf800000,0x3f04bf5cbf463f22,0x3e953f750000bf80,0x3f463f22bf0ebf55,0xbf783e793f800000,0xbf3e3f2c3f62bef1
.quad 0xbf80000000003f80,0x3f8000000000bf80,0x3e79bf78bf7bbe48,0xbeac3f713f753e95,0x3f623ef13ec4bf6d,0xbf46bf22bf0e3f55,0xbf2c3f3e3f553f0e,0x3f5cbf04bf22bf46
.quad 0x3ec4bf6dbf800000,0xbf6d3ec43f353f35,0x3f4e3f183e48bf7b,0xbd49bf80bf623ef1,0xbf463f223f6d3ec4,0x3f753e95be48bf7b,0xbedbbf67bf0e3f55,0xbf183f4e3f7f3dc9
.quad 0x3f353f350000bf80,0x3f35bf35bf800000,0xbf5c3f043f7b3e48,0x3edb3f673e95bf75,0xbe95bf75bec43f6d,0xbf7f3dc93f553f0e,0x3f80bd49bf55bf0e,0x3e79bf78bf463f22
.quad 0xbf6d3ec43f800000,0xbec43f6d3f35bf35,0xbe16bf7dbe483f7b,0xbf3ebf2c3ef13f62,0x3f7f3dc9bf6dbec4,0x3f62bef1bf7b3e48,0xbeac3f713f0ebf55,0x3e163f7d3dc9bf7f
.quad 0xbf80000000003f80,0x3f8000000000bf80,0x3edbbf67bf6dbec4,0xbf043f5c3f623ef1,0x3f223f463f35bf35,0xbef1bf62bf553f0e,0xbf783e793ec43f6d,0x3f803d49bdc9bf7f
.quad 0x3f6d3ec40000bf80,0xbec4bf6dbf353f35,0xbf3e3f2c3f6d3ec4,0x3f7d3e16be95bf75,0xbe95bf75bf353f35,0xbf223f463f7b3e48,0x3f7d3e16bec4bf6d,0xbeacbf71bf223f46
.quad 0xbf35bf3500003f80,0xbf353f353f800000,0x3f71beacbf6dbec4,0xbe79bf78bef13f62,0xbdc93f7f3f35bf35,0x3f753e95bf0ebf55,0xbf5cbf043ec43f6d,0xbf3e3f2c3f7fbdc9
.quad 0x3ec43f6d0000bf80,0x3f6d3ec4bf35bf35,0xbf80bd493f6d3ec4,0xbf4e3f183f75be95,0x3ef1bf62bf353f35,0xbdc9bf7fbe483f7b,0x3f183f4ebec4bf6d,0x3f673edbbf46bf22
.quad 0xbf80000000003f80,0x3f8000000000bf80,0x3f18bf4ebf55bf0e,0xbf2c3f3e3f463f22,0x3e953f753f6dbec4,0xbdc9bf7fbf7b3e48,0xbf71beacbe483f7b,0x3f4e3f183ef1bf62
.quad 0xbec43f6d3f800000,0x3f6dbec4bf35bf35,0xbf04bf5cbf0e3f55,0xbeac3f713f7fbdc9,0x3f7f3dc9bec4bf6d,0xbef1bf62bf0e3f55,0xbf2c3f3e3f7b3e48,0x3f783e79be95bf75
.quad 0x3f353f350000bf80,0x3f35bf35bf800000,0xbf7d3e163f553f0e,0x3d493f803f22bf46,0x3ef1bf62bf6d3ec4,0xbf46bf223e483f7b,0x3edb3f673e48bf7b,0x3f7dbe16bf62bef1
.quad 0x3f6dbec4bf800000,0x3ec4bf6dbf353f35,0xbe793f783f0ebf55,0x3edb3f67bdc9bf7f,0xbf22bf463ec43f6d,0xbf75be953f553f0e,0x3f80bd49bf7bbe48,0x3f5cbf04bf753e95
.quad 0xbf80000000003f80,0x3f8000000000bf80,0x3f3ebf2cbf35bf35,0xbf4e3f183f223f46,0xbdc93f7f3f800000,0x3e95bf75bf7bbe48,0xbf18bf4ebf353f35,0x3eac3f713f62bef1
.quad 0xbf6dbec400003f80,0x3ec43f6d3f35bf35,0x3f71beacbf35bf35,0xbf5cbf04bdc93f7f,0xbef13f623f800000,0x3f7fbdc9bf0ebf55,0xbe79bf78bf353f35,0xbf3e3f2c3f753e95
.quad 0xbf35bf3500003f80,0xbf353f353f800000,0x3f803d49bf35bf35,0x3e16bf7dbf463f22,0xbf463f223f800000,0x3ef13f623e48bf7b,0x3e16bf7dbf353f35,0xbf67bedb3ef13f62
.quad 0xbec4bf6d00003f80,0xbf6dbec43f353f35,0x3f673edbbf35bf35,0x3f78be79bf7fbdc9,0xbf753e953f800000,0xbf223f463f55bf0e,0x3f04bf5cbf353f35,0x3d49bf80be953f75
.quad 0xbf80000000003f80,0x3f8000000000bf80,0x3f5cbf04bf0ebf55,0xbf673edb3ef13f62,0xbef13f623f6d3ec4,0x3f22bf46bf55bf0e,0xbd49bf80bf7b3e48,0xbe793f783f7f3dc9
.quad 0x3ec4bf6dbf800000,0xbf6d3ec43f353f35,0x3e163f7d3f55bf0e,0x3f2cbf3ebf75be95,0xbf22bf46bec43f6d,0xbe953f753f7bbe48,0x3f713eacbe48bf7b,0xbe16bf7dbf463f22
.quad 0x3f353f350000bf80,0x3f35bf35bf800000,0xbf78be793f0e3f55,0xbeac3f713f62bef1,0x3f75be95bf6dbec4,0xbdc9bf7fbf0e3f55,0xbf2c3f3e3f7bbe48,0x3f043f5c3dc9bf7f
.quad 0xbf6d3ec43f800000,0xbec43f6d3f35bf35,0x3f18bf4ebf553f0e,0xbd49bf80be953f75,0xbdc93f7f3ec4bf6d,0x3ef13f62be48bf7b,0xbedbbf673e483f7b,0xbf4ebf183f223f46
.quad 0xbf80000000003f80,0x3f8000000000bf80,0x3f71beacbec4bf6d,0xbf783e793e953f75,0xbf463f223f353f35,0x3f62bef1bf0ebf55,0x3f04bf5cbf6dbec4,0xbf3e3f2c3f463f22
.quad 0x3f6d3ec40000bf80,0xbec4bf6dbf353f35,0xbf80bd493ec43f6d,0x3f183f4e3ef1bf62,0x3f75be95bf35bf35,0xbf46bf22be483f7b,0xbf4e3f183f6d3ec4,0x3f673edbbdc9bf7f
.quad 0xbf35bf3500003f80,0xbf353f353f800000,0x3f673edbbec4bf6d,0x3f04bf5cbf753e95,0xbf7fbdc93f353f35,0xbe953f753f55bf0e,0x3f78be79bf6dbec4,0x3d49bf80bf223f46
.quad 0x3ec43f6d0000bf80,0x3f6d3ec4bf35bf35,0xbf2cbf3e3ec43f6d,0xbf7dbe163f623ef1,0x3f623ef1bf35bf35,0x3f7fbdc9bf7bbe48,0xbf7dbe163f6d3ec4,0xbf713eac3f7fbdc9
.quad 0xbf80000000003f80,0x3f8000000000bf80,0x3f7dbe16be48bf7b,0xbf803d493dc93f7f,0xbf753e953ec43f6d,0x3f7fbdc9be48bf7b,0x3f67bedbbf0ebf55,0xbf7d3e163e953f75
.quad 0xbec43f6d3f800000,0x3f6dbec4bf35bf35,0x3e79bf78bf7b3e48,0xbf673edb3f463f22,0xbdc93f7f3f6dbec4,0x3f62bef1bf55bf0e,0xbd49bf80bf553f0e,0xbf5c3f043f623ef1
.quad 0x3f353f350000bf80,0x3f35bf35bf800000,0xbf4ebf183e483f7b,0xbf2c3f3e3f7fbdc9,0x3f623ef1bec4bf6d,0x3f22bf46bf7b3e48,0xbf71beac3f0e3f55,0xbf183f4e3f75be95
.quad 0x3f6dbec4bf800000,0x3ec4bf6dbf353f35,0xbf5c3f043f7bbe48,0xbeac3f713f22bf46,0x3f46bf22bf6d3ec4,0x3e95bf75bf0e3f55,0xbf2c3f3e3f55bf0e,0xbe793f783ef1bf62
.quad 0xbf7bbe483f803f80,0x3f553f0e3ec4bf6d,0xbf78be79bf803f80,0x3f3e3f2c3ef1bf62,0xbf75be953f803f80,0x3f223f463f0ebf55,0xbf71beacbf803f80,0x3f043f5c3f22bf46
.quad 0xbf55bf0e3f803f80,0xbe483f7b3f6dbec4,0xbf4ebf18bf803f80,0xbeac3f713f75be95,0xbf46bf223f803f80,0xbef13f623f7bbe48,0xbf3ebf2cbf803f80,0xbf183f4e3f7fbdc9
.quad 0xbf0ebf553f803f80,0xbf7b3e483f6d3ec4,0xbf04bf5cbf803f80,0xbf803d493f623ef1,0xbef1bf623f803f80,0xbf7fbdc93f553f0e,0xbedbbf67bf803f80,0xbf78be793f463f22
.quad 0xbe48bf7b3f803f80,0xbf0ebf553ec43f6d,0xbe16bf7dbf803f80,0xbedbbf673e953f75,0xbdc9bf7f3f803f80,0xbe95bf753e483f7b,0xbd49bf80bf803f80,0xbe16bf7d3dc93f7f
.quad 0xbf0ebf55bf353f35,0x3e483f7b3f6dbec4,0xbeacbf71bf553f0e,0xbe163f7d3f7fbdc9,0xbdc9bf7fbf6d3ec4,0xbef13f623f7b3e48,0x3e16bf7dbf7b3e48,0xbf3e3f2c3f623ef1
.quad 0x3f7bbe48bf35bf35,0xbf0ebf55bec43f6d,0x3f803d49bf0ebf55,0xbe79bf78bf223f46,0x3f753e95bec4bf6d,0x3dc9bf7fbf553f0e,0x3f5c3f04be48bf7b,0x3edbbf67bf753e95
.quad 0xbe483f7b3f35bf35,0x3f553f0ebec4bf6d,0xbedb3f673f55bf0e,0x3f183f4ebdc9bf7f,0xbf223f463f6dbec4,0x3e953f753e48bf7b,0xbf4e3f183f7bbe48,0xbd493f803ef1bf62
.quad 0xbf55bf0e3f353f35,0xbf7bbe483f6d3ec4,0xbf2cbf3e3f0e3f55,0xbf5cbf043f463f22,0xbef1bf623ec43f6d,0xbf22bf463f0e3f55,0xbe79bf783e483f7b,0xbeacbf713e953f75
.quad 0x3e48bf7bbf800000,0xbf0e3f553f6d3ec4,0x3f18bf4ebf6dbec4,0xbf673edb3f223f46,0x3f62bef1bf35bf35,0xbf7fbdc93e483f7b,0x3f80bd49bec4bf6d,0xbf4ebf18be953f75
.quad 0xbf0e3f553f800000,0x3f7b3e48bec4bf6d,0xbf5c3f043f6d3ec4,0x3f3e3f2c3dc9bf7f,0xbf7f3dc93f353f35,0x3e953f753f0ebf55,0xbf71beac3ec43f6d,0xbe793f783f62bef1
.quad 0x3f55bf0ebf800000,0xbe48bf7bbec43f6d,0x3f7dbe16bf6dbec4,0x3eacbf71bf463f22,0x3f753e95bf35bf35,0x3f46bf22bf7b3e48,0x3f3e3f2cbec4bf6d,0x3f7dbe16bf75be95
.quad 0xbf7b3e483f800000,0xbf553f0e3f6dbec4,0xbf78be793f6d3ec4,0xbf803d493f7f3dc9,0xbf46bf223f353f35,0xbf62bef13f553f0e,0xbedbbf673ec43f6d,0xbf04bf5c3ef13f62
.quad 0x3f55bf0ebf35bf35,0xbf7b3e483ec43f6d,0x3f803d49be48bf7b,0xbf5cbf04be953f75,0x3f463f223ec4bf6d,0xbe95bf75bf553f0e,0x3e793f783f55bf0e,0x3edbbf67bf7fbdc9
.quad 0xbe48bf7bbf353f35,0xbf553f0e3f6d3ec4,0x3edbbf67bf7b3e48,0xbf7dbe163ef13f62,0x3f62bef1bf6dbec4,0xbf22bf46be483f7b,0x3f7d3e16bf0ebf55,0x3d49bf80bf463f22
.quad 0xbf7bbe483f353f35,0xbf0e3f553f6dbec4,0xbf2cbf3e3e483f7b,0xbf783e793f753e95,0xbdc9bf7fbec43f6d,0xbf62bef13f0e3f55,0x3f04bf5cbf553f0e,0xbeacbf71bdc93f7f
.quad 0xbf0e3f553f35bf35,0xbe483f7b3ec4bf6d,0xbf713eac3f7bbe48,0xbf4e3f183f62bef1,0xbf75be953f6d3ec4,0xbf7fbdc93f7b3e48,0xbf18bf4e3f0e3f55,0xbf2cbf3e3f223f46
.quad 0x3f7b3e480000bf80,0xbf55bf0ebec43f6d,0x3f043f5c3f35bf35,0xbd49bf80bf753e95,0xbe953f753f800000,0x3f46bf22bf55bf0e,0xbf673edb3f353f35,0x3f783e79bdc9bf7f
.quad 0x3f553f0e0000bf80,0x3e48bf7bbf6d3ec4,0x3e163f7d3f35bf35,0x3f67bedbbf62bef1,0xbf223f463f800000,0x3f623ef1be48bf7b,0xbf803d493f353f35,0x3e163f7d3f22bf46
.quad 0x3f0e3f550000bf80,0x3f7bbe48bf6dbec4,0xbe793f783f35bf35,0x3f3e3f2cbe95bf75,0xbf623ef13f800000,0xbdc93f7f3f0ebf55,0xbf71beac3f353f35,0xbf5c3f043f7fbdc9
.quad 0x3e483f7b0000bf80,0x3f0e3f55bec4bf6d,0xbf183f4e3f35bf35,0xbeac3f713ef1bf62,0xbf7f3dc93f800000,0xbf753e953f7bbe48,0xbf3ebf2c3f353f35,0xbf4ebf183f463f22
.quad 0x3f0e3f553f35bf35,0xbe48bf7bbf6d3ec4,0xbedb3f673f7b3e48,0x3f4ebf18bf46bf22,0xbf7f3dc93ec43f6d,0x3f623ef13e48bf7b,0xbf18bf4ebf0e3f55,0xbd493f803f75be95
.quad 0xbf7b3e483f353f35,0x3f0e3f553ec4bf6d,0xbf2cbf3ebe483f7b,0xbf043f5c3f7fbdc9,0x3e95bf75bf6d3ec4,0xbf7fbdc93f0e3f55,0x3f78be79bf55bf0e,0xbeacbf71bef13f62
.quad 0x3e48bf7bbf353f35,0xbf55bf0e3ec43f6d,0x3f71beacbf7bbe48,0x3e16bf7dbf223f46,0x3f463f22bec4bf6d,0x3f75be95bf7bbe48,0xbe163f7d3f0ebf55,0x3f2c3f3ebe95bf75
.quad 0x3f553f0ebf35bf35,0x3f7b3e48bf6dbec4,0xbd493f803e48bf7b,0x3e793f78bdc9bf7f,0xbf623ef13f6dbec4,0xbf463f223f55bf0e,0xbf5cbf043f553f0e,0xbf67bedb3f623ef1
.quad 0xbe483f7b3f800000,0x3f0ebf55bf6dbec4,0xbf7d3e163ec43f6d,0x3f713eac3dc9bf7f,0xbef1bf62bf353f35,0xbdc93f7f3f7bbe48,0x3f2cbf3ebf6dbec4,0xbf7d3e163ef13f62
.quad 0x3f0ebf55bf800000,0xbf7bbe483ec43f6d,0x3f783e79bec4bf6d,0xbd49bf80bf463f22,0x3dc93f7f3f35bf35,0x3f75be95bf55bf0e,0xbf673edb3f6d3ec4,0x3f043f5c3e95bf75
.quad 0xbf553f0e3f800000,0x3e483f7b3ec4bf6d,0xbf4ebf183ec43f6d,0xbf673edb3f7f3dc9,0x3e95bf75bf353f35,0xbf22bf463e483f7b,0x3f80bd49bf6dbec4,0x3f18bf4ebf623ef1
.quad 0x3f7bbe48bf800000,0x3f55bf0ebf6d3ec4,0x3f043f5cbec4bf6d,0x3f3e3f2cbf22bf46,0xbf223f463f35bf35,0xbef13f623f0ebf55,0xbf71beac3f6d3ec4,0xbf78be793f753e95
.quad 0xbf553f0e3f353f35,0x3f7bbe48bec4bf6d,0xbf2cbf3ebf0e3f55,0x3e793f783f62bef1,0x3f22bf46bf6dbec4,0xbf753e953f0e3f55,0x3f5c3f043e48bf7b,0xbeacbf71bf463f22
.quad 0x3e483f7b3f35bf35,0x3f55bf0ebf6dbec4,0xbf713eac3f553f0e,0x3f183f4e3e95bf75,0xbef1bf62bec43f6d,0xbf463f223f7b3e48,0x3f4ebf18bf7bbe48,0xbf2cbf3ebdc93f7f
.quad 0x3f7b3e48bf35bf35,0x3f0ebf55bf6d3ec4,0xbd493f803f0ebf55,0x3f5c3f04bef1bf62,0xbf7f3dc93f6d3ec4,0xbef13f623f55bf0e,0xbe79bf78be483f7b,0xbf67bedb3f223f46
.quad 0x3f0ebf55bf353f35,0x3e48bf7bbec43f6d,0x3f673edbbf55bf0e,0x3f7d3e16bf75be95,0xbe953f753ec4bf6d,0xbdc93f7f3e48bf7b,0xbf7dbe163f7b3e48,0xbf80bd493f7f3dc9
.quad 0xbf7bbe4800003f80,0x3f553f0e3ec4bf6d,0x3e79bf78bf800000,0xbf2c3f3e3f623ef1,0x3f753e950000bf80,0xbf22bf46bf0e3f55,0xbeac3f713f800000,0x3f5cbf04bf46bf22
.quad 0xbf55bf0e00003f80,0xbe483f7b3f6dbec4,0x3f18bf4ebf800000,0xbf71beac3e953f75,0x3f463f220000bf80,0x3ef1bf62bf7b3e48,0xbf2c3f3e3f800000,0x3f4e3f18bdc9bf7f
.quad 0xbf0ebf5500003f80,0xbf7b3e483f6d3ec4,0x3f5cbf04bf800000,0xbd49bf80bef13f62,0x3ef13f620000bf80,0x3f7f3dc9bf55bf0e,0xbf673edb3f800000,0xbe793f783f22bf46
.quad 0xbe48bf7b00003f80,0xbf0ebf553ec43f6d,0x3f7dbe16bf800000,0x3f67bedbbf753e95,0x3dc93f7f0000bf80,0x3e953f75be48bf7b,0xbf803d493f800000,0xbf7d3e163f7fbdc9
.quad 0xbf0ebf55bf353f35,0x3e483f7b3f6dbec4,0x3f71beacbf0ebf55,0xbf7dbe163dc93f7f,0x3dc93f7f3f6dbec4,0x3ef1bf62bf7bbe48,0xbf7dbe163e483f7b,0x3f2c3f3e3ef1bf62
.quad 0x3f7bbe48bf35bf35,0xbf0ebf55bec43f6d,0xbd493f803f55bf0e,0x3f78be79bf46bf22,0xbf75be953ec43f6d,0xbdc93f7f3f55bf0e,0x3f04bf5cbf7b3e48,0xbf67bedb3e953f75
.quad 0xbe483f7b3f35bf35,0x3f553f0ebec4bf6d,0xbf67bedb3f0e3f55,0xbf4e3f183f7fbdc9,0x3f22bf46bf6d3ec4,0xbe95bf75be483f7b,0x3f183f4ebe48bf7b,0x3f803d49bf62bef1
.quad 0xbf55bf0e3f353f35,0xbf7bbe483f6d3ec4,0x3f3ebf2cbf553f0e,0x3f04bf5cbf223f46,0x3ef13f62bec4bf6d,0x3f223f46bf0ebf55,0xbf783e793f7bbe48,0xbf713eac3f75be95
.quad 0x3e48bf7bbf800000,0xbf0e3f553f6d3ec4,0x3f4e3f183ec4bf6d,0xbedbbf67bf463f22,0xbf623ef13f353f35,0x3f7f3dc9be48bf7b,0xbd49bf80bf6d3ec4,0xbf183f4e3f753e95
.quad 0xbf0e3f553f800000,0x3f7b3e48bec4bf6d,0xbf04bf5cbec43f6d,0xbf2c3f3e3f7f3dc9,0x3f7fbdc9bf35bf35,0xbe95bf75bf0e3f55,0xbeac3f713f6dbec4,0x3f783e79bef1bf62
.quad 0x3f55bf0ebf800000,0xbe48bf7bbec43f6d,0x3e163f7d3ec4bf6d,0x3f713eacbf22bf46,0xbf75be953f353f35,0xbf463f223f7bbe48,0x3f2cbf3ebf6d3ec4,0xbe16bf7dbe953f75
.quad 0xbf7b3e483f800000,0xbf553f0e3f6dbec4,0x3e79bf78bec43f6d,0xbd49bf80bdc93f7f,0x3f463f22bf35bf35,0x3f623ef1bf55bf0e,0xbf673edb3f6dbec4,0xbf5c3f043f62bef1
.quad 0x3f55bf0ebf35bf35,0xbf7b3e483ec43f6d,0xbd493f803f7bbe48,0x3f04bf5cbf75be95,0xbf46bf22bec43f6d,0x3e953f753f55bf0e,0x3f78be79bf0ebf55,0xbf67bedbbdc93f7f
.quad 0xbe48bf7bbf353f35,0xbf553f0e3f6d3ec4,0x3f673edbbe48bf7b,0x3e16bf7dbf623ef1,0xbf623ef13f6d3ec4,0x3f223f463e48bf7b,0x3e16bf7dbf553f0e,0xbf80bd493f223f46
.quad 0xbf7bbe483f353f35,0xbf0e3f553f6dbec4,0x3f3ebf2cbf7b3e48,0xbe79bf78be953f75,0x3dc93f7f3ec4bf6d,0x3f623ef1bf0ebf55,0xbf5cbf043f0e3f55,0xbf713eac3f7f3dc9
.quad 0xbf0e3f553f35bf35,0xbe483f7b3ec4bf6d,0xbeacbf713e483f7b,0xbf18bf4e3ef13f62,0x3f753e95bf6dbec4,0x3f7f3dc9bf7bbe48,0xbf4e3f183f55bf0e,0xbf3e3f2c3f46bf22
.quad 0x3f7b3e480000bf80,0xbf55bf0ebec43f6d,0xbf5c3f043f353f35,0x3f80bd49be95bf75,0x3e95bf75bf800000,0xbf463f223f553f0e,0x3edb3f673f35bf35,0x3e79bf78bf7f3dc9
.quad 0x3f553f0e0000bf80,0x3e48bf7bbf6d3ec4,0xbf7d3e163f353f35,0x3edb3f673ef1bf62,0x3f22bf46bf800000,0xbf62bef13e483f7b,0x3d493f803f35bf35,0x3f7dbe16bf46bf22
.quad 0x3f0e3f550000bf80,0x3f7bbe48bf6dbec4,0xbf78be793f353f35,0xbf2c3f3e3f75be95,0x3f62bef1bf800000,0x3dc9bf7fbf0e3f55,0xbeac3f713f35bf35,0x3f043f5cbdc9bf7f
.quad 0x3e483f7b0000bf80,0x3f0e3f55bec4bf6d,0xbf4ebf183f353f35,0xbf71beac3f623ef1,0x3f7fbdc9bf800000,0x3f75be95bf7b3e48,0xbf2c3f3e3f35bf35,0xbf183f4e3f22bf46
.quad 0x3f0e3f553f35bf35,0xbe48bf7bbf6d3ec4,0xbf67bedbbe483f7b,0x3f183f4e3f22bf46,0x3f7fbdc9bec4bf6d,0xbf62bef1be483f7b,0xbf4e3f183f553f0e,0x3f803d49be95bf75
.quad 0xbf7b3e483f353f35,0x3f0e3f553ec4bf6d,0x3f3ebf2cbf7bbe48,0xbf5cbf043dc93f7f,0xbe953f753f6dbec4,0x3f7f3dc9bf0ebf55,0xbe79bf78bf0e3f55,0xbf713eac3f623ef1
.quad 0x3e48bf7bbf353f35,0xbf55bf0e3ec43f6d,0x3eac3f713e48bf7b,0x3f7d3e16bf46bf22,0xbf46bf223ec43f6d,0xbf753e953f7b3e48,0x3f7d3e16bf55bf0e,0x3f3ebf2cbf753e95
.quad 0x3f553f0ebf35bf35,0x3f7b3e48bf6dbec4,0xbf80bd493f7b3e48,0xbf783e793f7fbdc9,0x3f62bef1bf6d3ec4,0x3f46bf22bf553f0e,0xbf043f5c3f0ebf55,0xbedb3f673ef1bf62
.quad 0xbe483f7b3f800000,0x3f0ebf55bf6dbec4,0xbe16bf7dbf6d3ec4,0xbeac3f713f7f3dc9,0x3ef13f623f35bf35,0x3dc9bf7fbf7b3e48,0xbf3ebf2cbec43f6d,0x3e163f7d3f62bef1
.quad 0x3f0ebf55bf800000,0xbf7bbe483ec43f6d,0xbe793f783f6dbec4,0x3f80bd49bf22bf46,0xbdc9bf7fbf353f35,0xbf753e953f553f0e,0x3edb3f673ec4bf6d,0x3f5cbf04bf75be95
.quad 0xbf553f0e3f800000,0x3e483f7b3ec4bf6d,0x3f18bf4ebf6d3ec4,0xbedbbf67bdc93f7f,0xbe953f753f35bf35,0x3f223f46be48bf7b,0xbd49bf80bec43f6d,0xbf4ebf183ef13f62
.quad 0x3f7bbe48bf800000,0x3f55bf0ebf6d3ec4,0xbf5c3f043f6dbec4,0xbf2c3f3e3f46bf22,0x3f22bf46bf353f35,0x3ef1bf62bf0e3f55,0xbeac3f713ec4bf6d,0xbe793f783e95bf75
.quad 0xbf553f0e3f353f35,0x3f7bbe48bec4bf6d,0x3f3ebf2cbf55bf0e,0xbf783e793ef13f62,0xbf223f463f6d3ec4,0x3f75be95bf0ebf55,0x3f04bf5cbf7bbe48,0xbf713eac3f223f46
.quad 0x3e483f7b3f35bf35,0x3f55bf0ebf6dbec4,0xbeacbf71bf0e3f55,0xbf4e3f183f753e95,0x3ef13f623ec4bf6d,0x3f46bf22bf7bbe48,0xbf18bf4ebe483f7b,0xbf3e3f2c3f7f3dc9
.quad 0x3f7b3e48bf35bf35,0x3f0ebf55bf6d3ec4,0xbf80bd493f553f0e,0xbf043f5c3f62bef1,0x3f7fbdc9bf6dbec4,0x3ef1bf62bf553f0e,0xbf783e793f7b3e48,0xbedb3f673f46bf22
.quad 0x3f0ebf55bf353f35,0x3e48bf7bbec43f6d,0xbedb3f673f0ebf55,0xbe163f7d3e95bf75,0x3e95bf75bec43f6d,0x3dc9bf7fbe483f7b,0xbe163f7d3e48bf7b,0xbd493f803dc9bf7f
.quad 0xbf803f803f80,0xbf8000003f80,0x3d49bf80bf803f80,0x3e16bf7dbdc93f7f,0x3dc9bf7f3f803f80,0x3e95bf75be483f7b,0x3e16bf7dbf803f80,0x3edbbf67be953f75
.quad 0x3ec4bf6d3f803f80,0x3f6dbec4bf353f35,0x3edbbf67bf803f80,0x3f78be79bf463f22,0x3ef1bf623f803f80,0x3f7fbdc9bf553f0e,0x3f04bf5cbf803f80,0x3f803d49bf623ef1
.quad 0x3f35bf353f803f80,0x3f353f35bf800000,0x3f3ebf2cbf803f80,0x3f183f4ebf7fbdc9,0x3f46bf223f803f80,0x3ef13f62bf7bbe48,0x3f4ebf18bf803f80,0x3eac3f71bf75be95
.quad 0x3f6dbec43f803f80,0xbec43f6dbf35bf35,0x3f71beacbf803f80,0xbf043f5cbf22bf46,0x3f75be953f803f80,0xbf223f46bf0ebf55,0x3f78be79bf803f80,0xbf3e3f2cbef1bf62
.quad 0xbf8000003f80,0xbf8000003f80,0x3e79bf78be483f7b,0x3eacbf71be953f75,0x3ef1bf62bec43f6d,0x3f22bf46bf0e3f55,0x3f2cbf3ebf0e3f55,0x3f5cbf04bf463f22
.quad 0x3f6d3ec4bf800000,0x3ec43f6dbf35bf35,0x3f4e3f18bf7bbe48,0x3d493f80bef1bf62,0x3f223f46bf6dbec4,0xbe953f75be48bf7b,0x3edb3f67bf55bf0e,0xbf183f4e3dc9bf7f
.quad 0xbf353f350000bf80,0xbf35bf353f800000,0xbf5c3f043e48bf7b,0xbedbbf673f753e95,0xbf753e953ec4bf6d,0xbdc9bf7f3f553f0e,0xbf803d493f0ebf55,0x3e79bf783f223f46
.quad 0xbec4bf6d3f800000,0x3f6d3ec4bf353f35,0xbe16bf7d3f7b3e48,0x3f3e3f2cbf623ef1,0x3dc9bf7f3f6d3ec4,0x3ef13f62bf7b3e48,0x3eacbf713f553f0e,0x3e163f7dbf7fbdc9
.quad 0xbf8000003f80,0xbf8000003f80,0x3edbbf67bec43f6d,0x3f04bf5cbef13f62,0x3f46bf22bf353f35,0x3f62bef1bf553f0e,0x3f78be79bf6d3ec4,0x3f803d49bf7f3dc9
.quad 0xbec43f6d0000bf80,0xbf6d3ec43f35bf35,0xbf3e3f2c3ec4bf6d,0xbf7dbe163f75be95,0xbf753e953f35bf35,0xbf46bf223f7b3e48,0xbf7dbe163f6dbec4,0xbeacbf713f463f22
.quad 0x3f35bf3500003f80,0x3f353f35bf800000,0x3f71beacbec43f6d,0x3e793f78bf62bef1,0x3f7f3dc9bf353f35,0xbe953f75bf0ebf55,0x3f5c3f04bf6d3ec4,0xbf3e3f2cbdc9bf7f
.quad 0xbf6d3ec40000bf80,0x3ec4bf6d3f353f35,0xbf80bd493ec4bf6d,0x3f4ebf183e953f75,0xbf62bef13f35bf35,0x3f7fbdc9be483f7b,0xbf18bf4e3f6dbec4,0x3f673edbbf223f46
.quad 0xbf8000003f80,0xbf8000003f80,0x3f18bf4ebf0e3f55,0x3f2cbf3ebf223f46,0x3f75be95bf6d3ec4,0x3f7fbdc9bf7b3e48,0x3f713eacbf7bbe48,0x3f4e3f18bf62bef1
.quad 0xbf6dbec43f800000,0xbec4bf6d3f353f35,0xbf04bf5c3f553f0e,0x3eacbf713dc93f7f,0x3dc9bf7f3ec43f6d,0x3f62bef1bf0e3f55,0x3f2cbf3ebe483f7b,0x3f783e79bf753e95
.quad 0xbf353f350000bf80,0xbf35bf353f800000,0xbf7d3e163f0ebf55,0xbd49bf803f463f22,0xbf62bef13f6dbec4,0x3f22bf463e483f7b,0xbedbbf673f7b3e48,0x3f7dbe16bef13f62
.quad 0x3ec43f6dbf800000,0xbf6dbec43f35bf35,0xbe793f78bf55bf0e,0xbedbbf673f7fbdc9,0xbf463f22bec4bf6d,0x3e95bf753f553f0e,0xbf803d493e48bf7b,0x3f5cbf043e953f75
.quad 0xbf8000003f80,0xbf8000003f80,0x3f3ebf2cbf353f35,0x3f4ebf18bf463f22,0x3f7f3dc9bf800000,0x3f753e95bf7bbe48,0x3f183f4ebf35bf35,0x3eac3f71bef1bf62
.quad 0x3ec4bf6d00003f80,0x3f6dbec4bf353f35,0x3f71beacbf353f35,0x3f5c3f04bf7fbdc9,0x3f623ef1bf800000,0x3dc93f7fbf0ebf55,0x3e793f78bf35bf35,0xbf3e3f2c3e95bf75
.quad 0x3f35bf3500003f80,0x3f353f35bf800000,0x3f803d49bf353f35,0xbe163f7dbf22bf46,0x3f223f46bf800000,0xbf623ef13e48bf7b,0xbe163f7dbf35bf35,0xbf67bedb3f62bef1
.quad 0x3f6dbec400003f80,0xbec43f6dbf35bf35,0x3f673edbbf353f35,0xbf783e793dc9bf7f,0x3e953f75bf800000,0xbf46bf223f55bf0e,0xbf043f5cbf35bf35,0x3d49bf803f753e95
.quad 0xbf8000003f80,0xbf8000003f80,0x3f5cbf04bf553f0e,0x3f67bedbbf623ef1,0x3f623ef1bf6dbec4,0x3f463f22bf55bf0e,0x3d493f80be48bf7b,0xbe793f783dc9bf7f
.quad 0x3f6d3ec4bf800000,0x3ec43f6dbf35bf35,0x3e163f7dbf0ebf55,0xbf2c3f3e3e95bf75,0xbf463f223ec4bf6d,0xbf75be953f7bbe48,0xbf71beac3f7bbe48,0xbe16bf7d3f223f46
.quad 0xbf353f350000bf80,0xbf35bf353f800000,0xbf78be793f55bf0e,0x3eacbf713ef13f62,0xbe95bf753f6d3ec4,0x3f7fbdc9bf0e3f55,0x3f2cbf3e3e483f7b,0x3f043f5cbf7fbdc9
.quad 0xbec4bf6d3f800000,0x3f6d3ec4bf353f35,0x3f18bf4e3f0e3f55,0x3d493f80bf75be95,0x3f7f3dc9bec43f6d,0xbf623ef1be48bf7b,0x3edb3f67bf7b3e48,0xbf4ebf183f46bf22
.quad 0xbf8000003f80,0xbf8000003f80,0x3f71beacbf6d3ec4,0x3f78be79bf753e95,0x3f223f46bf35bf35,0x3ef13f62bf0ebf55,0xbf043f5c3ec4bf6d,0xbf3e3f2c3f22bf46
.quad 0xbec43f6d0000bf80,0xbf6d3ec43f35bf35,0xbf80bd493f6dbec4,0xbf18bf4e3f623ef1,0xbe95bf753f353f35,0x3f22bf46be483f7b,0x3f4ebf18bec43f6d,0x3f673edbbf7f3dc9
.quad 0x3f35bf3500003f80,0x3f353f35bf800000,0x3f673edbbf6d3ec4,0xbf043f5cbe95bf75,0xbdc93f7fbf35bf35,0xbf75be953f55bf0e,0xbf783e793ec4bf6d,0x3d49bf803f463f22
.quad 0xbf6d3ec40000bf80,0x3ec4bf6d3f353f35,0xbf2cbf3e3f6dbec4,0x3f7d3e16bef13f62,0x3ef1bf623f353f35,0x3dc93f7fbf7bbe48,0x3f7d3e16bec43f6d,0xbf713eacbdc9bf7f
.quad 0xbf8000003f80,0xbf8000003f80,0x3f7dbe16bf7b3e48,0x3f80bd49bf7f3dc9,0x3e953f75bec4bf6d,0x3dc93f7fbe48bf7b,0xbf673edb3f55bf0e,0xbf7d3e163f75be95
.quad 0xbf6dbec43f800000,0xbec4bf6d3f353f35,0x3e79bf783e483f7b,0x3f67bedbbf223f46,0x3f7f3dc9bf6d3ec4,0x3ef13f62bf55bf0e,0x3d493f80bf0ebf55,0xbf5c3f043ef1bf62
.quad 0xbf353f350000bf80,0xbf35bf353f800000,0xbf4ebf183f7bbe48,0x3f2cbf3e3dc93f7f,0x3ef1bf623ec43f6d,0x3f463f22bf7b3e48,0x3f713eacbf553f0e,0xbf183f4ebe95bf75
.quad 0x3ec43f6dbf800000,0xbf6dbec43f35bf35,0xbf5c3f04be48bf7b,0x3eacbf713f463f22,0xbf22bf463f6dbec4,0x3f753e95bf0e3f55,0x3f2cbf3e3f0e3f55,0xbe793f78bf62bef1
.quad 0xbf8000003f80,0xbf8000003f80,0x3f803d49bf800000,0x3f7d3e16bf7fbdc9,0xbdc93f7f0000bf80,0xbe953f753e48bf7b,0xbf7dbe163f800000,0xbf67bedb3f753e95
.quad 0x3ec4bf6d00003f80,0x3f6dbec4bf353f35,0x3f673edbbf800000,0x3e793f78bf22bf46,0xbef13f620000bf80,0xbf7f3dc93f55bf0e,0xbf5cbf043f800000,0x3d49bf803ef13f62
.quad 0x3f35bf3500003f80,0x3f353f35bf800000,0x3f2c3f3ebf800000,0xbf4e3f183dc9bf7f,0xbf463f220000bf80,0xbef1bf623f7b3e48,0xbf18bf4e3f800000,0x3f71beacbe953f75
.quad 0x3f6dbec400003f80,0xbec43f6dbf35bf35,0x3eac3f71bf800000,0xbf5cbf043f46bf22,0xbf753e950000bf80,0x3f22bf463f0e3f55,0xbe79bf783f800000,0x3f2c3f3ebf623ef1
.quad 0xbf8000003f80,0xbf8000003f80,0x3f783e79bf7bbe48,0x3f713eacbf75be95,0xbef13f623ec4bf6d,0xbf223f463f0ebf55,0xbf3ebf2c3f553f0e,0xbf04bf5c3f223f46
.quad 0x3f6d3ec4bf800000,0x3ec43f6dbf35bf35,0xbf183f4e3e48bf7b,0xbf803d493f62bef1,0xbf22bf463f6d3ec4,0x3e95bf753e483f7b,0x3f67bedbbf0e3f55,0x3f4e3f18bf7fbdc9
.quad 0xbf353f350000bf80,0xbf35bf353f800000,0xbf04bf5c3f7b3e48,0x3f67bedbbe953f75,0x3f75be95bec43f6d,0x3dc93f7fbf55bf0e,0x3d493f80bf55bf0e,0xbf78be793f46bf22
.quad 0xbec4bf6d3f800000,0x3f6d3ec4bf353f35,0x3f7dbe16be483f7b,0xbf2c3f3ebef1bf62,0xbdc93f7fbf6dbec4,0xbef1bf623f7bbe48,0xbf71beac3f0ebf55,0x3f7dbe16bdc93f7f
.quad 0xbf8000003f80,0xbf8000003f80,0x3f673edbbf6dbec4,0x3f5c3f04bf62bef1,0xbf463f223f35bf35,0xbf623ef13f55bf0e,0xbe79bf783ec43f6d,0x3d49bf803dc93f7f
.quad 0xbec43f6d0000bf80,0xbf6d3ec43f35bf35,0xbf2cbf3e3f6d3ec4,0x3e16bf7d3e953f75,0x3f75be95bf353f35,0x3f463f22bf7bbe48,0xbe163f7dbec4bf6d,0xbf713eac3f22bf46
.quad 0x3f35bf3500003f80,0x3f353f35bf800000,0x3eac3f71bf6dbec4,0xbf783e793ef1bf62,0xbf7fbdc93f35bf35,0x3e95bf753f0e3f55,0x3f04bf5c3ec43f6d,0x3f2c3f3ebf7f3dc9
.quad 0xbf6d3ec40000bf80,0x3ec4bf6d3f353f35,0x3d49bf803f6d3ec4,0x3f183f4ebf753e95,0x3f623ef1bf353f35,0xbf7f3dc93e48bf7b,0xbf4e3f18bec4bf6d,0x3edbbf673f463f22
.quad 0xbf8000003f80,0xbf8000003f80,0x3f4e3f18bf55bf0e,0x3f3e3f2cbf46bf22,0xbf753e953f6dbec4,0xbf7f3dc93f7bbe48,0x3eacbf71be483f7b,0x3f18bf4ebef13f62
.quad 0xbf6dbec43f800000,0xbec4bf6d3f353f35,0x3f5cbf04bf0e3f55,0x3f713eacbf7f3dc9,0xbdc93f7fbec4bf6d,0xbf623ef13f0ebf55,0xbf3ebf2c3f7b3e48,0x3e79bf783e953f75
.quad 0xbf353f350000bf80,0xbf35bf353f800000,0xbe16bf7d3f553f0e,0x3f80bd49bf223f46,0x3f623ef1bf6d3ec4,0xbf223f46be48bf7b,0xbf673edb3e48bf7b,0xbe16bf7d3f623ef1
.quad 0x3ec43f6dbf800000,0xbf6dbec43f35bf35,0xbf78be793f0ebf55,0x3f67bedb3dc93f7f,0x3f46bf223ec43f6d,0xbe953f75bf55bf0e,0x3d493f80bf7bbe48,0xbf04bf5c3f75be95
.quad 0xbf8000003f80,0xbf8000003f80,0x3f2c3f3ebf35bf35,0x3f183f4ebf22bf46,0xbf7fbdc93f800000,0xbf75be953f7b3e48,0x3f4ebf18bf353f35,0x3f71beacbf623ef1
.quad 0x3ec4bf6d00003f80,0x3f6dbec4bf353f35,0x3eac3f71bf35bf35,0xbf043f5c3dc9bf7f,0xbf62bef13f800000,0xbdc9bf7f3f0e3f55,0x3f78be79bf353f35,0x3f2c3f3ebf75be95
.quad 0x3f35bf3500003f80,0x3f353f35bf800000,0xbd493f80bf35bf35,0xbf7dbe163f46bf22,0xbf22bf463f800000,0x3f62bef1be483f7b,0x3f7d3e16bf353f35,0xbedb3f67bef1bf62
.quad 0x3f6dbec400003f80,0xbec43f6dbf35bf35,0xbedb3f67bf35bf35,0xbe79bf783f7f3dc9,0xbe95bf753f800000,0x3f463f22bf553f0e,0x3f5c3f04bf353f35,0xbf80bd493e95bf75
.quad 0xbf8000003f80,0xbf8000003f80,0x3f043f5cbf0ebf55,0x3edb3f67bef1bf62,0xbf62bef13f6d3ec4,0xbf46bf223f553f0e,0x3f80bd49bf7b3e48,0x3f783e79bf7fbdc9
.quad 0x3f6d3ec4bf800000,0x3ec43f6dbf35bf35,0xbf7d3e163f55bf0e,0xbf3ebf2c3f753e95,0x3f46bf22bec43f6d,0x3f753e95bf7b3e48,0xbeac3f71be48bf7b,0xbf7d3e163f46bf22
.quad 0xbf353f350000bf80,0xbf35bf353f800000,0x3e79bf783f0e3f55,0x3f713eacbf623ef1,0x3e953f75bf6dbec4,0xbf7f3dc93f0ebf55,0xbf3ebf2c3f7bbe48,0x3f5cbf04bdc93f7f
.quad 0xbec4bf6d3f800000,0x3f6d3ec4bf353f35,0x3f4e3f18bf553f0e,0xbf803d493e95bf75,0xbf7fbdc93ec4bf6d,0x3f62bef13e483f7b,0x3f67bedb3e483f7b,0xbf183f4ebf22bf46
.quad 0xbf8000003f80,0xbf8000003f80,0x3eac3f71bec4bf6d,0x3e793f78be95bf75,0xbf22bf463f353f35,0xbef1bf623f0e3f55,0x3f5c3f04bf6dbec4,0x3f2c3f3ebf46bf22
.quad 0xbec43f6d0000bf80,0xbf6d3ec43f35bf35,0x3d49bf803ec43f6d,0x3f4ebf18bef13f62,0x3e953f75bf35bf35,0xbf223f463e48bf7b,0xbf18bf4e3f6d3ec4,0x3edbbf673dc93f7f
.quad 0x3f35bf3500003f80,0x3f353f35bf800000,0xbedb3f67bec4bf6d,0xbf5cbf043f75be95,0x3dc9bf7f3f353f35,0x3f753e95bf553f0e,0x3e793f78bf6dbec4,0xbf80bd493f22bf46
.quad 0xbf6d3ec40000bf80,0x3ec4bf6d3f353f35,0x3f3ebf2c3ec43f6d,0xbe163f7dbf62bef1,0xbef13f62bf35bf35,0xbdc9bf7f3f7b3e48,0x3e16bf7d3f6d3ec4,0x3eac3f71bf7f3dc9
.quad 0xbf8000003f80,0xbf8000003f80,0x3e163f7dbe48bf7b,0x3d493f80bdc9bf7f,0xbe95bf753ec43f6d,0xbdc9bf7f3e483f7b,0x3edb3f67bf0ebf55,0x3e163f7dbe95bf75
.quad 0xbf6dbec43f800000,0xbec4bf6d3f353f35,0x3f783e79bf7b3e48,0x3edb3f67bf46bf22,0xbf7fbdc93f6dbec4,0xbef1bf623f553f0e,0x3f80bd49bf553f0e,0x3f043f5cbf62bef1
.quad 0xbf353f350000bf80,0xbf35bf353f800000,0x3f18bf4e3e483f7b,0x3f3e3f2cbf7f3dc9,0xbef13f62bec4bf6d,0xbf46bf223f7bbe48,0x3eacbf713f0e3f55,0x3f4e3f18bf753e95
.quad 0x3ec43f6dbf800000,0xbf6dbec43f35bf35,0xbf04bf5c3f7bbe48,0x3f713eacbf223f46,0x3f223f46bf6d3ec4,0xbf75be953f0ebf55,0xbf3ebf2c3f55bf0e,0x3f783e79bef13f62
.quad 0x3e48bf7b3f803f80,0x3f0ebf55bec43f6d,0x3e79bf78bf803f80,0x3f2cbf3ebef13f62,0x3e95bf753f803f80,0x3f46bf22bf0e3f55,0x3eacbf71bf803f80,0x3f5cbf04bf223f46
.quad 0x3f0ebf553f803f80,0x3f7b3e48bf6d3ec4,0x3f18bf4ebf803f80,0x3f713eacbf753e95,0x3f22bf463f803f80,0x3f623ef1bf7b3e48,0x3f2cbf3ebf803f80,0x3f4e3f18bf7f3dc9
.quad 0x3f55bf0e3f803f80,0x3e483f7bbf6dbec4,0x3f5cbf04bf803f80,0x3d493f80bf62bef1,0x3f62bef13f803f80,0xbdc93f7fbf55bf0e,0x3f67bedbbf803f80,0xbe793f78bf46bf22
.quad 0x3f7bbe483f803f80,0xbf553f0ebec4bf6d,0x3f7dbe16bf803f80,0xbf673edbbe95bf75,0x3f7fbdc93f803f80,0xbf753e95be48bf7b,0x3f80bd49bf803f80,0xbf7d3e16bdc9bf7f
.quad 0x3f55bf0ebf353f35,0x3f7bbe48bf6d3ec4,0x3f71beacbf553f0e,0x3f7d3e16bf7f3dc9,0x3f7fbdc9bf6d3ec4,0x3f623ef1bf7bbe48,0x3f7d3e16bf7b3e48,0x3f2c3f3ebf62bef1
.quad 0x3e483f7bbf35bf35,0xbf553f0e3ec4bf6d,0xbd493f80bf0ebf55,0xbf783e793f22bf46,0xbe953f75bec4bf6d,0xbf7fbdc93f55bf0e,0xbf043f5cbe48bf7b,0xbf67bedb3f75be95
.quad 0xbf7bbe483f35bf35,0x3f0ebf553ec43f6d,0xbf67bedb3f55bf0e,0x3f4ebf183dc93f7f,0xbf46bf223f6dbec4,0x3f75be95be483f7b,0xbf18bf4e3f7bbe48,0x3f803d49bef13f62
.quad 0x3f0ebf553f353f35,0xbe483f7bbf6dbec4,0x3f3ebf2c3f0e3f55,0xbf043f5cbf46bf22,0x3f62bef13ec43f6d,0xbf463f22bf0ebf55,0x3f78be793e483f7b,0xbf713eacbe95bf75
.quad 0x3f7b3e48bf800000,0x3f553f0ebf6dbec4,0x3f4e3f18bf6dbec4,0x3edb3f67bf22bf46,0x3ef13f62bf35bf35,0xbdc93f7fbe48bf7b,0x3d493f80bec4bf6d,0xbf183f4e3e95bf75
.quad 0xbf55bf0e3f800000,0x3e48bf7b3ec43f6d,0xbf04bf5c3f6d3ec4,0x3f2cbf3ebdc93f7f,0xbdc9bf7f3f353f35,0x3f75be95bf0e3f55,0x3eacbf713ec43f6d,0x3f783e79bf623ef1
.quad 0x3f0e3f55bf800000,0xbf7b3e483ec4bf6d,0x3e163f7dbf6dbec4,0xbf71beac3f46bf22,0xbe953f75bf35bf35,0xbf22bf463f7bbe48,0xbf2c3f3ebec4bf6d,0xbe16bf7d3f753e95
.quad 0xbe48bf7b3f800000,0x3f0e3f55bf6d3ec4,0x3e79bf783f6d3ec4,0x3d493f80bf7fbdc9,0x3f22bf463f353f35,0xbef13f62bf55bf0e,0x3f67bedb3ec43f6d,0xbf5c3f04bef1bf62
.quad 0x3f0e3f55bf35bf35,0x3e483f7bbec4bf6d,0xbd493f80be48bf7b,0xbf043f5c3e95bf75,0xbf223f463ec4bf6d,0xbf753e953f55bf0e,0xbf783e793f55bf0e,0xbf67bedb3f7f3dc9
.quad 0x3f7bbe48bf353f35,0x3f0e3f55bf6dbec4,0x3f673edbbf7b3e48,0xbe163f7dbef1bf62,0x3ef13f62bf6dbec4,0xbf463f223e48bf7b,0xbe163f7dbf0ebf55,0xbf80bd493f46bf22
.quad 0x3e48bf7b3f353f35,0x3f553f0ebf6d3ec4,0x3f3ebf2c3e483f7b,0x3e793f78bf75be95,0x3f7fbdc9bec43f6d,0xbef13f62bf0ebf55,0x3f5c3f04bf553f0e,0xbf713eac3dc9bf7f
.quad 0xbf55bf0e3f35bf35,0x3f7b3e48bec43f6d,0xbeacbf713f7bbe48,0x3f183f4ebf623ef1,0x3e95bf753f6d3ec4,0xbdc93f7fbf7bbe48,0x3f4ebf183f0e3f55,0xbf3e3f2cbf22bf46
.quad 0xbe483f7b0000bf80,0xbf0e3f553ec4bf6d,0xbf5c3f043f35bf35,0xbf803d493f75be95,0xbf75be953f800000,0xbf22bf463f553f0e,0xbedbbf673f353f35,0x3e79bf783dc93f7f
.quad 0xbf0e3f550000bf80,0xbf7bbe483f6dbec4,0xbf7d3e163f35bf35,0xbedbbf673f623ef1,0xbf46bf223f800000,0x3ef1bf623e483f7b,0xbd49bf803f353f35,0x3f7dbe16bf223f46
.quad 0xbf553f0e0000bf80,0xbe48bf7b3f6d3ec4,0xbf78be793f35bf35,0x3f2cbf3e3e953f75,0xbef1bf623f800000,0x3f7f3dc9bf0e3f55,0x3eacbf713f353f35,0x3f043f5cbf7f3dc9
.quad 0xbf7b3e480000bf80,0x3f55bf0e3ec43f6d,0xbf4ebf183f35bf35,0x3f713eacbef13f62,0xbdc9bf7f3f800000,0x3e953f75bf7b3e48,0x3f2cbf3e3f353f35,0xbf183f4ebf46bf22
.quad 0xbf553f0e3f35bf35,0xbf7b3e483f6dbec4,0xbf67bedb3f7b3e48,0xbf18bf4e3f463f22,0xbdc9bf7f3ec43f6d,0x3ef1bf62be483f7b,0x3f4ebf18bf0e3f55,0x3f803d49bf753e95
.quad 0xbe48bf7b3f353f35,0x3f55bf0ebec43f6d,0x3f3ebf2cbe483f7b,0x3f5c3f04bf7f3dc9,0x3f753e95bf6d3ec4,0xbdc93f7fbf0ebf55,0x3e793f78bf55bf0e,0xbf713eac3ef1bf62
.quad 0x3f7b3e48bf353f35,0xbf0e3f55bec4bf6d,0x3eac3f71bf7bbe48,0xbf7dbe163f22bf46,0xbf223f46bec4bf6d,0xbe95bf753f7b3e48,0xbf7dbe163f0ebf55,0x3f3ebf2c3e953f75
.quad 0xbf0e3f55bf35bf35,0x3e48bf7b3f6d3ec4,0xbf80bd493e48bf7b,0x3f78be793dc93f7f,0xbef1bf623f6dbec4,0x3f223f46bf553f0e,0x3f04bf5c3f553f0e,0xbedb3f67bf62bef1
.quad 0xbf7bbe483f800000,0xbf55bf0e3f6d3ec4,0xbe16bf7d3ec43f6d,0x3eacbf71bdc93f7f,0x3f62bef1bf353f35,0x3f7f3dc9bf7b3e48,0x3f3e3f2cbf6dbec4,0x3e163f7dbef1bf62
.quad 0x3f553f0ebf800000,0xbe483f7bbec4bf6d,0xbe793f78bec4bf6d,0xbf803d493f46bf22,0xbf7f3dc93f35bf35,0xbe95bf753f553f0e,0xbedbbf673f6d3ec4,0x3f5cbf04be953f75
.quad 0xbf0ebf553f800000,0x3f7bbe48bec43f6d,0x3f18bf4e3ec43f6d,0x3edb3f67bf7fbdc9,0x3f753e95bf353f35,0xbf463f22be48bf7b,0x3d493f80bf6dbec4,0xbf4ebf183f62bef1
.quad 0x3e483f7bbf800000,0xbf0ebf553f6dbec4,0xbf5c3f04bec4bf6d,0x3f2cbf3e3f223f46,0xbf46bf223f35bf35,0x3f623ef1bf0e3f55,0x3eacbf713f6d3ec4,0xbe793f78bf75be95
.quad 0xbf0ebf553f353f35,0xbe48bf7b3ec43f6d,0x3f3ebf2cbf0e3f55,0x3f78be79bf623ef1,0x3f463f22bf6dbec4,0x3e953f75bf0ebf55,0xbf043f5c3e48bf7b,0xbf713eac3f46bf22
.quad 0xbf7b3e483f35bf35,0xbf0ebf553f6d3ec4,0xbeacbf713f553f0e,0x3f4ebf18be953f75,0x3f62bef1bec43f6d,0x3f223f46bf7bbe48,0x3f183f4ebf7bbe48,0xbf3e3f2c3dc9bf7f
.quad 0xbe483f7bbf35bf35,0xbf55bf0e3f6dbec4,0xbf80bd493f0ebf55,0x3f04bf5c3ef13f62,0xbdc9bf7f3f6d3ec4,0x3f623ef1bf553f0e,0x3f78be79be483f7b,0xbedb3f67bf22bf46
.quad 0x3f553f0ebf353f35,0xbf7bbe483ec4bf6d,0xbedb3f67bf55bf0e,0x3e16bf7d3f753e95,0xbf75be953ec4bf6d,0x3f7f3dc9be483f7b,0x3e16bf7d3f7b3e48,0xbd493f80bf7fbdc9
.quad 0x3e48bf7b00003f80,0x3f0ebf55bec43f6d,0x3f783e79bf800000,0x3f3e3f2cbf62bef1,0xbe953f750000bf80,0xbf463f223f0ebf55,0xbf71beac3f800000,0xbf04bf5c3f463f22
.quad 0x3f0ebf5500003f80,0x3f7b3e48bf6d3ec4,0x3f4e3f18bf800000,0xbeac3f71be95bf75,0xbf223f460000bf80,0xbf62bef13f7bbe48,0xbf3ebf2c3f800000,0x3f18bf4e3dc93f7f
.quad 0x3f55bf0e00003f80,0x3e483f7bbf6dbec4,0x3f043f5cbf800000,0xbf803d493ef1bf62,0xbf623ef10000bf80,0x3dc9bf7f3f553f0e,0xbedbbf673f800000,0x3f783e79bf223f46
.quad 0x3f7bbe4800003f80,0xbf553f0ebec4bf6d,0x3e163f7dbf800000,0xbedbbf673f75be95,0xbf7f3dc90000bf80,0x3f75be953e483f7b,0xbd49bf803f800000,0x3e163f7dbf7f3dc9
.quad 0x3f55bf0ebf353f35,0x3f7bbe48bf6d3ec4,0x3eac3f71bf0ebf55,0xbe163f7dbdc9bf7f,0xbf7f3dc93f6dbec4,0xbf62bef13f7b3e48,0x3e16bf7d3e483f7b,0x3f3ebf2cbef13f62
.quad 0x3e483f7bbf35bf35,0xbf553f0e3ec4bf6d,0xbf80bd493f55bf0e,0xbe79bf783f463f22,0x3e95bf753ec43f6d,0x3f7f3dc9bf553f0e,0x3f5c3f04bf7b3e48,0xbedb3f67be95bf75
.quad 0xbf7bbe483f35bf35,0x3f0ebf553ec43f6d,0x3edbbf673f0e3f55,0x3f183f4ebf7f3dc9,0x3f463f22bf6d3ec4,0xbf753e953e48bf7b,0xbf4e3f18be48bf7b,0x3d49bf803f623ef1
.quad 0x3f0ebf553f353f35,0xbe483f7bbf6dbec4,0x3f2c3f3ebf553f0e,0xbf5cbf043f22bf46,0xbf623ef1bec4bf6d,0x3f46bf223f0e3f55,0xbe79bf783f7bbe48,0x3eac3f71bf753e95
.quad 0x3f7b3e48bf800000,0x3f553f0ebf6dbec4,0xbf183f4e3ec4bf6d,0xbf673edb3f46bf22,0xbef1bf623f353f35,0x3dc9bf7f3e483f7b,0x3f80bd49bf6d3ec4,0x3f4e3f18bf75be95
.quad 0xbf55bf0e3f800000,0x3e48bf7b3ec43f6d,0x3f5cbf04bec43f6d,0x3f3e3f2cbf7fbdc9,0x3dc93f7fbf35bf35,0xbf753e953f0ebf55,0xbf71beac3f6dbec4,0x3e79bf783ef13f62
.quad 0x3f0e3f55bf800000,0xbf7b3e483ec4bf6d,0xbf7d3e163ec4bf6d,0x3eacbf713f223f46,0x3e95bf753f353f35,0x3f223f46bf7b3e48,0x3f3e3f2cbf6d3ec4,0xbf7d3e163e95bf75
.quad 0xbe48bf7b3f800000,0x3f0e3f55bf6d3ec4,0x3f783e79bec43f6d,0xbf803d493dc9bf7f,0xbf223f46bf35bf35,0x3ef1bf623f553f0e,0xbedbbf673f6dbec4,0x3f043f5cbf623ef1
.quad 0x3f0e3f55bf35bf35,0x3e483f7bbec4bf6d,0xbf80bd493f7bbe48,0xbf5cbf043f753e95,0x3f22bf46bec43f6d,0x3f75be95bf553f0e,0x3e793f78bf0ebf55,0xbedb3f673dc9bf7f
.quad 0x3f7bbe48bf353f35,0x3f0e3f55bf6dbec4,0xbedb3f67be48bf7b,0xbf7dbe163f62bef1,0xbef1bf623f6d3ec4,0x3f46bf22be483f7b,0x3f7d3e16bf553f0e,0xbd493f80bf22bf46
.quad 0x3e48bf7b3f353f35,0x3f553f0ebf6d3ec4,0x3f2c3f3ebf7b3e48,0xbf783e793e95bf75,0xbf7f3dc93ec4bf6d,0x3ef1bf623f0e3f55,0x3f04bf5c3f0e3f55,0x3eac3f71bf7fbdc9
.quad 0xbf55bf0e3f35bf35,0x3f7b3e48bec43f6d,0x3f71beac3e483f7b,0xbf4e3f18bef1bf62,0xbe953f75bf6dbec4,0x3dc9bf7f3f7b3e48,0xbf18bf4e3f55bf0e,0x3f2c3f3ebf463f22
.quad 0xbe483f7b0000bf80,0xbf0e3f553ec4bf6d,0xbf04bf5c3f353f35,0xbd49bf803e953f75,0x3f753e95bf800000,0x3f223f46bf55bf0e,0xbf673edb3f35bf35,0xbf78be793f7fbdc9
.quad 0xbf0e3f550000bf80,0xbf7bbe483f6dbec4,0xbe16bf7d3f353f35,0x3f67bedbbef13f62,0x3f463f22bf800000,0xbef13f62be48bf7b,0xbf803d493f35bf35,0xbe16bf7d3f463f22
.quad 0xbf553f0e0000bf80,0xbe48bf7b3f6d3ec4,0x3e79bf783f353f35,0x3f3e3f2cbf753e95,0x3ef13f62bf800000,0xbf7fbdc93f0ebf55,0xbf71beac3f35bf35,0x3f5cbf043dc93f7f
.quad 0xbf7b3e480000bf80,0x3f55bf0e3ec43f6d,0x3f18bf4e3f353f35,0xbeac3f71bf62bef1,0x3dc93f7fbf800000,0xbe95bf753f7bbe48,0xbf3ebf2c3f35bf35,0x3f4e3f18bf223f46
.quad 0xbf553f0e3f35bf35,0xbf7b3e483f6dbec4,0x3edbbf67be483f7b,0x3f4ebf18bf223f46,0x3dc93f7fbec4bf6d,0xbef13f623e48bf7b,0xbf18bf4e3f553f0e,0x3d49bf803e953f75
.quad 0xbe48bf7b3f353f35,0x3f55bf0ebec43f6d,0x3f2c3f3ebf7bbe48,0xbf043f5cbdc9bf7f,0xbf75be953f6dbec4,0x3dc9bf7f3f0e3f55,0x3f78be79bf0e3f55,0x3eac3f71bf62bef1
.quad 0x3f7b3e48bf353f35,0xbf0e3f55bec4bf6d,0xbf713eac3e48bf7b,0x3e16bf7d3f463f22,0x3f22bf463ec43f6d,0x3e953f75bf7bbe48,0xbe163f7dbf55bf0e,0xbf2cbf3e3f75be95
.quad 0xbf0e3f55bf35bf35,0x3e48bf7b3f6d3ec4,0x3d49bf803f7b3e48,0x3e793f78bf7f3dc9,0x3ef13f62bf6d3ec4,0xbf22bf463f55bf0e,0xbf5cbf043f0ebf55,0x3f673edbbef13f62
.quad 0xbf7bbe483f800000,0xbf55bf0e3f6d3ec4,0x3f7dbe16bf6d3ec4,0x3f713eacbf7fbdc9,0xbf623ef13f35bf35,0xbf7fbdc93f7bbe48,0x3f2cbf3ebec43f6d,0x3f7dbe16bf623ef1
.quad 0x3f553f0ebf800000,0xbe483f7bbec4bf6d,0xbf78be793f6dbec4,0xbd49bf803f223f46,0x3f7fbdc9bf353f35,0x3e953f75bf55bf0e,0xbf673edb3ec4bf6d,0xbf04bf5c3f753e95
.quad 0xbf0ebf553f800000,0x3f7bbe48bec43f6d,0x3f4e3f18bf6d3ec4,0xbf673edb3dc9bf7f,0xbf75be953f35bf35,0x3f46bf223e483f7b,0x3f80bd49bec43f6d,0xbf183f4ebef1bf62
.quad 0x3e483f7bbf800000,0xbf0ebf553f6dbec4,0xbf04bf5c3f6dbec4,0x3f3e3f2cbf463f22,0x3f463f22bf353f35,0xbf62bef13f0ebf55,0xbf71beac3ec4bf6d,0x3f783e79be953f75
.quad 0xbf0ebf553f353f35,0xbe48bf7b3ec43f6d,0x3f2c3f3ebf55bf0e,0x3e793f78bef1bf62,0xbf46bf223f6d3ec4,0xbe95bf753f0e3f55,0x3f5c3f04bf7bbe48,0x3eac3f71bf22bf46
.quad 0xbf7b3e483f35bf35,0xbf0ebf553f6d3ec4,0x3f71beacbf0e3f55,0x3f183f4ebf75be95,0xbf623ef13ec4bf6d,0xbf22bf463f7b3e48,0x3f4ebf18be483f7b,0x3f2c3f3ebf7fbdc9
.quad 0xbe483f7bbf35bf35,0xbf55bf0e3f6dbec4,0x3d49bf803f553f0e,0x3f5c3f04bf623ef1,0x3dc93f7fbf6dbec4,0xbf62bef13f55bf0e,0xbe79bf783f7b3e48,0x3f673edbbf463f22
.quad 0x3f553f0ebf353f35,0xbf7bbe483ec4bf6d,0xbf67bedb3f0ebf55,0x3f7d3e16be953f75,0x3f753e95bec43f6d,0xbf7fbdc93e48bf7b,0xbf7dbe163e48bf7b,0x3f803d49bdc93f7f
.quad 0x3f8000003f803f80,0xbf8000000000bf80,0x3f803d49bf803f80,0xbf7dbe163dc9bf7f,0x3f7f3dc93f803f80,0xbf75be953e48bf7b,0x3f7d3e16bf803f80,0xbf67bedb3e95bf75
.quad 0x3f6d3ec43f803f80,0xbec4bf6d3f35bf35,0x3f673edbbf803f80,0xbe79bf783f46bf22,0x3f623ef13f803f80,0xbdc9bf7f3f55bf0e,0x3f5c3f04bf803f80,0x3d49bf803f62bef1
.quad 0x3f353f353f803f80,0x3f35bf353f800000,0x3f2c3f3ebf803f80,0x3f4ebf183f7f3dc9,0x3f223f463f803f80,0x3f62bef13f7b3e48,0x3f183f4ebf803f80,0x3f71beac3f753e95
.quad 0x3ec43f6d3f803f80,0x3f6d3ec43f353f35,0x3eac3f71bf803f80,0x3f5c3f043f223f46,0x3e953f753f803f80,0x3f463f223f0e3f55,0x3e793f78bf803f80,0x3f2c3f3e3ef13f62
.quad 0x3f80000000003f80,0xbf8000000000bf80,0x3f783e79be483f7b,0xbf71beac3e95bf75,0x3f623ef1bec43f6d,0xbf46bf223f0ebf55,0x3f3e3f2cbf0e3f55,0xbf04bf5c3f46bf22
.quad 0xbec43f6dbf800000,0x3f6dbec43f353f35,0xbf183f4ebf7bbe48,0x3f80bd493ef13f62,0xbf463f22bf6dbec4,0x3f753e953e483f7b,0xbf673edbbf55bf0e,0x3f4e3f18bdc93f7f
.quad 0xbf35bf350000bf80,0xbf353f35bf800000,0xbf04bf5c3e48bf7b,0xbf673edbbf75be95,0xbe95bf753ec4bf6d,0xbf7f3dc9bf55bf0e,0xbd49bf803f0ebf55,0xbf78be79bf22bf46
.quad 0x3f6dbec43f800000,0x3ec4bf6d3f35bf35,0x3f7dbe163f7b3e48,0x3f2cbf3e3f62bef1,0x3f7f3dc93f6d3ec4,0x3f62bef13f7bbe48,0x3f713eac3f553f0e,0x3f7dbe163f7f3dc9
.quad 0x3f80000000003f80,0xbf8000000000bf80,0x3f673edbbec43f6d,0xbf5cbf043ef1bf62,0x3f223f46bf353f35,0xbef1bf623f55bf0e,0x3e793f78bf6d3ec4,0x3d49bf803f7fbdc9
.quad 0xbf6dbec40000bf80,0x3ec43f6dbf353f35,0xbf2cbf3e3ec4bf6d,0xbe163f7dbf753e95,0xbe95bf753f35bf35,0xbf223f46bf7bbe48,0x3e16bf7d3f6dbec4,0xbf713eacbf46bf22
.quad 0x3f353f3500003f80,0x3f35bf353f800000,0x3eac3f71bec43f6d,0x3f78be793f623ef1,0xbdc93f7fbf353f35,0x3f753e953f0e3f55,0xbf043f5cbf6d3ec4,0x3f2c3f3e3dc93f7f
.quad 0xbec4bf6d0000bf80,0xbf6dbec4bf35bf35,0x3d49bf803ec4bf6d,0xbf18bf4ebe95bf75,0x3ef1bf623f35bf35,0xbdc9bf7f3e48bf7b,0x3f4ebf183f6dbec4,0x3edbbf673f22bf46
.quad 0x3f80000000003f80,0xbf8000000000bf80,0x3f4e3f18bf0e3f55,0xbf3ebf2c3f22bf46,0x3e953f75bf6d3ec4,0xbdc9bf7f3f7bbe48,0xbeac3f71bf7bbe48,0x3f18bf4e3f623ef1
.quad 0x3ec4bf6d3f800000,0xbf6d3ec4bf35bf35,0x3f5cbf043f553f0e,0xbf71beacbdc9bf7f,0x3f7f3dc93ec43f6d,0xbef1bf623f0ebf55,0x3f3e3f2cbe483f7b,0x3e79bf783f75be95
.quad 0xbf35bf350000bf80,0xbf353f35bf800000,0xbe16bf7d3f0ebf55,0xbf803d49bf46bf22,0x3ef1bf623f6dbec4,0xbf46bf22be48bf7b,0x3f67bedb3f7b3e48,0xbe16bf7d3ef1bf62
.quad 0xbf6d3ec4bf800000,0xbec43f6dbf353f35,0xbf78be79bf55bf0e,0xbf673edbbf7f3dc9,0xbf22bf46bec4bf6d,0xbf75be95bf55bf0e,0xbd49bf803e48bf7b,0xbf04bf5cbe95bf75
.quad 0x3f80000000003f80,0xbf8000000000bf80,0x3f2c3f3ebf353f35,0xbf18bf4e3f46bf22,0xbdc93f7fbf800000,0x3e95bf753f7b3e48,0xbf4e3f18bf35bf35,0x3f71beac3ef13f62
.quad 0x3f6d3ec400003f80,0xbec4bf6d3f35bf35,0x3eac3f71bf353f35,0x3f04bf5c3f7f3dc9,0xbef13f62bf800000,0x3f7fbdc93f0e3f55,0xbf783e79bf35bf35,0x3f2c3f3ebe953f75
.quad 0x3f353f3500003f80,0x3f35bf353f800000,0xbd493f80bf353f35,0x3f7d3e163f223f46,0xbf463f22bf800000,0x3ef13f62be483f7b,0xbf7dbe16bf35bf35,0xbedb3f67bf623ef1
.quad 0x3ec43f6d00003f80,0x3f6d3ec43f353f35,0xbedb3f67bf353f35,0x3e793f78bdc93f7f,0xbf753e95bf800000,0xbf223f46bf553f0e,0xbf5cbf04bf35bf35,0xbf80bd49bf75be95
.quad 0x3f80000000003f80,0xbf8000000000bf80,0x3f043f5cbf553f0e,0xbedbbf673f62bef1,0xbef13f62bf6dbec4,0x3f22bf463f553f0e,0xbf803d49be48bf7b,0x3f783e79bdc93f7f
.quad 0xbec43f6dbf800000,0x3f6dbec43f353f35,0xbf7d3e16bf0ebf55,0x3f3e3f2cbe953f75,0xbf22bf463ec4bf6d,0xbe953f75bf7b3e48,0x3eacbf713f7bbe48,0xbf7d3e16bf22bf46
.quad 0xbf35bf350000bf80,0xbf353f35bf800000,0x3e79bf783f55bf0e,0xbf71beacbef1bf62,0x3f75be953f6d3ec4,0xbdc9bf7f3f0ebf55,0x3f3e3f2c3e483f7b,0x3f5cbf043f7f3dc9
.quad 0x3f6dbec43f800000,0x3ec4bf6d3f35bf35,0x3f4e3f183f0e3f55,0x3f80bd493f753e95,0xbdc93f7fbec43f6d,0x3ef13f623e483f7b,0xbf673edbbf7b3e48,0xbf183f4ebf463f22
.quad 0x3f80000000003f80,0xbf8000000000bf80,0x3eac3f71bf6d3ec4,0xbe79bf783f75be95,0xbf463f22bf35bf35,0x3f62bef13f0e3f55,0xbf5cbf043ec4bf6d,0x3f2c3f3ebf223f46
.quad 0xbf6dbec40000bf80,0x3ec43f6dbf353f35,0x3d49bf803f6dbec4,0xbf4e3f18bf62bef1,0x3f75be953f353f35,0xbf46bf223e48bf7b,0x3f183f4ebec43f6d,0x3edbbf673f7fbdc9
.quad 0x3f353f3500003f80,0x3f35bf353f800000,0xbedb3f67bf6d3ec4,0x3f5c3f043e953f75,0xbf7fbdc9bf35bf35,0xbe953f75bf553f0e,0xbe79bf783ec4bf6d,0xbf80bd49bf46bf22
.quad 0xbec4bf6d0000bf80,0xbf6dbec4bf35bf35,0x3f3ebf2c3f6dbec4,0x3e16bf7d3ef1bf62,0x3f623ef13f353f35,0x3f7fbdc93f7b3e48,0xbe163f7dbec43f6d,0x3eac3f713dc93f7f
.quad 0x3f80000000003f80,0xbf8000000000bf80,0x3e163f7dbf7b3e48,0xbd49bf803f7fbdc9,0xbf753e95bec4bf6d,0x3f7fbdc93e483f7b,0xbedbbf673f55bf0e,0x3e163f7dbf753e95
.quad 0x3ec4bf6d3f800000,0xbf6d3ec4bf35bf35,0x3f783e793e483f7b,0xbedbbf673f22bf46,0xbdc93f7fbf6d3ec4,0x3f62bef13f553f0e,0xbf803d49bf0ebf55,0x3f043f5cbef13f62
.quad 0xbf35bf350000bf80,0xbf353f35bf800000,0x3f18bf4e3f7bbe48,0xbf3ebf2cbdc9bf7f,0x3f623ef13ec43f6d,0x3f22bf463f7bbe48,0xbeac3f71bf553f0e,0x3f4e3f183e953f75
.quad 0xbf6d3ec4bf800000,0xbec43f6dbf353f35,0xbf04bf5cbe48bf7b,0xbf71beacbf46bf22,0x3f46bf223f6dbec4,0x3e95bf753f0ebf55,0x3f3e3f2c3f0e3f55,0x3f783e793f623ef1
.quad 0x3f80000000003f80,0xbf8000000000bf80,0xbd493f80bf800000,0x3e16bf7d3f7f3dc9,0xbf7fbdc90000bf80,0x3f753e95be483f7b,0x3e16bf7d3f800000,0xbedb3f67bf75be95
.quad 0x3f6d3ec400003f80,0xbec4bf6d3f35bf35,0xbedb3f67bf800000,0x3f78be793f223f46,0xbf62bef10000bf80,0x3dc93f7fbf553f0e,0x3f04bf5c3f800000,0xbf80bd49bef1bf62
.quad 0x3f353f3500003f80,0x3f35bf353f800000,0xbf3e3f2cbf800000,0x3f183f4ebdc93f7f,0xbf22bf460000bf80,0xbf623ef1bf7bbe48,0x3f4ebf183f800000,0xbeacbf713e95bf75
.quad 0x3ec43f6d00003f80,0x3f6d3ec43f353f35,0xbf713eacbf800000,0xbf043f5cbf463f22,0xbe95bf750000bf80,0xbf46bf22bf0ebf55,0x3f78be793f800000,0x3f3ebf2c3f62bef1
.quad 0x3f80000000003f80,0xbf8000000000bf80,0xbe793f78bf7bbe48,0x3eacbf713f753e95,0xbf62bef13ec4bf6d,0x3f463f22bf0e3f55,0x3f2cbf3e3f553f0e,0xbf5c3f04bf22bf46
.quad 0xbec43f6dbf800000,0x3f6dbec43f353f35,0xbf4ebf183e48bf7b,0x3d493f80bf623ef1,0x3f46bf223f6d3ec4,0xbf75be95be48bf7b,0x3edb3f67bf0e3f55,0x3f18bf4e3f7f3dc9
.quad 0xbf35bf350000bf80,0xbf353f35bf800000,0x3f5cbf043f7b3e48,0xbedbbf673e95bf75,0x3e953f75bec43f6d,0x3f7fbdc93f553f0e,0xbf803d49bf55bf0e,0xbe793f78bf463f22
.quad 0x3f6dbec43f800000,0x3ec4bf6d3f35bf35,0x3e163f7dbe483f7b,0x3f3e3f2c3ef13f62,0xbf7fbdc9bf6dbec4,0xbf623ef1bf7b3e48,0x3eacbf713f0ebf55,0xbe16bf7d3dc9bf7f
.quad 0x3f80000000003f80,0xbf8000000000bf80,0xbedb3f67bf6dbec4,0x3f04bf5c3f623ef1,0xbf22bf463f35bf35,0x3ef13f62bf553f0e,0x3f78be793ec43f6d,0xbf80bd49bdc9bf7f
.quad 0xbf6dbec40000bf80,0x3ec43f6dbf353f35,0x3f3ebf2c3f6d3ec4,0xbf7dbe16be95bf75,0x3e953f75bf353f35,0x3f22bf463f7b3e48,0xbf7dbe16bec4bf6d,0x3eac3f71bf223f46
.quad 0x3f353f3500003f80,0x3f35bf353f800000,0xbf713eacbf6dbec4,0x3e793f78bef13f62,0x3dc9bf7f3f35bf35,0xbf75be95bf0ebf55,0x3f5c3f043ec43f6d,0x3f3ebf2c3f7fbdc9
.quad 0xbec4bf6d0000bf80,0xbf6dbec4bf35bf35,0x3f803d493f6d3ec4,0x3f4ebf183f75be95,0xbef13f62bf353f35,0x3dc93f7fbe483f7b,0xbf18bf4ebec4bf6d,0xbf67bedbbf46bf22
.quad 0x3f80000000003f80,0xbf8000000000bf80,0xbf183f4ebf55bf0e,0x3f2cbf3e3f463f22,0xbe95bf753f6dbec4,0x3dc93f7fbf7b3e48,0x3f713eacbe483f7b,0xbf4ebf183ef1bf62
.quad 0x3ec4bf6d3f800000,0xbf6d3ec4bf35bf35,0x3f043f5cbf0e3f55,0x3eacbf713f7fbdc9,0xbf7fbdc9bec4bf6d,0x3ef13f62bf0e3f55,0x3f2cbf3e3f7b3e48,0xbf78be79be95bf75
.quad 0xbf35bf350000bf80,0xbf353f35bf800000,0x3f7dbe163f553f0e,0xbd49bf803f22bf46,0xbef13f62bf6d3ec4,0x3f463f223e483f7b,0xbedbbf673e48bf7b,0xbf7d3e16bf62bef1
.quad 0xbf6d3ec4bf800000,0xbec43f6dbf353f35,0x3e79bf783f0ebf55,0xbedbbf67bdc9bf7f,0x3f223f463ec43f6d,0x3f753e953f553f0e,0xbf803d49bf7bbe48,0xbf5c3f04bf753e95
.quad 0x3f80000000003f80,0xbf8000000000bf80,0xbf3e3f2cbf35bf35,0x3f4ebf183f223f46,0x3dc9bf7f3f800000,0xbe953f75bf7bbe48,0x3f183f4ebf353f35,0xbeacbf713f62bef1
.quad 0x3f6d3ec400003f80,0xbec4bf6d3f35bf35,0xbf713eacbf35bf35,0x3f5c3f04bdc93f7f,0x3ef1bf623f800000,0xbf7f3dc9bf0ebf55,0x3e793f78bf353f35,0x3f3ebf2c3f753e95
.quad 0x3f353f3500003f80,0x3f35bf353f800000,0xbf80bd49bf35bf35,0xbe163f7dbf463f22,0x3f46bf223f800000,0xbef1bf623e48bf7b,0xbe163f7dbf353f35,0x3f673edb3ef13f62
.quad 0x3ec43f6d00003f80,0x3f6d3ec43f353f35,0xbf67bedbbf35bf35,0xbf783e79bf7fbdc9,0x3f75be953f800000,0x3f22bf463f55bf0e,0xbf043f5cbf353f35,0xbd493f80be953f75
.quad 0x3f80000000003f80,0xbf8000000000bf80,0xbf5c3f04bf0ebf55,0x3f67bedb3ef13f62,0x3ef1bf623f6d3ec4,0xbf223f46bf55bf0e,0x3d493f80bf7b3e48,0x3e79bf783f7f3dc9
.quad 0xbec43f6dbf800000,0x3f6dbec43f353f35,0xbe16bf7d3f55bf0e,0xbf2c3f3ebf75be95,0x3f223f46bec43f6d,0x3e95bf753f7bbe48,0xbf71beacbe48bf7b,0x3e163f7dbf463f22
.quad 0xbf35bf350000bf80,0xbf353f35bf800000,0x3f783e793f0e3f55,0x3eacbf713f62bef1,0xbf753e95bf6dbec4,0x3dc93f7fbf0e3f55,0x3f2cbf3e3f7bbe48,0xbf04bf5c3dc9bf7f
.quad 0x3f6dbec43f800000,0x3ec4bf6d3f35bf35,0xbf183f4ebf553f0e,0x3d493f80be953f75,0x3dc9bf7f3ec4bf6d,0xbef1bf62be48bf7b,0x3edb3f673e483f7b,0x3f4e3f183f223f46
.quad 0x3f80000000003f80,0xbf8000000000bf80,0xbf713eacbec4bf6d,0x3f78be793e953f75,0x3f46bf223f353f35,0xbf623ef1bf0ebf55,0xbf043f5cbf6dbec4,0x3f3ebf2c3f463f22
.quad 0xbf6dbec40000bf80,0x3ec43f6dbf353f35,0x3f803d493ec43f6d,0xbf18bf4e3ef1bf62,0xbf753e95bf35bf35,0x3f463f22be483f7b,0x3f4ebf183f6d3ec4,0xbf67bedbbdc9bf7f
.quad 0x3f353f3500003f80,0x3f35bf353f800000,0xbf67bedbbec4bf6d,0xbf043f5cbf753e95,0x3f7f3dc93f353f35,0x3e95bf753f55bf0e,0xbf783e79bf6dbec4,0xbd493f80bf223f46
.quad 0xbec4bf6d0000bf80,0xbf6dbec4bf35bf35,0x3f2c3f3e3ec43f6d,0x3f7d3e163f623ef1,0xbf62bef1bf35bf35,0xbf7f3dc9bf7bbe48,0x3f7d3e163f6d3ec4,0x3f71beac3f7fbdc9
.quad 0x3f80000000003f80,0xbf8000000000bf80,0xbf7d3e16be48bf7b,0x3f80bd493dc93f7f,0x3f75be953ec43f6d,0xbf7f3dc9be48bf7b,0xbf673edbbf0ebf55,0x3f7dbe163e953f75
.quad 0x3ec4bf6d3f800000,0xbf6d3ec4bf35bf35,0xbe793f78bf7b3e48,0x3f67bedb3f463f22,0x3dc9bf7f3f6dbec4,0xbf623ef1bf55bf0e,0x3d493f80bf553f0e,0x3f5cbf043f623ef1
.quad 0xbf35bf350000bf80,0xbf353f35bf800000,0x3f4e3f183e483f7b,0x3f2cbf3e3f7fbdc9,0xbf62bef1bec4bf6d,0xbf223f46bf7b3e48,0x3f713eac3f0e3f55,0x3f18bf4e3f75be95
.quad 0xbf6d3ec4bf800000,0xbec43f6dbf353f35,0x3f5cbf043f7bbe48,0x3eacbf713f22bf46,0xbf463f22bf6d3ec4,0xbe953f75bf0e3f55,0x3f2cbf3e3f55bf0e,0x3e79bf783ef1bf62
.quad 0x3f7b3e483f803f80,0xbf55bf0e3ec4bf6d,0x3f783e79bf803f80,0xbf3ebf2c3ef1bf62,0x3f753e953f803f80,0xbf22bf463f0ebf55,0x3f713eacbf803f80,0xbf04bf5c3f22bf46
.quad 0x3f553f0e3f803f80,0x3e48bf7b3f6dbec4,0x3f4e3f18bf803f80,0x3eacbf713f75be95,0x3f463f223f803f80,0x3ef1bf623f7bbe48,0x3f3e3f2cbf803f80,0x3f18bf4e3f7fbdc9
.quad 0x3f0e3f553f803f80,0x3f7bbe483f6d3ec4,0x3f043f5cbf803f80,0x3f80bd493f623ef1,0x3ef13f623f803f80,0x3f7f3dc93f553f0e,0x3edb3f67bf803f80,0x3f783e793f463f22
.quad 0x3e483f7b3f803f80,0x3f0e3f553ec43f6d,0x3e163f7dbf803f80,0x3edb3f673e953f75,0x3dc93f7f3f803f80,0x3e953f753e483f7b,0x3d493f80bf803f80,0x3e163f7d3dc93f7f
.quad 0x3f0e3f55bf353f35,0xbe48bf7b3f6dbec4,0x3eac3f71bf553f0e,0x3e16bf7d3f7fbdc9,0x3dc93f7fbf6d3ec4,0x3ef1bf623f7b3e48,0xbe163f7dbf7b3e48,0x3f3ebf2c3f623ef1
.quad 0xbf7b3e48bf35bf35,0x3f0e3f55bec43f6d,0xbf80bd49bf0ebf55,0x3e793f78bf223f46,0xbf75be95bec4bf6d,0xbdc93f7fbf553f0e,0xbf5cbf04be48bf7b,0xbedb3f67bf753e95
.quad 0x3e48bf7b3f35bf35,0xbf55bf0ebec4bf6d,0x3edbbf673f55bf0e,0xbf18bf4ebdc9bf7f,0x3f22bf463f6dbec4,0xbe95bf753e48bf7b,0x3f4ebf183f7bbe48,0x3d49bf803ef1bf62
.quad 0x3f553f0e3f353f35,0x3f7b3e483f6d3ec4,0x3f2c3f3e3f0e3f55,0x3f5c3f043f463f22,0x3ef13f623ec43f6d,0x3f223f463f0e3f55,0x3e793f783e483f7b,0x3eac3f713e953f75
.quad 0xbe483f7bbf800000,0x3f0ebf553f6d3ec4,0xbf183f4ebf6dbec4,0x3f67bedb3f223f46,0xbf623ef1bf35bf35,0x3f7f3dc93e483f7b,0xbf803d49bec4bf6d,0x3f4e3f18be953f75
.quad 0x3f0ebf553f800000,0xbf7bbe48bec4bf6d,0x3f5cbf043f6d3ec4,0xbf3ebf2c3dc9bf7f,0x3f7fbdc93f353f35,0xbe95bf753f0ebf55,0x3f713eac3ec43f6d,0x3e79bf783f62bef1
.quad 0xbf553f0ebf800000,0x3e483f7bbec43f6d,0xbf7d3e16bf6dbec4,0xbeac3f71bf463f22,0xbf75be95bf35bf35,0xbf463f22bf7b3e48,0xbf3ebf2cbec4bf6d,0xbf7d3e16bf75be95
.quad 0x3f7bbe483f800000,0x3f55bf0e3f6dbec4,0x3f783e793f6d3ec4,0x3f80bd493f7f3dc9,0x3f463f223f353f35,0x3f623ef13f553f0e,0x3edb3f673ec43f6d,0x3f043f5c3ef13f62
.quad 0xbf553f0ebf35bf35,0x3f7bbe483ec43f6d,0xbf80bd49be48bf7b,0x3f5c3f04be953f75,0xbf46bf223ec4bf6d,0x3e953f75bf553f0e,0xbe79bf783f55bf0e,0xbedb3f67bf7fbdc9
.quad 0x3e483f7bbf353f35,0x3f55bf0e3f6d3ec4,0xbedb3f67bf7b3e48,0x3f7d3e163ef13f62,0xbf623ef1bf6dbec4,0x3f223f46be483f7b,0xbf7dbe16bf0ebf55,0xbd493f80bf463f22
.quad 0x3f7b3e483f353f35,0x3f0ebf553f6dbec4,0x3f2c3f3e3e483f7b,0x3f78be793f753e95,0x3dc93f7fbec43f6d,0x3f623ef13f0e3f55,0xbf043f5cbf553f0e,0x3eac3f71bdc93f7f
.quad 0x3f0ebf553f35bf35,0x3e48bf7b3ec4bf6d,0x3f71beac3f7bbe48,0x3f4ebf183f62bef1,0x3f753e953f6d3ec4,0x3f7f3dc93f7b3e48,0x3f183f4e3f0e3f55,0x3f2c3f3e3f223f46
.quad 0xbf7bbe480000bf80,0x3f553f0ebec43f6d,0xbf04bf5c3f35bf35,0x3d493f80bf753e95,0x3e95bf753f800000,0xbf463f22bf55bf0e,0x3f67bedb3f353f35,0xbf78be79bdc9bf7f
.quad 0xbf55bf0e0000bf80,0xbe483f7bbf6d3ec4,0xbe16bf7d3f35bf35,0xbf673edbbf62bef1,0x3f22bf463f800000,0xbf62bef1be48bf7b,0x3f80bd493f353f35,0xbe16bf7d3f22bf46
.quad 0xbf0ebf550000bf80,0xbf7b3e48bf6dbec4,0x3e79bf783f35bf35,0xbf3ebf2cbe95bf75,0x3f62bef13f800000,0x3dc9bf7f3f0ebf55,0x3f713eac3f353f35,0x3f5cbf043f7fbdc9
.quad 0xbe48bf7b0000bf80,0xbf0ebf55bec4bf6d,0x3f18bf4e3f35bf35,0x3eacbf713ef1bf62,0x3f7fbdc93f800000,0x3f75be953f7bbe48,0x3f3e3f2c3f353f35,0x3f4e3f183f463f22
.quad 0xbf0ebf553f35bf35,0x3e483f7bbf6d3ec4,0x3edbbf673f7b3e48,0xbf4e3f18bf46bf22,0x3f7fbdc93ec43f6d,0xbf62bef13e48bf7b,0x3f183f4ebf0e3f55,0x3d49bf803f75be95
.quad 0x3f7bbe483f353f35,0xbf0ebf553ec4bf6d,0x3f2c3f3ebe483f7b,0x3f04bf5c3f7fbdc9,0xbe953f75bf6d3ec4,0x3f7f3dc93f0e3f55,0xbf783e79bf55bf0e,0x3eac3f71bef13f62
.quad 0xbe483f7bbf353f35,0x3f553f0e3ec43f6d,0xbf713eacbf7bbe48,0xbe163f7dbf223f46,0xbf46bf22bec4bf6d,0xbf753e95bf7bbe48,0x3e16bf7d3f0ebf55,0xbf2cbf3ebe95bf75
.quad 0xbf55bf0ebf35bf35,0xbf7bbe48bf6dbec4,0x3d49bf803e48bf7b,0xbe79bf78bdc9bf7f,0x3f62bef13f6dbec4,0x3f46bf223f55bf0e,0x3f5c3f043f553f0e,0x3f673edb3f623ef1
.quad 0x3e48bf7b3f800000,0xbf0e3f55bf6dbec4,0x3f7dbe163ec43f6d,0xbf71beac3dc9bf7f,0x3ef13f62bf353f35,0x3dc9bf7f3f7bbe48,0xbf2c3f3ebf6dbec4,0x3f7dbe163ef13f62
.quad 0xbf0e3f55bf800000,0x3f7b3e483ec43f6d,0xbf78be79bec4bf6d,0x3d493f80bf463f22,0xbdc9bf7f3f35bf35,0xbf753e95bf55bf0e,0x3f67bedb3f6d3ec4,0xbf04bf5c3e95bf75
.quad 0x3f55bf0e3f800000,0xbe48bf7b3ec4bf6d,0x3f4e3f183ec43f6d,0x3f67bedb3f7f3dc9,0xbe953f75bf353f35,0x3f223f463e483f7b,0xbf803d49bf6dbec4,0xbf183f4ebf623ef1
.quad 0xbf7b3e48bf800000,0xbf553f0ebf6d3ec4,0xbf04bf5cbec4bf6d,0xbf3ebf2cbf22bf46,0x3f22bf463f35bf35,0x3ef1bf623f0ebf55,0x3f713eac3f6d3ec4,0x3f783e793f753e95
.quad 0x3f55bf0e3f353f35,0xbf7b3e48bec4bf6d,0x3f2c3f3ebf0e3f55,0xbe79bf783f62bef1,0xbf223f46bf6dbec4,0x3f75be953f0e3f55,0xbf5cbf043e48bf7b,0x3eac3f71bf463f22
.quad 0xbe48bf7b3f35bf35,0xbf553f0ebf6dbec4,0x3f71beac3f553f0e,0xbf18bf4e3e95bf75,0x3ef13f62bec43f6d,0x3f46bf223f7b3e48,0xbf4e3f18bf7bbe48,0x3f2c3f3ebdc93f7f
.quad 0xbf7bbe48bf35bf35,0xbf0e3f55bf6d3ec4,0x3d49bf803f0ebf55,0xbf5cbf04bef1bf62,0x3f7fbdc93f6d3ec4,0x3ef1bf623f55bf0e,0x3e793f78be483f7b,0x3f673edb3f223f46
.quad 0xbf0e3f55bf353f35,0xbe483f7bbec43f6d,0xbf67bedbbf55bf0e,0xbf7dbe16bf75be95,0x3e95bf753ec4bf6d,0x3dc9bf7f3e48bf7b,0x3f7d3e163f7b3e48,0x3f803d493f7f3dc9
.quad 0x3f7b3e4800003f80,0xbf55bf0e3ec4bf6d,0xbe793f78bf800000,0x3f2cbf3e3f623ef1,0xbf75be950000bf80,0x3f223f46bf0e3f55,0x3eacbf713f800000,0xbf5c3f04bf46bf22
.quad 0x3f553f0e00003f80,0x3e48bf7b3f6dbec4,0xbf183f4ebf800000,0x3f713eac3e953f75,0xbf46bf220000bf80,0xbef13f62bf7b3e48,0x3f2cbf3e3f800000,0xbf4ebf18bdc9bf7f
.quad 0x3f0e3f5500003f80,0x3f7bbe483f6d3ec4,0xbf5c3f04bf800000,0x3d493f80bef13f62,0xbef1bf620000bf80,0xbf7fbdc9bf55bf0e,0x3f67bedb3f800000,0x3e79bf783f22bf46
.quad 0x3e483f7b00003f80,0x3f0e3f553ec43f6d,0xbf7d3e16bf800000,0xbf673edbbf753e95,0xbdc9bf7f0000bf80,0xbe95bf75be48bf7b,0x3f80bd493f800000,0x3f7dbe163f7fbdc9
.quad 0x3f0e3f55bf353f35,0xbe48bf7b3f6dbec4,0xbf713eacbf0ebf55,0x3f7d3e163dc93f7f,0xbdc9bf7f3f6dbec4,0xbef13f62bf7bbe48,0x3f7d3e163e483f7b,0xbf2cbf3e3ef1bf62
.quad 0xbf7b3e48bf35bf35,0x3f0e3f55bec43f6d,0x3d49bf803f55bf0e,0xbf783e79bf46bf22,0x3f753e953ec43f6d,0x3dc9bf7f3f55bf0e,0xbf043f5cbf7b3e48,0x3f673edb3e953f75
.quad 0x3e48bf7b3f35bf35,0xbf55bf0ebec4bf6d,0x3f673edb3f0e3f55,0x3f4ebf183f7fbdc9,0xbf223f46bf6d3ec4,0x3e953f75be483f7b,0xbf18bf4ebe48bf7b,0xbf80bd49bf62bef1
.quad 0x3f553f0e3f353f35,0x3f7b3e483f6d3ec4,0xbf3e3f2cbf553f0e,0xbf043f5cbf223f46,0xbef1bf62bec4bf6d,0xbf22bf46bf0ebf55,0x3f78be793f7bbe48,0x3f71beac3f75be95
.quad 0xbe483f7bbf800000,0x3f0ebf553f6d3ec4,0xbf4ebf183ec4bf6d,0x3edb3f67bf463f22,0x3f62bef13f353f35,0xbf7fbdc9be48bf7b,0x3d493f80bf6d3ec4,0x3f18bf4e3f753e95
.quad 0x3f0ebf553f800000,0xbf7bbe48bec4bf6d,0x3f043f5cbec43f6d,0x3f2cbf3e3f7f3dc9,0xbf7f3dc9bf35bf35,0x3e953f75bf0e3f55,0x3eacbf713f6dbec4,0xbf78be79bef1bf62
.quad 0xbf553f0ebf800000,0x3e483f7bbec43f6d,0xbe16bf7d3ec4bf6d,0xbf71beacbf22bf46,0x3f753e953f353f35,0x3f46bf223f7bbe48,0xbf2c3f3ebf6d3ec4,0x3e163f7dbe953f75
.quad 0x3f7bbe483f800000,0x3f55bf0e3f6dbec4,0xbe793f78bec43f6d,0x3d493f80bdc93f7f,0xbf46bf22bf35bf35,0xbf62bef1bf55bf0e,0x3f67bedb3f6dbec4,0x3f5cbf043f62bef1
.quad 0xbf553f0ebf35bf35,0x3f7bbe483ec43f6d,0x3d49bf803f7bbe48,0xbf043f5cbf75be95,0x3f463f22bec43f6d,0xbe95bf753f55bf0e,0xbf783e79bf0ebf55,0x3f673edbbdc93f7f
.quad 0x3e483f7bbf353f35,0x3f55bf0e3f6d3ec4,0xbf67bedbbe48bf7b,0xbe163f7dbf623ef1,0x3f62bef13f6d3ec4,0xbf22bf463e48bf7b,0xbe163f7dbf553f0e,0x3f803d493f223f46
.quad 0x3f7b3e483f353f35,0x3f0ebf553f6dbec4,0xbf3e3f2cbf7b3e48,0x3e793f78be953f75,0xbdc9bf7f3ec4bf6d,0xbf62bef1bf0ebf55,0x3f5c3f043f0e3f55,0x3f71beac3f7f3dc9
.quad 0x3f0ebf553f35bf35,0x3e48bf7b3ec4bf6d,0x3eac3f713e483f7b,0x3f183f4e3ef13f62,0xbf75be95bf6dbec4,0xbf7fbdc9bf7bbe48,0x3f4ebf183f55bf0e,0x3f3ebf2c3f46bf22
.quad 0xbf7bbe480000bf80,0x3f553f0ebec43f6d,0x3f5cbf043f353f35,0xbf803d49be95bf75,0xbe953f75bf800000,0x3f46bf223f553f0e,0xbedbbf673f35bf35,0xbe793f78bf7f3dc9
.quad 0xbf55bf0e0000bf80,0xbe483f7bbf6d3ec4,0x3f7dbe163f353f35,0xbedbbf673ef1bf62,0xbf223f46bf800000,0x3f623ef13e483f7b,0xbd49bf803f35bf35,0xbf7d3e16bf46bf22
.quad 0xbf0ebf550000bf80,0xbf7b3e48bf6dbec4,0x3f783e793f353f35,0x3f2cbf3e3f75be95,0xbf623ef1bf800000,0xbdc93f7fbf0e3f55,0x3eacbf713f35bf35,0xbf04bf5cbdc9bf7f
.quad 0xbe48bf7b0000bf80,0xbf0ebf55bec4bf6d,0x3f4e3f183f353f35,0x3f713eac3f623ef1,0xbf7f3dc9bf800000,0xbf753e95bf7b3e48,0x3f2cbf3e3f35bf35,0x3f18bf4e3f22bf46
.quad 0xbf0ebf553f35bf35,0x3e483f7bbf6d3ec4,0x3f673edbbe483f7b,0xbf18bf4e3f22bf46,0xbf7f3dc9bec4bf6d,0x3f623ef1be483f7b,0x3f4ebf183f553f0e,0xbf80bd49be95bf75
.quad 0x3f7bbe483f353f35,0xbf0ebf553ec4bf6d,0xbf3e3f2cbf7bbe48,0x3f5c3f043dc93f7f,0x3e95bf753f6dbec4,0xbf7fbdc9bf0ebf55,0x3e793f78bf0e3f55,0x3f71beac3f623ef1
.quad 0xbe483f7bbf353f35,0x3f553f0e3ec43f6d,0xbeacbf713e48bf7b,0xbf7dbe16bf46bf22,0x3f463f223ec43f6d,0x3f75be953f7b3e48,0xbf7dbe16bf55bf0e,0xbf3e3f2cbf753e95
.quad 0xbf55bf0ebf35bf35,0xbf7bbe48bf6dbec4,0x3f803d493f7b3e48,0x3f78be793f7fbdc9,0xbf623ef1bf6d3ec4,0xbf463f22bf553f0e,0x3f04bf5c3f0ebf55,0x3edbbf673ef1bf62
.quad 0x3e48bf7b3f800000,0xbf0e3f55bf6dbec4,0x3e163f7dbf6d3ec4,0x3eacbf713f7f3dc9,0xbef1bf623f35bf35,0xbdc93f7fbf7b3e48,0x3f3e3f2cbec43f6d,0xbe16bf7d3f62bef1
.quad 0xbf0e3f55bf800000,0x3f7b3e483ec43f6d,0x3e79bf783f6dbec4,0xbf803d49bf22bf46,0x3dc93f7fbf353f35,0x3f75be953f553f0e,0xbedbbf673ec4bf6d,0xbf5c3f04bf75be95
.quad 0x3f55bf0e3f800000,0xbe48bf7b3ec4bf6d,0xbf183f4ebf6d3ec4,0x3edb3f67bdc93f7f,0x3e95bf753f35bf35,0xbf22bf46be48bf7b,0x3d493f80bec43f6d,0x3f4e3f183ef13f62
.quad 0xbf7b3e48bf800000,0xbf553f0ebf6d3ec4,0x3f5cbf043f6dbec4,0x3f2cbf3e3f46bf22,0xbf223f46bf353f35,0xbef13f62bf0e3f55,0x3eacbf713ec4bf6d,0x3e79bf783e95bf75
.quad 0x3f55bf0e3f353f35,0xbf7b3e48bec4bf6d,0xbf3e3f2cbf55bf0e,0x3f78be793ef13f62,0x3f22bf463f6d3ec4,0xbf753e95bf0ebf55,0xbf043f5cbf7bbe48,0x3f71beac3f223f46
.quad 0xbe48bf7b3f35bf35,0xbf553f0ebf6dbec4,0x3eac3f71bf0e3f55,0x3f4ebf183f753e95,0xbef1bf623ec4bf6d,0xbf463f22bf7bbe48,0x3f183f4ebe483f7b,0x3f3ebf2c3f7f3dc9
.quad 0xbf7bbe48bf35bf35,0xbf0e3f55bf6d3ec4,0x3f803d493f553f0e,0x3f04bf5c3f62bef1,0xbf7f3dc9bf6dbec4,0xbef13f62bf553f0e,0x3f78be793f7b3e48,0x3edbbf673f46bf22
.quad 0xbf0e3f55bf353f35,0xbe483f7bbec43f6d,0x3edbbf673f0ebf55,0x3e16bf7d3e95bf75,0xbe953f75bec43f6d,0xbdc93f7fbe483f7b,0x3e16bf7d3e48bf7b,0x3d49bf803dc9bf7f
.size L_tab, 71680
.section .rodata,"a"
.p2align 6
.amdhsa_kernel sequential_preLN__spectral_gfnet__dense_activation_silu__prompt_kernel
  .amdhsa_next_free_vgpr 512
  .amdhsa_next_free_sgpr 102
  .amdhsa_accum_offset 256
  .amdhsa_group_segment_fixed_size 0
  .amdhsa_kernarg_size 72
  .amdhsa_user_sgpr_count 2
  .amdhsa_user_sgpr_kernarg_segment_ptr 1
  .amdhsa_system_sgpr_workgroup_id_x 1
.end_amdhsa_kernel
```
